```python
import torch

def _softmax(x, axis=-1):
    return torch.softmax(x, dim=axis)
def _gelu(x):
    return torch.nn.functional.gelu(x, approximate="tanh")
def _silu(x):
    return torch.nn.functional.silu(x)
def _sigmoid(x):
    return torch.sigmoid(x)
def _layernorm(x, axis=-1, eps=1e-5):
    m = x.mean(dim=axis, keepdim=True)
    v = x.var(dim=axis, keepdim=True, unbiased=False)
    return (x - m) / torch.sqrt(v + eps)
def _scatter_add(tgt, idx, src, axis=0):
    return tgt.clone().index_add_(axis, idx, src)
def _segment_sum(src, seg, n):
    out = torch.zeros((n,) + src.shape[1:], dtype=src.dtype)
    return out.index_add_(0, seg, src)
def _pad(x, pw):
    flat = tuple(v for pair in reversed(pw) for v in pair)
    return torch.nn.functional.pad(x, flat)

kernel_name = 'interleave_layers__ssm_conv_h3__swiglu_ffn__prompt'

def setup_inputs():

    _w = (lambda a: (lambda t: t.to(torch.bfloat16) if t.is_floating_point() else t)(torch.as_tensor(a)))
    def _A_setup():
        B, S, D = 1, 2048, 448
        ks = 4
        return {
            "q": _w((lambda *s: torch.randn(*s, dtype=torch.bfloat16) * 0.05)(B, S, D)),
            "k": _w((lambda *s: torch.randn(*s, dtype=torch.bfloat16) * 0.8)(B, S, D)),
            "v": _w((lambda *s: torch.randn(*s, dtype=torch.bfloat16) * 0.8)(B, S, D)),
            "shift_k": _w((lambda *s: torch.randn(*s, dtype=torch.bfloat16) * 0.8)(D, ks) * 0.5),
            "ssm_k": _w((lambda *s: torch.randn(*s, dtype=torch.bfloat16) * 0.8)(D, S) * (1.0 / S ** 0.5)),
            "ssm_D": _w((lambda *s: torch.randn(*s, dtype=torch.bfloat16) * 0.8)(D)),
        }
    _A_in = _A_setup()

    def _B_setup():
        B, S, D, F = 1, 2048, 448, 1792
        return {
            "x": _w((lambda *s: torch.randn(*s, dtype=torch.bfloat16) * 0.05)(B, S, D)),
            "w_gate": _w((lambda *s: torch.randn(*s, dtype=torch.bfloat16) * 0.1)(D, F)),
            "w_up": _w((lambda *s: torch.randn(*s, dtype=torch.bfloat16) * 0.1)(D, F)),
            "w_down": _w((lambda *s: torch.randn(*s, dtype=torch.bfloat16) * 0.1)(F, D)),
        }
    _B_in = _B_setup()

    return {
        "A_q": _A_in["q"],
        "A_k": _A_in["k"],
        "A_v": _A_in["v"],
        "A_shift_k": _A_in["shift_k"],
        "A_ssm_k": _A_in["ssm_k"],
        "A_ssm_D": _A_in["ssm_D"],
        "B_x": _B_in["x"],
        "B_w_gate": _B_in["w_gate"],
        "B_w_up": _B_in["w_up"],
        "B_w_down": _B_in["w_down"],
    }

def reference(A_q, A_k, A_v, A_shift_k, A_ssm_k, A_ssm_D, B_x, B_w_gate, B_w_up, B_w_down):
    def _A_ref(q, k, v, shift_k, ssm_k, ssm_D):
        B, S, D = q.shape
        ks = shift_k.shape[-1]
        k_pad = _pad(k, ((0, 0), (ks - 1, 0), (0, 0)))
        k_shift = torch.zeros_like(k)
        for t in range(ks):
            k_shift = k_shift + k_pad[:, t:t + S, :] * shift_k[:, ks - 1 - t][None, None, :]
        kv = k_shift * v
        L = 2 * S
        kv_pad = _pad(kv, ((0, 0), (0, S), (0, 0)))
        kf_pad = _pad(ssm_k, ((0, 0), (0, S)))
        kv_f = (lambda x, axes=(-2,-1): torch.fft.rfft2(x.float(), dim=axes))(kv_pad[:, None, :, :], axes=(1, 2))
        kf_f = (lambda x, axes=(-2,-1): torch.fft.rfft2(x.float(), dim=axes))(kf_pad[:, None, :], axes=(1, 2))
        kf_f = (lambda x, *d: x.permute(*d))(kf_f, 1, 2, 0)
        y_f = kv_f * kf_f[None, :, :, :]
        y = (lambda x, s, axes=(-2,-1): torch.fft.irfft2(x, s=s, dim=axes).to(torch.bfloat16))(y_f, (1, L), axes=(1, 2))[:, 0, :S, :]
        y = y + kv * ssm_D[None, None, :]
        return q * y

    def _B_ref(x, w_gate, w_up, w_down):
        g = _silu(x @ w_gate)
        u = x @ w_up
        return (g * u) @ w_down

    x = A_q
    x = x + _A_ref(_layernorm(x, axis=-1), A_k, A_v, A_shift_k, A_ssm_k, A_ssm_D)
    x = x + _B_ref(_layernorm(x, axis=-1), B_w_gate, B_w_up, B_w_down)
    x = x + _A_ref(_layernorm(x, axis=-1), A_k, A_v, A_shift_k, A_ssm_k, A_ssm_D)
    x = x + _B_ref(_layernorm(x, axis=-1), B_w_gate, B_w_up, B_w_down)
    return x
```

```asm
; @launch grid=(256,1,1) block=(256,1,1) lds=163840
.amdgcn_target "amdgcn-amd-amdhsa--gfx950"
.text
.globl interleave_layers__ssm_conv_h3__swiglu_ffn__prompt_kernel
.p2align 8
.type interleave_layers__ssm_conv_h3__swiglu_ffn__prompt_kernel,@function
interleave_layers__ssm_conv_h3__swiglu_ffn__prompt_kernel:
    s_cmp_ge_u32 s2, 256
    s_cbranch_scc1 KB_done
    s_load_dwordx2 s[4:5], s[0:1], 96
    s_load_dwordx4 s[48:51], s[0:1], 32
    s_load_dwordx2 s[6:7], s[0:1], 0
    s_load_dwordx4 s[52:55], s[0:1], 56
    s_load_dwordx4 s[56:59], s[0:1], 72
    s_load_dwordx4 s[40:43], s[0:1], 8
    s_load_dwordx2 s[44:45], s[0:1], 24
    s_load_dwordx2 s[98:99], s[0:1], 88
    s_memrealtime s[96:97]
    v_lshrrev_b32 v1, 6, v0
    v_and_b32 v0, 63, v0
    v_readfirstlane_b32 s36, v1
    s_getreg_b32 s38, hwreg(HW_REG_XCC_ID, 0, 4)
    s_mov_b32 s39, 0
    s_mov_b32 s77, 0xffff0000
    s_mov_b32 s78, 4096
    v_lshlrev_b32 v1, 4, v0
    s_waitcnt lgkmcnt(0)
    s_or_b32 s97, s97, 0x80000000
    s_or_b32 s3, s2, s36
    s_cmp_eq_u32 s3, 0
    s_cbranch_scc0 NP_1_1
    v_mov_b32 v2, s96
    v_mov_b32 v3, s97
    v_mov_b32 v4, 0
    s_mov_b64 s[60:61], exec
    s_mov_b64 exec, 1
    global_store_dwordx2 v4, v[2:3], s[98:99] sc0 sc1
    s_mov_b64 exec, s[60:61]
NP_1_1:
    s_mov_b32 s8, s4
    s_and_b32 s9, s5, 0xffff
    s_mov_b32 s10, 0x19c6400
    s_mov_b32 s11, 0x20000
    s_mov_b32 s12, s48
    s_and_b32 s13, s49, 0xffff
    s_mov_b32 s14, 0x1c0000
    s_mov_b32 s15, 0x20000
    s_mov_b32 s16, s6
    s_and_b32 s17, s7, 0xffff
    s_mov_b32 s18, 0x1c0000
    s_mov_b32 s19, 0x20000
    s_mov_b32 s20, s52
    s_and_b32 s21, s53, 0xffff
    s_mov_b32 s22, 0x188000
    s_mov_b32 s23, 0x20000
    s_mov_b32 s24, s54
    s_and_b32 s25, s55, 0xffff
    s_mov_b32 s26, 0x188000
    s_mov_b32 s27, 0x20000
    s_mov_b32 s28, s56
    s_and_b32 s29, s57, 0xffff
    s_mov_b32 s30, 0x188000
    s_mov_b32 s31, 0x20000
    s_mov_b32 s32, s58
    s_and_b32 s33, s59, 0xffff
    s_mov_b32 s34, 0x1c0000
    s_mov_b32 s35, 0x20000
    s_mov_b32 s100, s50
    s_mov_b32 s101, s51
    s_mov_b32 s48, s40
    s_and_b32 s49, s41, 0xffff
    s_mov_b32 s50, 0x1c0000
    s_mov_b32 s51, 0x20000
    s_mov_b32 s52, s42
    s_and_b32 s53, s43, 0xffff
    s_mov_b32 s54, 0x1c0000
    s_mov_b32 s55, 0x20000
    s_mov_b32 s56, s44
    s_and_b32 s57, s45, 0xffff
    s_mov_b32 s58, 0xe00
    s_mov_b32 s59, 0x20000
    s_cmp_ge_u32 s2, 224
    s_cbranch_scc1 KB_spare
    s_and_b32 s64, s2, 7
    s_lshr_b32 s65, s2, 3
    s_mul_hi_u32 s67, s65, 0x24924925
    s_mul_i32 s80, s67, 7
    s_sub_u32 s66, s65, s80
    s_lshl_b32 s76, s64, 3
    s_add_u32 s68, s67, s76
    s_and_b32 s80, s36, 1
    s_lshl_b32 s69, s66, 1
    s_add_u32 s69, s69, s80
    s_lshr_b32 s5, s36, 1
    s_lshl_b32 s63, s65, 2
    s_add_u32 s63, s63, s36
    s_mul_i32 s3, s68, 28
    s_lshl_b32 s80, s69, 1
    s_add_u32 s3, s3, s80
    s_add_u32 s3, s3, s5
    s_lshl_b32 s3, s3, 10
    s_mul_i32 s4, s68, 14
    s_add_u32 s4, s4, s69
    s_lshl_b32 s4, s4, 9
    s_mul_hi_u32 s40, s2, 0x24924925
    s_mul_i32 s41, s40, 7
    s_sub_u32 s41, s2, s41
    s_mul_i32 s42, s40, 57344
    s_lshl_b32 s43, s41, 7
    s_add_u32 s42, s42, s43
    s_sub_u32 s42, s42, 3584
    v_and_b32 v2, 7, v0
    v_lshrrev_b32 v3, 3, v0
    s_lshl_b32 s44, s36, 3
    v_add_u32 v3, s44, v3
    v_mul_u32_u24 v4, 1792, v3
    v_lshl_add_u32 v4, v2, 4, v4
    v_add_u32 v4, s42, v4
    v_add_u32 v5, 896, v4
    v_add_u32 v6, 1792, v4
    v_add_u32 v7, 2688, v4
    v_add_u32 v8, 3584, v4
    v_add_u32 v9, 4480, v4
    buffer_load_dwordx4 v[12:15], v4, s[48:51], 0 offen
    buffer_load_dwordx4 v[16:19], v5, s[48:51], 0 offen
    buffer_load_dwordx4 v[20:23], v6, s[48:51], 0 offen
    buffer_load_dwordx4 v[24:27], v7, s[48:51], 0 offen
    buffer_load_dwordx4 v[28:31], v8, s[48:51], 0 offen
    buffer_load_dwordx4 v[32:35], v9, s[48:51], 0 offen
    buffer_load_dwordx4 v[36:39], v7, s[52:55], 0 offen
    buffer_load_dwordx4 v[40:43], v8, s[52:55], 0 offen
    buffer_load_dwordx4 v[44:47], v9, s[52:55], 0 offen
    s_lshl_b32 s43, s41, 9
    v_lshl_add_u32 v10, v2, 6, s43
    buffer_load_dwordx4 v[48:51], v10, s[56:59], 0 offen offset:0
    buffer_load_dwordx4 v[52:55], v10, s[56:59], 0 offen offset:16
    buffer_load_dwordx4 v[56:59], v10, s[56:59], 0 offen offset:32
    buffer_load_dwordx4 v[60:63], v10, s[56:59], 0 offen offset:48
    v_mov_b32 v116, 0
    global_load_dwordx2 v[114:115], v116, s[98:99] sc1
    s_lshr_b32 s81, s36, 1
    v_lshrrev_b32 v177, 4, v0
    v_and_b32 v177, 1, v177
    v_lshrrev_b32 v178, 2, v0
    v_and_b32 v178, 3, v178
    v_lshl_add_u32 v177, v177, 2, v178
    s_mov_b32 s80, 3584
    v_mul_lo_u32 v177, s80, v177
    v_and_b32 v178, 3, v0
    s_lshl_b32 s80, s81, 1
    v_xor_b32 v178, s80, v178
    v_lshrrev_b32 v179, 5, v0
    v_lshl_add_u32 v178, v179, 2, v178
    v_lshl_add_u32 v176, v178, 4, v177
    s_cmp_eq_u32 s81, 0
    s_cselect_b32 s72, s20, s24
    s_cselect_b32 s73, s21, s25
    s_mov_b32 s74, 0x188000
    s_mov_b32 s75, 0x20000
    s_and_b32 s82, s36, 1
    s_mul_i32 s70, s82, 802816
    s_lshl_b32 s71, s65, 7
    s_add_u32 s70, s70, s71
    s_mul_i32 s71, s81, 57344
    s_mul_i32 s82, s82, 28672
    s_add_u32 s71, s71, s82
    s_barrier
    s_add_u32 m0, s71, 0
    s_add_u32 s79, s70, 0
    buffer_load_dwordx4 v176, s[72:75], s79 offen offset:0 lds
    s_add_u32 m0, s71, 0
    s_add_u32 s79, s70, 27648
    buffer_load_dwordx4 v176, s[72:75], s79 offen offset:1024 lds
    s_add_u32 m0, s71, 0
    s_add_u32 s79, s70, 55296
    buffer_load_dwordx4 v176, s[72:75], s79 offen offset:2048 lds
    s_add_u32 m0, s71, 0
    s_add_u32 s79, s70, 82944
    buffer_load_dwordx4 v176, s[72:75], s79 offen offset:3072 lds
    s_add_u32 m0, s71, 4096
    s_add_u32 s79, s70, 114688
    buffer_load_dwordx4 v176, s[72:75], s79 offen offset:0 lds
    s_add_u32 m0, s71, 4096
    s_add_u32 s79, s70, 142336
    buffer_load_dwordx4 v176, s[72:75], s79 offen offset:1024 lds
    s_add_u32 m0, s71, 4096
    s_add_u32 s79, s70, 169984
    buffer_load_dwordx4 v176, s[72:75], s79 offen offset:2048 lds
    s_add_u32 m0, s71, 4096
    s_add_u32 s79, s70, 197632
    buffer_load_dwordx4 v176, s[72:75], s79 offen offset:3072 lds
    s_waitcnt vmcnt(9)
    s_mul_hi_u32 s40, s2, 0x24924925
    s_mul_i32 s41, s40, 7
    s_sub_u32 s41, s2, s41
    v_sub_u32 v10, 31, v3
    v_lshlrev_b32 v11, 2, v2
    v_xor_b32 v10, v10, v11
    v_lshlrev_b32 v10, 2, v10
    v_lshl_add_u32 v10, v2, 10, v10
    v_add_u32 v10, 114688, v10
    v_lshlrev_b32 v64, 16, v12
    v_and_b32 v65, s77, v12
    v_lshlrev_b32 v66, 16, v16
    v_and_b32 v67, s77, v16
    v_lshlrev_b32 v68, 16, v20
    v_and_b32 v69, s77, v20
    v_lshlrev_b32 v70, 16, v24
    v_and_b32 v71, s77, v24
    v_lshlrev_b32 v72, 16, v28
    v_and_b32 v73, s77, v28
    v_lshlrev_b32 v74, 16, v32
    v_and_b32 v75, s77, v32
    v_lshlrev_b32 v76, 16, v36
    v_and_b32 v77, s77, v36
    v_lshlrev_b32 v78, 16, v40
    v_and_b32 v79, s77, v40
    v_lshlrev_b32 v80, 16, v44
    v_and_b32 v81, s77, v44
    v_lshlrev_b32 v82, 16, v48
    v_and_b32 v83, s77, v48
    v_lshlrev_b32 v84, 16, v49
    v_and_b32 v85, s77, v49
    v_lshlrev_b32 v86, 16, v50
    v_and_b32 v87, s77, v50
    v_lshlrev_b32 v88, 16, v51
    v_and_b32 v89, s77, v51
    v_mul_f32 v90, v64, v85
    v_fmac_f32 v90, v66, v84
    v_fmac_f32 v90, v68, v83
    v_fmac_f32 v90, v70, v82
    v_mul_f32 v90, v90, v76
    v_mul_f32 v91, v65, v89
    v_fmac_f32 v91, v67, v88
    v_fmac_f32 v91, v69, v87
    v_fmac_f32 v91, v71, v86
    v_mul_f32 v91, v91, v77
    v_mul_f32 v92, v66, v85
    v_fmac_f32 v92, v68, v84
    v_fmac_f32 v92, v70, v83
    v_fmac_f32 v92, v72, v82
    v_mul_f32 v92, v92, v78
    v_mul_f32 v93, v67, v89
    v_fmac_f32 v93, v69, v88
    v_fmac_f32 v93, v71, v87
    v_fmac_f32 v93, v73, v86
    v_mul_f32 v93, v93, v79
    v_mul_f32 v94, v68, v85
    v_fmac_f32 v94, v70, v84
    v_fmac_f32 v94, v72, v83
    v_fmac_f32 v94, v74, v82
    v_mul_f32 v94, v94, v80
    v_mul_f32 v95, v69, v89
    v_fmac_f32 v95, v71, v88
    v_fmac_f32 v95, v73, v87
    v_fmac_f32 v95, v75, v86
    v_mul_f32 v95, v95, v81
    v_cvt_pk_bf16_f32 v96, v92, v90
    v_cvt_pk_bf16_f32 v97, v94, v92
    ds_write_b32 v10, v96 offset:0
    ds_write_b32 v10, v97 offset:8192
    v_cvt_pk_bf16_f32 v98, v93, v91
    v_cvt_pk_bf16_f32 v99, v95, v93
    ds_write_b32 v10, v98 offset:128
    ds_write_b32 v10, v99 offset:8320
    v_lshlrev_b32 v64, 16, v13
    v_and_b32 v65, s77, v13
    v_lshlrev_b32 v66, 16, v17
    v_and_b32 v67, s77, v17
    v_lshlrev_b32 v68, 16, v21
    v_and_b32 v69, s77, v21
    v_lshlrev_b32 v70, 16, v25
    v_and_b32 v71, s77, v25
    v_lshlrev_b32 v72, 16, v29
    v_and_b32 v73, s77, v29
    v_lshlrev_b32 v74, 16, v33
    v_and_b32 v75, s77, v33
    v_lshlrev_b32 v76, 16, v37
    v_and_b32 v77, s77, v37
    v_lshlrev_b32 v78, 16, v41
    v_and_b32 v79, s77, v41
    v_lshlrev_b32 v80, 16, v45
    v_and_b32 v81, s77, v45
    v_lshlrev_b32 v82, 16, v52
    v_and_b32 v83, s77, v52
    v_lshlrev_b32 v84, 16, v53
    v_and_b32 v85, s77, v53
    v_lshlrev_b32 v86, 16, v54
    v_and_b32 v87, s77, v54
    v_lshlrev_b32 v88, 16, v55
    v_and_b32 v89, s77, v55
    v_mul_f32 v90, v64, v85
    v_fmac_f32 v90, v66, v84
    v_fmac_f32 v90, v68, v83
    v_fmac_f32 v90, v70, v82
    v_mul_f32 v90, v90, v76
    v_mul_f32 v91, v65, v89
    v_fmac_f32 v91, v67, v88
    v_fmac_f32 v91, v69, v87
    v_fmac_f32 v91, v71, v86
    v_mul_f32 v91, v91, v77
    v_mul_f32 v92, v66, v85
    v_fmac_f32 v92, v68, v84
    v_fmac_f32 v92, v70, v83
    v_fmac_f32 v92, v72, v82
    v_mul_f32 v92, v92, v78
    v_mul_f32 v93, v67, v89
    v_fmac_f32 v93, v69, v88
    v_fmac_f32 v93, v71, v87
    v_fmac_f32 v93, v73, v86
    v_mul_f32 v93, v93, v79
    v_mul_f32 v94, v68, v85
    v_fmac_f32 v94, v70, v84
    v_fmac_f32 v94, v72, v83
    v_fmac_f32 v94, v74, v82
    v_mul_f32 v94, v94, v80
    v_mul_f32 v95, v69, v89
    v_fmac_f32 v95, v71, v88
    v_fmac_f32 v95, v73, v87
    v_fmac_f32 v95, v75, v86
    v_mul_f32 v95, v95, v81
    v_cvt_pk_bf16_f32 v96, v92, v90
    v_cvt_pk_bf16_f32 v97, v94, v92
    ds_write_b32 v10, v96 offset:256
    ds_write_b32 v10, v97 offset:8448
    v_cvt_pk_bf16_f32 v98, v93, v91
    v_cvt_pk_bf16_f32 v99, v95, v93
    ds_write_b32 v10, v98 offset:384
    ds_write_b32 v10, v99 offset:8576
    v_lshlrev_b32 v64, 16, v14
    v_and_b32 v65, s77, v14
    v_lshlrev_b32 v66, 16, v18
    v_and_b32 v67, s77, v18
    v_lshlrev_b32 v68, 16, v22
    v_and_b32 v69, s77, v22
    v_lshlrev_b32 v70, 16, v26
    v_and_b32 v71, s77, v26
    v_lshlrev_b32 v72, 16, v30
    v_and_b32 v73, s77, v30
    v_lshlrev_b32 v74, 16, v34
    v_and_b32 v75, s77, v34
    v_lshlrev_b32 v76, 16, v38
    v_and_b32 v77, s77, v38
    v_lshlrev_b32 v78, 16, v42
    v_and_b32 v79, s77, v42
    v_lshlrev_b32 v80, 16, v46
    v_and_b32 v81, s77, v46
    v_lshlrev_b32 v82, 16, v56
    v_and_b32 v83, s77, v56
    v_lshlrev_b32 v84, 16, v57
    v_and_b32 v85, s77, v57
    v_lshlrev_b32 v86, 16, v58
    v_and_b32 v87, s77, v58
    v_lshlrev_b32 v88, 16, v59
    v_and_b32 v89, s77, v59
    v_mul_f32 v90, v64, v85
    v_fmac_f32 v90, v66, v84
    v_fmac_f32 v90, v68, v83
    v_fmac_f32 v90, v70, v82
    v_mul_f32 v90, v90, v76
    v_mul_f32 v91, v65, v89
    v_fmac_f32 v91, v67, v88
    v_fmac_f32 v91, v69, v87
    v_fmac_f32 v91, v71, v86
    v_mul_f32 v91, v91, v77
    v_mul_f32 v92, v66, v85
    v_fmac_f32 v92, v68, v84
    v_fmac_f32 v92, v70, v83
    v_fmac_f32 v92, v72, v82
    v_mul_f32 v92, v92, v78
    v_mul_f32 v93, v67, v89
    v_fmac_f32 v93, v69, v88
    v_fmac_f32 v93, v71, v87
    v_fmac_f32 v93, v73, v86
    v_mul_f32 v93, v93, v79
    v_mul_f32 v94, v68, v85
    v_fmac_f32 v94, v70, v84
    v_fmac_f32 v94, v72, v83
    v_fmac_f32 v94, v74, v82
    v_mul_f32 v94, v94, v80
    v_mul_f32 v95, v69, v89
    v_fmac_f32 v95, v71, v88
    v_fmac_f32 v95, v73, v87
    v_fmac_f32 v95, v75, v86
    v_mul_f32 v95, v95, v81
    v_cvt_pk_bf16_f32 v96, v92, v90
    v_cvt_pk_bf16_f32 v97, v94, v92
    ds_write_b32 v10, v96 offset:512
    ds_write_b32 v10, v97 offset:8704
    v_cvt_pk_bf16_f32 v98, v93, v91
    v_cvt_pk_bf16_f32 v99, v95, v93
    ds_write_b32 v10, v98 offset:640
    ds_write_b32 v10, v99 offset:8832
    v_lshlrev_b32 v64, 16, v15
    v_and_b32 v65, s77, v15
    v_lshlrev_b32 v66, 16, v19
    v_and_b32 v67, s77, v19
    v_lshlrev_b32 v68, 16, v23
    v_and_b32 v69, s77, v23
    v_lshlrev_b32 v70, 16, v27
    v_and_b32 v71, s77, v27
    v_lshlrev_b32 v72, 16, v31
    v_and_b32 v73, s77, v31
    v_lshlrev_b32 v74, 16, v35
    v_and_b32 v75, s77, v35
    v_lshlrev_b32 v76, 16, v39
    v_and_b32 v77, s77, v39
    v_lshlrev_b32 v78, 16, v43
    v_and_b32 v79, s77, v43
    v_lshlrev_b32 v80, 16, v47
    v_and_b32 v81, s77, v47
    v_lshlrev_b32 v82, 16, v60
    v_and_b32 v83, s77, v60
    v_lshlrev_b32 v84, 16, v61
    v_and_b32 v85, s77, v61
    v_lshlrev_b32 v86, 16, v62
    v_and_b32 v87, s77, v62
    v_lshlrev_b32 v88, 16, v63
    v_and_b32 v89, s77, v63
    v_mul_f32 v90, v64, v85
    v_fmac_f32 v90, v66, v84
    v_fmac_f32 v90, v68, v83
    v_fmac_f32 v90, v70, v82
    v_mul_f32 v90, v90, v76
    v_mul_f32 v91, v65, v89
    v_fmac_f32 v91, v67, v88
    v_fmac_f32 v91, v69, v87
    v_fmac_f32 v91, v71, v86
    v_mul_f32 v91, v91, v77
    v_mul_f32 v92, v66, v85
    v_fmac_f32 v92, v68, v84
    v_fmac_f32 v92, v70, v83
    v_fmac_f32 v92, v72, v82
    v_mul_f32 v92, v92, v78
    v_mul_f32 v93, v67, v89
    v_fmac_f32 v93, v69, v88
    v_fmac_f32 v93, v71, v87
    v_fmac_f32 v93, v73, v86
    v_mul_f32 v93, v93, v79
    v_mul_f32 v94, v68, v85
    v_fmac_f32 v94, v70, v84
    v_fmac_f32 v94, v72, v83
    v_fmac_f32 v94, v74, v82
    v_mul_f32 v94, v94, v80
    v_mul_f32 v95, v69, v89
    v_fmac_f32 v95, v71, v88
    v_fmac_f32 v95, v73, v87
    v_fmac_f32 v95, v75, v86
    v_mul_f32 v95, v95, v81
    v_cvt_pk_bf16_f32 v96, v92, v90
    v_cvt_pk_bf16_f32 v97, v94, v92
    ds_write_b32 v10, v96 offset:768
    ds_write_b32 v10, v97 offset:8960
    v_cvt_pk_bf16_f32 v98, v93, v91
    v_cvt_pk_bf16_f32 v99, v95, v93
    ds_write_b32 v10, v98 offset:896
    ds_write_b32 v10, v99 offset:9088
    s_waitcnt lgkmcnt(0)
    s_barrier
    v_lshrrev_b32 v4, 3, v3
    v_xor_b32 v4, v4, v2
    v_lshlrev_b32 v5, 4, v4
    v_lshl_add_u32 v5, v3, 7, v5
    v_add_u32 v5, 114688, v5
    v_xor_b32 v6, 64, v5
    v_add_u32 v6, 4096, v6
    ds_read_b128 v[12:15], v5
    ds_read_b128 v[16:19], v6
    ds_read_b128 v[20:23], v5 offset:8192
    ds_read_b128 v[24:27], v6 offset:8192
    s_lshl_b32 s45, s41, 18
    s_lshl_b32 s46, s40, 7
    s_sub_u32 s45, s45, s46
    s_add_u32 s45, s45, 3968
    v_lshlrev_b32 v7, 12, v3
    v_lshl_add_u32 v7, v2, 4, v7
    v_add_u32 v7, s45, v7
    v_add_u32 v8, 131072, v7
    s_mov_b32 s47, 1835008
    s_waitcnt lgkmcnt(3)
    buffer_store_dwordx4 v[12:15], v7, s[8:11], 0 offen sc0 sc1
    s_waitcnt lgkmcnt(2)
    buffer_store_dwordx4 v[16:19], v8, s[8:11], 0 offen sc0 sc1
    s_waitcnt lgkmcnt(1)
    buffer_store_dwordx4 v[20:23], v7, s[8:11], s47 offen sc0 sc1
    s_waitcnt lgkmcnt(0)
    buffer_store_dwordx4 v[24:27], v8, s[8:11], s47 offen sc0 sc1
    s_waitcnt vmcnt(12)
    s_mov_b32 s80, 0
NG_1_2:
    v_readfirstlane_b32 s96, v114
    v_readfirstlane_b32 s97, v115
    s_nop 0
    s_cmp_lg_u32 s97, 0
    s_cbranch_scc1 NGD_1_3
    v_mov_b32 v116, 0
    global_load_dwordx2 v[114:115], v116, s[98:99] sc1
    s_waitcnt vmcnt(0)
    s_add_u32 s80, s80, 1
    s_cmp_lt_u32 s80, 20000
    s_cbranch_scc0 NGD_1_3_to
    s_sleep 1
    s_branch NG_1_2
NGD_1_3_to:
    s_or_b32 s39, s39, 1024
NGD_1_3:
    s_lshl_b32 s43, s64, 8
    s_lshl_b32 s44, s65, 3
    s_add_u32 s43, s43, s44
    s_add_u32 s43, s43, 25416704
    s_lshl_b32 s45, s41, 8
    s_lshl_b32 s46, s40, 3
    s_add_u32 s45, s45, s46
    s_add_u32 s45, s45, 25413632
    s_waitcnt vmcnt(0)
    s_barrier
    s_cmp_eq_u32 s36, 0
    s_cbranch_scc0 FL_1_4
    v_mov_b32 v2, s96
    v_mov_b32 v3, s97
    v_mov_b32 v4, s45
    s_mov_b64 s[60:61], exec
    s_mov_b64 exec, 1
    buffer_store_dwordx2 v[2:3], v4, s[8:11], 0 offen sc0 sc1
    s_mov_b64 exec, s[60:61]
FL_1_4:
    s_cmp_eq_u32 s36, 0
    s_cbranch_scc0 FL_1_5
    v_mov_b32 v116, s96
    v_mov_b32 v117, s97
    v_xor_b32 v117, s38, v117
    v_mov_b32 v118, s43
    s_mov_b64 s[60:61], exec
    s_mov_b64 exec, 1
    buffer_store_dwordx2 v[116:117], v118, s[8:11], 0 offen sc0 sc1
    s_mov_b64 exec, s[60:61]
FL_1_5:
    s_lshr_b32 s46, s36, 1
    s_and_b32 s47, s36, 1
    s_lshl_b32 s40, s2, 1
    s_add_u32 s40, s40, s46
    s_lshl_b32 s40, s40, 12
    s_lshl_b32 s43, s47, 11
    s_add_u32 s44, s40, s43
    s_mul_i32 s45, s46, 4608
    s_add_u32 s45, s45, 131840
    s_add_u32 s43, s43, s45
    s_add_u32 m0, s43, 512
    s_nop 0
    buffer_load_dwordx4 v1, s[12:15], s44 offen offset:0 lds
    buffer_load_dwordx4 v1, s[12:15], s44 offen offset:1024 lds
    s_lshl_b32 s43, s2, 2
    s_load_dword s62, s[100:101], s43
    s_lshr_b32 s46, s36, 1
    s_and_b32 s47, s36, 1
    s_lshl_b32 s40, s2, 1
    s_add_u32 s40, s40, s46
    s_lshl_b32 s40, s40, 12
    s_mul_i32 s45, s46, 4608
    s_add_u32 s45, s45, 131840
    s_mul_i32 s42, s36, 4288
    s_add_u32 s42, s42, 114688
    v_mov_b32 v104, 0
    v_mov_b32 v105, 0
    v_mov_b32 v106, 0
    v_mov_b32 v107, 0
    s_add_u32 s43, s42, 4096
    v_add_u32 v108, s43, v1
    s_lshl_b32 s43, s47, 8
    s_add_u32 s43, s43, s45
    s_sub_u32 s43, s43, 128
    v_add_u32 v109, s43, v1
    v_cmp_gt_u32 vcc, 8, v0
    s_nop 1
    v_cndmask_b32 v108, v109, v108, vcc
    v_cmp_gt_u32 vcc, 24, v0
    s_nop 0
    s_and_saveexec_b64 s[60:61], vcc
    ds_write_b128 v108, v[104:107]
    s_mov_b64 exec, s[60:61]
    v_and_b32 v100, 31, v0
    s_lshl_b32 s80, s68, 5
    v_add_u32 v100, s80, v100
    v_mul_u32_u24 v101, 896, v100
    v_lshrrev_b32 v102, 5, v0
    v_lshl_add_u32 v101, v102, 3, v101
    s_lshl_b32 s80, s69, 6
    s_lshl_b32 s81, s5, 5
    s_add_u32 s80, s80, s81
    s_add_u32 s81, s80, 114688
    buffer_load_dwordx2 a[0:1], v101, s[16:19], s80 offen offset:0
    buffer_load_dwordx2 a[2:3], v101, s[16:19], s80 offen offset:16
    buffer_load_dwordx2 a[4:5], v101, s[16:19], s81 offen offset:0
    buffer_load_dwordx2 a[6:7], v101, s[16:19], s81 offen offset:16
    v_and_b32 v184, 7, v0
    v_lshlrev_b32 v184, 7, v184
    v_bfe_u32 v185, v0, 3, 1
    v_mul_u32_u24 v186, 114688, v185
    v_add_u32 v186, v186, v184
    s_add_u32 s80, s3, 5505024
    v_add_u32 v186, s80, v186
    v_and_b32 v185, 3, v0
    v_lshlrev_b32 v185, 7, v185
    v_bfe_u32 v187, v0, 2, 1
    v_mul_u32_u24 v187, 28672, v187
    v_add_u32 v185, v185, v187
    s_add_u32 s80, s4, 23920640
    v_add_u32 v187, s80, v185
    v_cmp_le_u32 vcc, 16, v0
    s_nop 1
    v_cndmask_b32 v186, v186, v187, vcc
    v_add_u32 v187, 917504, v187
    v_cmp_le_u32 vcc, 24, v0
    s_nop 1
    v_cndmask_b32 v186, v186, v187, vcc
    s_mul_i32 s80, s76, 112
    s_add_u32 s80, s80, s63
    s_lshl_b32 s80, s80, 3
    s_add_u32 s80, s80, 25296896
    v_and_b32 v185, 7, v0
    v_mul_u32_u24 v185, 896, v185
    v_add_u32 v185, s80, v185
    v_cmp_le_u32 vcc, 32, v0
    s_nop 1
    v_cndmask_b32 v186, v186, v185, vcc
    s_mov_b64 s[86:87], exec
    s_mov_b32 exec_hi, 0xff
    buffer_load_dword v187, v186, s[8:11], 0 offen sc1
    s_mov_b64 exec, s[86:87]
    s_add_u32 m0, s71, 8192
    s_add_u32 s79, s70, 229376
    buffer_load_dwordx4 v176, s[72:75], s79 offen offset:0 lds
    s_add_u32 m0, s71, 8192
    s_add_u32 s79, s70, 257024
    buffer_load_dwordx4 v176, s[72:75], s79 offen offset:1024 lds
    s_add_u32 m0, s71, 8192
    s_add_u32 s79, s70, 284672
    buffer_load_dwordx4 v176, s[72:75], s79 offen offset:2048 lds
    s_add_u32 m0, s71, 8192
    s_add_u32 s79, s70, 312320
    buffer_load_dwordx4 v176, s[72:75], s79 offen offset:3072 lds
    s_add_u32 m0, s71, 12288
    s_add_u32 s79, s70, 344064
    buffer_load_dwordx4 v176, s[72:75], s79 offen offset:0 lds
    s_add_u32 m0, s71, 12288
    s_add_u32 s79, s70, 371712
    buffer_load_dwordx4 v176, s[72:75], s79 offen offset:1024 lds
    s_lshr_b32 s40, s2, 5
    s_lshl_b32 s40, s40, 8
    s_add_u32 s40, s40, 25413632
    v_and_b32 v2, 31, v0
    v_lshlrev_b32 v2, 3, v2
    v_add_u32 v2, s40, v2
    buffer_load_dwordx2 v[4:5], v2, s[8:11], 0 offen sc1
    s_waitcnt vmcnt(0)
    v_cmp_ne_u64 vcc, s[96:97], v[4:5]
    s_cbranch_vccz FSD_1_7
    s_mov_b32 s80, 0
FS_1_6:
    buffer_load_dwordx2 v[4:5], v2, s[8:11], 0 offen sc1
    s_waitcnt vmcnt(0)
    v_cmp_ne_u64 vcc, s[96:97], v[4:5]
    s_cbranch_vccz FSD_1_7
    s_add_u32 s80, s80, 1
    s_cmp_lt_u32 s80, 20000
    s_cbranch_scc0 FSD_1_7_to
    s_sleep 1
    s_branch FS_1_6
FSD_1_7_to:
    s_or_b32 s39, s39, 512
FSD_1_7:
    s_lshr_b32 s46, s36, 1
    s_and_b32 s47, s36, 1
    s_lshl_b32 s40, s2, 1
    s_add_u32 s40, s40, s46
    s_lshl_b32 s40, s40, 12
    s_mul_i32 s41, s47, 1835008
    s_add_u32 s41, s41, s40
    s_mul_i32 s42, s36, 4288
    s_add_u32 m0, s42, 114688
    s_nop 0
    buffer_load_dwordx4 v1, s[8:11], s41 offen offset:0 lds
    buffer_load_dwordx4 v1, s[8:11], s41 offen offset:1024 lds
    buffer_load_dwordx4 v1, s[8:11], s41 offen offset:2048 lds
    buffer_load_dwordx4 v1, s[8:11], s41 offen offset:3072 lds
    v_and_b32 v3, 15, v0
    v_lshrrev_b32 v4, 4, v0
    v_lshrrev_b32 v5, 1, v4
    v_and_b32 v4, 1, v4
    v_and_b32 v6, 1, v3
    s_mul_i32 s40, s46, 8576
    s_add_u32 s40, s40, 118588
    s_lshl_b32 s41, s47, 8
    s_sub_u32 s40, s40, s41
    v_mul_u32_u24 v7, 4290, v6
    v_add_u32 v7, s40, v7
    v_lshlrev_b32 v6, 1, v3
    v_sub_u32 v7, v7, v6
    v_lshlrev_b32 v6, 5, v5
    v_sub_u32 v7, v7, v6
    v_lshl_add_u32 v8, v4, 4, v7
    v_subrev_u32 v9, 512, v8
    v_subrev_u32 v10, 1024, v8
    v_subrev_u32 v11, 1536, v8
    v_subrev_u32 v12, 2048, v8
    v_subrev_u32 v13, 2560, v8
    v_subrev_u32 v14, 3072, v8
    v_subrev_u32 v15, 3584, v8
    s_mul_i32 s40, s46, 4608
    s_add_u32 s40, s40, 132160
    s_sub_u32 s40, s40, s41
    v_lshlrev_b32 v2, 5, v3
    v_add_u32 v2, s40, v2
    v_sub_u32 v2, v2, v6
    v_lshl_add_u32 v2, v4, 4, v2
    s_waitcnt vmcnt(0) lgkmcnt(0)
    s_barrier
    ds_read_b128 v[80:83], v2 offset:192
    ds_read2_b32 v[48:49], v8 offset0:48 offset1:49
    ds_read2_b32 v[50:51], v8 offset0:50 offset1:51
    ds_read_b128 v[84:87], v2 offset:704
    ds_read2_b32 v[52:53], v9 offset0:48 offset1:49
    ds_read2_b32 v[54:55], v9 offset0:50 offset1:51
    ds_read_b128 v[88:91], v2 offset:1216
    ds_read2_b32 v[56:57], v10 offset0:48 offset1:49
    ds_read2_b32 v[58:59], v10 offset0:50 offset1:51
    ds_read_b128 v[92:95], v2 offset:1728
    ds_read2_b32 v[60:61], v11 offset0:48 offset1:49
    ds_read2_b32 v[62:63], v11 offset0:50 offset1:51
    ds_read_b128 v[96:99], v2 offset:2240
    ds_read2_b32 v[64:65], v12 offset0:48 offset1:49
    ds_read2_b32 v[66:67], v12 offset0:50 offset1:51
    ds_read_b128 v[100:103], v2 offset:2752
    ds_read2_b32 v[68:69], v13 offset0:48 offset1:49
    ds_read2_b32 v[70:71], v13 offset0:50 offset1:51
    ds_read_b128 v[104:107], v2 offset:3264
    ds_read2_b32 v[72:73], v14 offset0:48 offset1:49
    ds_read2_b32 v[74:75], v14 offset0:50 offset1:51
    ds_read_b128 v[108:111], v2 offset:3776
    ds_read2_b32 v[76:77], v15 offset0:48 offset1:49
    ds_read2_b32 v[78:79], v15 offset0:50 offset1:51
    s_waitcnt lgkmcnt(0)
    v_mfma_f32_16x16x32_bf16 v[16:19], v[48:51], v[80:83], 0
    ds_read_b128 v[144:147], v2 offset:128
    v_mfma_f32_16x16x32_bf16 v[20:23], v[48:51], v[84:87], 0
    ds_read2_b32 v[112:113], v8 offset0:32 offset1:33
    s_add_u32 m0, s71, 12288
    s_add_u32 s79, s70, 399360
    buffer_load_dwordx4 v176, s[72:75], s79 offen offset:2048 lds
    v_mfma_f32_16x16x32_bf16 v[24:27], v[48:51], v[88:91], 0
    ds_read2_b32 v[114:115], v8 offset0:34 offset1:35
    v_mfma_f32_16x16x32_bf16 v[28:31], v[48:51], v[92:95], 0
    ds_read_b128 v[148:151], v2 offset:640
    v_mfma_f32_16x16x32_bf16 v[32:35], v[48:51], v[96:99], 0
    ds_read2_b32 v[116:117], v9 offset0:32 offset1:33
    v_mfma_f32_16x16x32_bf16 v[36:39], v[48:51], v[100:103], 0
    ds_read2_b32 v[118:119], v9 offset0:34 offset1:35
    s_add_u32 m0, s71, 12288
    s_add_u32 s79, s70, 427008
    buffer_load_dwordx4 v176, s[72:75], s79 offen offset:3072 lds
    v_mfma_f32_16x16x32_bf16 v[40:43], v[48:51], v[104:107], 0
    ds_read_b128 v[152:155], v2 offset:1152
    v_mfma_f32_16x16x32_bf16 v[44:47], v[48:51], v[108:111], 0
    ds_read2_b32 v[120:121], v10 offset0:32 offset1:33
    v_mfma_f32_16x16x32_bf16 v[20:23], v[52:55], v[80:83], v[20:23]
    ds_read2_b32 v[122:123], v10 offset0:34 offset1:35
    v_mfma_f32_16x16x32_bf16 v[24:27], v[52:55], v[84:87], v[24:27]
    ds_read_b128 v[156:159], v2 offset:1664
    s_add_u32 m0, s71, 16384
    s_add_u32 s79, s70, 458752
    buffer_load_dwordx4 v176, s[72:75], s79 offen offset:0 lds
    v_mfma_f32_16x16x32_bf16 v[28:31], v[52:55], v[88:91], v[28:31]
    ds_read2_b32 v[124:125], v11 offset0:32 offset1:33
    v_mfma_f32_16x16x32_bf16 v[32:35], v[52:55], v[92:95], v[32:35]
    ds_read2_b32 v[126:127], v11 offset0:34 offset1:35
    v_mfma_f32_16x16x32_bf16 v[36:39], v[52:55], v[96:99], v[36:39]
    ds_read_b128 v[160:163], v2 offset:2176
    v_mfma_f32_16x16x32_bf16 v[40:43], v[52:55], v[100:103], v[40:43]
    ds_read2_b32 v[128:129], v12 offset0:32 offset1:33
    s_add_u32 m0, s71, 16384
    s_add_u32 s79, s70, 486400
    buffer_load_dwordx4 v176, s[72:75], s79 offen offset:1024 lds
    v_mfma_f32_16x16x32_bf16 v[44:47], v[52:55], v[104:107], v[44:47]
    ds_read2_b32 v[130:131], v12 offset0:34 offset1:35
    v_mfma_f32_16x16x32_bf16 v[24:27], v[56:59], v[80:83], v[24:27]
    ds_read_b128 v[164:167], v2 offset:2688
    v_mfma_f32_16x16x32_bf16 v[28:31], v[56:59], v[84:87], v[28:31]
    ds_read2_b32 v[132:133], v13 offset0:32 offset1:33
    v_mfma_f32_16x16x32_bf16 v[32:35], v[56:59], v[88:91], v[32:35]
    ds_read2_b32 v[134:135], v13 offset0:34 offset1:35
    s_add_u32 m0, s71, 16384
    s_add_u32 s79, s70, 514048
    buffer_load_dwordx4 v176, s[72:75], s79 offen offset:2048 lds
    v_mfma_f32_16x16x32_bf16 v[36:39], v[56:59], v[92:95], v[36:39]
    ds_read_b128 v[168:171], v2 offset:3200
    v_mfma_f32_16x16x32_bf16 v[40:43], v[56:59], v[96:99], v[40:43]
    ds_read2_b32 v[136:137], v14 offset0:32 offset1:33
    v_mfma_f32_16x16x32_bf16 v[44:47], v[56:59], v[100:103], v[44:47]
    ds_read2_b32 v[138:139], v14 offset0:34 offset1:35
    v_mfma_f32_16x16x32_bf16 v[28:31], v[60:63], v[80:83], v[28:31]
    ds_read_b128 v[172:175], v2 offset:3712
    s_add_u32 m0, s71, 16384
    s_add_u32 s79, s70, 541696
    buffer_load_dwordx4 v176, s[72:75], s79 offen offset:3072 lds
    v_mfma_f32_16x16x32_bf16 v[32:35], v[60:63], v[84:87], v[32:35]
    ds_read2_b32 v[140:141], v15 offset0:32 offset1:33
    v_mfma_f32_16x16x32_bf16 v[36:39], v[60:63], v[88:91], v[36:39]
    ds_read2_b32 v[142:143], v15 offset0:34 offset1:35
    v_mfma_f32_16x16x32_bf16 v[40:43], v[60:63], v[92:95], v[40:43]
    v_mfma_f32_16x16x32_bf16 v[44:47], v[60:63], v[96:99], v[44:47]
    s_add_u32 m0, s71, 20480
    s_add_u32 s79, s70, 573440
    buffer_load_dwordx4 v176, s[72:75], s79 offen offset:0 lds
    v_mfma_f32_16x16x32_bf16 v[32:35], v[64:67], v[80:83], v[32:35]
    v_mfma_f32_16x16x32_bf16 v[36:39], v[64:67], v[84:87], v[36:39]
    v_mfma_f32_16x16x32_bf16 v[40:43], v[64:67], v[88:91], v[40:43]
    v_mfma_f32_16x16x32_bf16 v[44:47], v[64:67], v[92:95], v[44:47]
    s_add_u32 m0, s71, 20480
    s_add_u32 s79, s70, 601088
    buffer_load_dwordx4 v176, s[72:75], s79 offen offset:1024 lds
    v_mfma_f32_16x16x32_bf16 v[36:39], v[68:71], v[80:83], v[36:39]
    v_mfma_f32_16x16x32_bf16 v[40:43], v[68:71], v[84:87], v[40:43]
    v_mfma_f32_16x16x32_bf16 v[44:47], v[68:71], v[88:91], v[44:47]
    v_mfma_f32_16x16x32_bf16 v[40:43], v[72:75], v[80:83], v[40:43]
    s_add_u32 m0, s71, 20480
    s_add_u32 s79, s70, 628736
    buffer_load_dwordx4 v176, s[72:75], s79 offen offset:2048 lds
    v_mfma_f32_16x16x32_bf16 v[44:47], v[72:75], v[84:87], v[44:47]
    v_mfma_f32_16x16x32_bf16 v[44:47], v[76:79], v[80:83], v[44:47]
    s_waitcnt lgkmcnt(0)
    v_mfma_f32_16x16x32_bf16 v[16:19], v[112:115], v[144:147], v[16:19]
    ds_read_b128 v[80:83], v2 offset:64
    v_mfma_f32_16x16x32_bf16 v[20:23], v[112:115], v[148:151], v[20:23]
    ds_read2_b32 v[48:49], v8 offset0:16 offset1:17
    s_add_u32 m0, s71, 20480
    s_add_u32 s79, s70, 656384
    buffer_load_dwordx4 v176, s[72:75], s79 offen offset:3072 lds
    v_mfma_f32_16x16x32_bf16 v[24:27], v[112:115], v[152:155], v[24:27]
    ds_read2_b32 v[50:51], v8 offset0:18 offset1:19
    v_mfma_f32_16x16x32_bf16 v[28:31], v[112:115], v[156:159], v[28:31]
    ds_read_b128 v[84:87], v2 offset:576
    v_mfma_f32_16x16x32_bf16 v[32:35], v[112:115], v[160:163], v[32:35]
    ds_read2_b32 v[52:53], v9 offset0:16 offset1:17
    v_mfma_f32_16x16x32_bf16 v[36:39], v[112:115], v[164:167], v[36:39]
    ds_read2_b32 v[54:55], v9 offset0:18 offset1:19
    s_add_u32 m0, s71, 24576
    s_add_u32 s79, s70, 688128
    buffer_load_dwordx4 v176, s[72:75], s79 offen offset:0 lds
    v_mfma_f32_16x16x32_bf16 v[40:43], v[112:115], v[168:171], v[40:43]
    ds_read_b128 v[88:91], v2 offset:1088
    v_mfma_f32_16x16x32_bf16 v[44:47], v[112:115], v[172:175], v[44:47]
    ds_read2_b32 v[56:57], v10 offset0:16 offset1:17
    v_mfma_f32_16x16x32_bf16 v[20:23], v[116:119], v[144:147], v[20:23]
    ds_read2_b32 v[58:59], v10 offset0:18 offset1:19
    v_mfma_f32_16x16x32_bf16 v[24:27], v[116:119], v[148:151], v[24:27]
    ds_read_b128 v[92:95], v2 offset:1600
    s_add_u32 m0, s71, 24576
    s_add_u32 s79, s70, 715776
    buffer_load_dwordx4 v176, s[72:75], s79 offen offset:1024 lds
    v_mfma_f32_16x16x32_bf16 v[28:31], v[116:119], v[152:155], v[28:31]
    ds_read2_b32 v[60:61], v11 offset0:16 offset1:17
    v_mfma_f32_16x16x32_bf16 v[32:35], v[116:119], v[156:159], v[32:35]
    ds_read2_b32 v[62:63], v11 offset0:18 offset1:19
    v_mfma_f32_16x16x32_bf16 v[36:39], v[116:119], v[160:163], v[36:39]
    ds_read_b128 v[96:99], v2 offset:2112
    v_mfma_f32_16x16x32_bf16 v[40:43], v[116:119], v[164:167], v[40:43]
    ds_read2_b32 v[64:65], v12 offset0:16 offset1:17
    s_add_u32 m0, s71, 24576
    s_add_u32 s79, s70, 743424
    buffer_load_dwordx4 v176, s[72:75], s79 offen offset:2048 lds
    v_mfma_f32_16x16x32_bf16 v[44:47], v[116:119], v[168:171], v[44:47]
    ds_read2_b32 v[66:67], v12 offset0:18 offset1:19
    v_mfma_f32_16x16x32_bf16 v[24:27], v[120:123], v[144:147], v[24:27]
    ds_read_b128 v[100:103], v2 offset:2624
    v_mfma_f32_16x16x32_bf16 v[28:31], v[120:123], v[148:151], v[28:31]
    ds_read2_b32 v[68:69], v13 offset0:16 offset1:17
    v_mfma_f32_16x16x32_bf16 v[32:35], v[120:123], v[152:155], v[32:35]
    ds_read2_b32 v[70:71], v13 offset0:18 offset1:19
    s_add_u32 m0, s71, 24576
    s_add_u32 s79, s70, 771072
    buffer_load_dwordx4 v176, s[72:75], s79 offen offset:3072 lds
    v_mfma_f32_16x16x32_bf16 v[36:39], v[120:123], v[156:159], v[36:39]
    ds_read_b128 v[104:107], v2 offset:3136
    v_mfma_f32_16x16x32_bf16 v[40:43], v[120:123], v[160:163], v[40:43]
    ds_read2_b32 v[72:73], v14 offset0:16 offset1:17
    v_mfma_f32_16x16x32_bf16 v[44:47], v[120:123], v[164:167], v[44:47]
    ds_read2_b32 v[74:75], v14 offset0:18 offset1:19
    v_mfma_f32_16x16x32_bf16 v[28:31], v[124:127], v[144:147], v[28:31]
    ds_read_b128 v[108:111], v2 offset:3648
    v_mfma_f32_16x16x32_bf16 v[32:35], v[124:127], v[148:151], v[32:35]
    ds_read2_b32 v[76:77], v15 offset0:16 offset1:17
    v_mfma_f32_16x16x32_bf16 v[36:39], v[124:127], v[152:155], v[36:39]
    ds_read2_b32 v[78:79], v15 offset0:18 offset1:19
    v_mfma_f32_16x16x32_bf16 v[40:43], v[124:127], v[156:159], v[40:43]
    v_mfma_f32_16x16x32_bf16 v[44:47], v[124:127], v[160:163], v[44:47]
    v_mfma_f32_16x16x32_bf16 v[32:35], v[128:131], v[144:147], v[32:35]
    v_mfma_f32_16x16x32_bf16 v[36:39], v[128:131], v[148:151], v[36:39]
    v_mfma_f32_16x16x32_bf16 v[40:43], v[128:131], v[152:155], v[40:43]
    v_mfma_f32_16x16x32_bf16 v[44:47], v[128:131], v[156:159], v[44:47]
    v_mfma_f32_16x16x32_bf16 v[36:39], v[132:135], v[144:147], v[36:39]
    v_mfma_f32_16x16x32_bf16 v[40:43], v[132:135], v[148:151], v[40:43]
    v_mfma_f32_16x16x32_bf16 v[44:47], v[132:135], v[152:155], v[44:47]
    v_mfma_f32_16x16x32_bf16 v[40:43], v[136:139], v[144:147], v[40:43]
    v_mfma_f32_16x16x32_bf16 v[44:47], v[136:139], v[148:151], v[44:47]
    v_mfma_f32_16x16x32_bf16 v[44:47], v[140:143], v[144:147], v[44:47]
    s_waitcnt lgkmcnt(0)
    v_mfma_f32_16x16x32_bf16 v[16:19], v[48:51], v[80:83], v[16:19]
    ds_read_b128 v[144:147], v2 offset:0
    v_mfma_f32_16x16x32_bf16 v[20:23], v[48:51], v[84:87], v[20:23]
    ds_read2_b32 v[112:113], v8 offset0:0 offset1:1
    v_mfma_f32_16x16x32_bf16 v[24:27], v[48:51], v[88:91], v[24:27]
    ds_read2_b32 v[114:115], v8 offset0:2 offset1:3
    v_mfma_f32_16x16x32_bf16 v[28:31], v[48:51], v[92:95], v[28:31]
    ds_read_b128 v[148:151], v2 offset:512
    v_mfma_f32_16x16x32_bf16 v[32:35], v[48:51], v[96:99], v[32:35]
    ds_read2_b32 v[116:117], v9 offset0:0 offset1:1
    v_mfma_f32_16x16x32_bf16 v[36:39], v[48:51], v[100:103], v[36:39]
    ds_read2_b32 v[118:119], v9 offset0:2 offset1:3
    v_mfma_f32_16x16x32_bf16 v[40:43], v[48:51], v[104:107], v[40:43]
    ds_read_b128 v[152:155], v2 offset:1024
    v_mfma_f32_16x16x32_bf16 v[44:47], v[48:51], v[108:111], v[44:47]
    ds_read2_b32 v[120:121], v10 offset0:0 offset1:1
    v_mfma_f32_16x16x32_bf16 v[20:23], v[52:55], v[80:83], v[20:23]
    ds_read2_b32 v[122:123], v10 offset0:2 offset1:3
    v_mfma_f32_16x16x32_bf16 v[24:27], v[52:55], v[84:87], v[24:27]
    ds_read_b128 v[156:159], v2 offset:1536
    v_mfma_f32_16x16x32_bf16 v[28:31], v[52:55], v[88:91], v[28:31]
    ds_read2_b32 v[124:125], v11 offset0:0 offset1:1
    v_mfma_f32_16x16x32_bf16 v[32:35], v[52:55], v[92:95], v[32:35]
    ds_read2_b32 v[126:127], v11 offset0:2 offset1:3
    v_mfma_f32_16x16x32_bf16 v[36:39], v[52:55], v[96:99], v[36:39]
    ds_read_b128 v[160:163], v2 offset:2048
    v_mfma_f32_16x16x32_bf16 v[40:43], v[52:55], v[100:103], v[40:43]
    ds_read2_b32 v[128:129], v12 offset0:0 offset1:1
    v_mfma_f32_16x16x32_bf16 v[44:47], v[52:55], v[104:107], v[44:47]
    ds_read2_b32 v[130:131], v12 offset0:2 offset1:3
    v_mfma_f32_16x16x32_bf16 v[24:27], v[56:59], v[80:83], v[24:27]
    ds_read_b128 v[164:167], v2 offset:2560
    v_mfma_f32_16x16x32_bf16 v[28:31], v[56:59], v[84:87], v[28:31]
    ds_read2_b32 v[132:133], v13 offset0:0 offset1:1
    v_mfma_f32_16x16x32_bf16 v[32:35], v[56:59], v[88:91], v[32:35]
    ds_read2_b32 v[134:135], v13 offset0:2 offset1:3
    v_mfma_f32_16x16x32_bf16 v[36:39], v[56:59], v[92:95], v[36:39]
    ds_read_b128 v[168:171], v2 offset:3072
    v_mfma_f32_16x16x32_bf16 v[40:43], v[56:59], v[96:99], v[40:43]
    ds_read2_b32 v[136:137], v14 offset0:0 offset1:1
    v_mfma_f32_16x16x32_bf16 v[44:47], v[56:59], v[100:103], v[44:47]
    ds_read2_b32 v[138:139], v14 offset0:2 offset1:3
    v_mfma_f32_16x16x32_bf16 v[28:31], v[60:63], v[80:83], v[28:31]
    ds_read_b128 v[172:175], v2 offset:3584
    v_mfma_f32_16x16x32_bf16 v[32:35], v[60:63], v[84:87], v[32:35]
    ds_read2_b32 v[140:141], v15 offset0:0 offset1:1
    v_mfma_f32_16x16x32_bf16 v[36:39], v[60:63], v[88:91], v[36:39]
    ds_read2_b32 v[142:143], v15 offset0:2 offset1:3
    v_mfma_f32_16x16x32_bf16 v[40:43], v[60:63], v[92:95], v[40:43]
    v_mfma_f32_16x16x32_bf16 v[44:47], v[60:63], v[96:99], v[44:47]
    v_mfma_f32_16x16x32_bf16 v[32:35], v[64:67], v[80:83], v[32:35]
    v_mfma_f32_16x16x32_bf16 v[36:39], v[64:67], v[84:87], v[36:39]
    v_mfma_f32_16x16x32_bf16 v[40:43], v[64:67], v[88:91], v[40:43]
    v_mfma_f32_16x16x32_bf16 v[44:47], v[64:67], v[92:95], v[44:47]
    v_mfma_f32_16x16x32_bf16 v[36:39], v[68:71], v[80:83], v[36:39]
    v_mfma_f32_16x16x32_bf16 v[40:43], v[68:71], v[84:87], v[40:43]
    v_mfma_f32_16x16x32_bf16 v[44:47], v[68:71], v[88:91], v[44:47]
    v_mfma_f32_16x16x32_bf16 v[40:43], v[72:75], v[80:83], v[40:43]
    v_mfma_f32_16x16x32_bf16 v[44:47], v[72:75], v[84:87], v[44:47]
    v_mfma_f32_16x16x32_bf16 v[44:47], v[76:79], v[80:83], v[44:47]
    s_waitcnt lgkmcnt(0)
    v_mfma_f32_16x16x32_bf16 v[16:19], v[112:115], v[144:147], v[16:19]
    v_mfma_f32_16x16x32_bf16 v[20:23], v[112:115], v[148:151], v[20:23]
    v_mfma_f32_16x16x32_bf16 v[24:27], v[112:115], v[152:155], v[24:27]
    v_mfma_f32_16x16x32_bf16 v[28:31], v[112:115], v[156:159], v[28:31]
    v_mfma_f32_16x16x32_bf16 v[32:35], v[112:115], v[160:163], v[32:35]
    v_mfma_f32_16x16x32_bf16 v[36:39], v[112:115], v[164:167], v[36:39]
    v_mfma_f32_16x16x32_bf16 v[40:43], v[112:115], v[168:171], v[40:43]
    v_mfma_f32_16x16x32_bf16 v[44:47], v[112:115], v[172:175], v[44:47]
    v_mfma_f32_16x16x32_bf16 v[20:23], v[116:119], v[144:147], v[20:23]
    v_mfma_f32_16x16x32_bf16 v[24:27], v[116:119], v[148:151], v[24:27]
    v_mfma_f32_16x16x32_bf16 v[28:31], v[116:119], v[152:155], v[28:31]
    v_mfma_f32_16x16x32_bf16 v[32:35], v[116:119], v[156:159], v[32:35]
    v_mfma_f32_16x16x32_bf16 v[36:39], v[116:119], v[160:163], v[36:39]
    v_mfma_f32_16x16x32_bf16 v[40:43], v[116:119], v[164:167], v[40:43]
    v_mfma_f32_16x16x32_bf16 v[44:47], v[116:119], v[168:171], v[44:47]
    v_mfma_f32_16x16x32_bf16 v[24:27], v[120:123], v[144:147], v[24:27]
    v_mfma_f32_16x16x32_bf16 v[28:31], v[120:123], v[148:151], v[28:31]
    v_mfma_f32_16x16x32_bf16 v[32:35], v[120:123], v[152:155], v[32:35]
    v_mfma_f32_16x16x32_bf16 v[36:39], v[120:123], v[156:159], v[36:39]
    v_mfma_f32_16x16x32_bf16 v[40:43], v[120:123], v[160:163], v[40:43]
    v_mfma_f32_16x16x32_bf16 v[44:47], v[120:123], v[164:167], v[44:47]
    v_mfma_f32_16x16x32_bf16 v[28:31], v[124:127], v[144:147], v[28:31]
    v_mfma_f32_16x16x32_bf16 v[32:35], v[124:127], v[148:151], v[32:35]
    v_mfma_f32_16x16x32_bf16 v[36:39], v[124:127], v[152:155], v[36:39]
    v_mfma_f32_16x16x32_bf16 v[40:43], v[124:127], v[156:159], v[40:43]
    v_mfma_f32_16x16x32_bf16 v[44:47], v[124:127], v[160:163], v[44:47]
    v_mfma_f32_16x16x32_bf16 v[32:35], v[128:131], v[144:147], v[32:35]
    v_mfma_f32_16x16x32_bf16 v[36:39], v[128:131], v[148:151], v[36:39]
    v_mfma_f32_16x16x32_bf16 v[40:43], v[128:131], v[152:155], v[40:43]
    v_mfma_f32_16x16x32_bf16 v[44:47], v[128:131], v[156:159], v[44:47]
    v_mfma_f32_16x16x32_bf16 v[36:39], v[132:135], v[144:147], v[36:39]
    v_mfma_f32_16x16x32_bf16 v[40:43], v[132:135], v[148:151], v[40:43]
    v_mfma_f32_16x16x32_bf16 v[44:47], v[132:135], v[152:155], v[44:47]
    v_mfma_f32_16x16x32_bf16 v[40:43], v[136:139], v[144:147], v[40:43]
    v_mfma_f32_16x16x32_bf16 v[44:47], v[136:139], v[148:151], v[44:47]
    v_mfma_f32_16x16x32_bf16 v[44:47], v[140:143], v[144:147], v[44:47]
    s_lshl_b32 s40, s36, 12
    s_add_u32 s40, s40, 141056
    v_add_u32 v3, s40, v1
    s_xor_b32 s41, s36, 1
    s_lshl_b32 s41, s41, 12
    s_add_u32 s41, s41, 141056
    v_add_u32 v4, s41, v1
    v_and_b32 v5, 15, v0
    v_lshrrev_b32 v6, 4, v0
    v_lshlrev_b32 v7, 5, v5
    v_lshl_add_u32 v7, v6, 3, v7
    s_mul_i32 s40, s46, 8576
    s_add_u32 s40, s40, 121528
    s_lshl_b32 s41, s47, 11
    s_sub_u32 s40, s40, s41
    v_sub_u32 v8, s40, v7
    s_lshl_b32 s40, s2, 1
    s_add_u32 s40, s40, s46
    s_lshl_b32 s40, s40, 12
    s_add_u32 s40, s40, s41
    s_add_u32 s40, s40, 3670016
    v_add_u32 v9, s40, v7
    s_lshl_b32 s40, s62, 16
    s_and_b32 s41, s62, s77
    s_cmp_eq_u32 s46, 0
    s_cselect_b32 s62, s40, s41
    ds_read_b64 v[56:57], v8 offset:1536
    ds_read_b64 v[58:59], v8 offset:1024
    ds_read_b64 v[60:61], v8 offset:512
    ds_read_b64 v[62:63], v8 offset:0
    s_cmp_eq_u32 s47, 0
    s_cbranch_scc0 CV_1_8
    ds_write_b128 v3, v[32:35] offset:0
    ds_write_b128 v3, v[36:39] offset:1024
    ds_write_b128 v3, v[40:43] offset:2048
    ds_write_b128 v3, v[44:47] offset:3072
    s_waitcnt lgkmcnt(0)
    s_barrier
    ds_read_b128 v[64:67], v4 offset:0
    ds_read_b128 v[68:71], v4 offset:1024
    ds_read_b128 v[72:75], v4 offset:2048
    ds_read_b128 v[76:79], v4 offset:3072
    s_waitcnt lgkmcnt(0)
    v_and_b32 v80, s77, v57
    v_lshlrev_b32 v81, 16, v57
    v_and_b32 v82, s77, v56
    v_lshlrev_b32 v83, 16, v56
    v_add_f32 v16, v16, v64
    v_fmac_f32 v16, s62, v80
    v_add_f32 v17, v17, v65
    v_fmac_f32 v17, s62, v81
    v_add_f32 v18, v18, v66
    v_fmac_f32 v18, s62, v82
    v_add_f32 v19, v19, v67
    v_fmac_f32 v19, s62, v83
    v_cvt_pk_bf16_f32 v84, v16, v17
    v_cvt_pk_bf16_f32 v85, v18, v19
    buffer_store_dwordx2 v[84:85], v9, s[8:11], 0 offen offset:0 sc0 sc1
    v_and_b32 v80, s77, v59
    v_lshlrev_b32 v81, 16, v59
    v_and_b32 v82, s77, v58
    v_lshlrev_b32 v83, 16, v58
    v_add_f32 v20, v20, v68
    v_fmac_f32 v20, s62, v80
    v_add_f32 v21, v21, v69
    v_fmac_f32 v21, s62, v81
    v_add_f32 v22, v22, v70
    v_fmac_f32 v22, s62, v82
    v_add_f32 v23, v23, v71
    v_fmac_f32 v23, s62, v83
    v_cvt_pk_bf16_f32 v86, v20, v21
    v_cvt_pk_bf16_f32 v87, v22, v23
    buffer_store_dwordx2 v[86:87], v9, s[8:11], 0 offen offset:512 sc0 sc1
    v_and_b32 v80, s77, v61
    v_lshlrev_b32 v81, 16, v61
    v_and_b32 v82, s77, v60
    v_lshlrev_b32 v83, 16, v60
    v_add_f32 v24, v24, v72
    v_fmac_f32 v24, s62, v80
    v_add_f32 v25, v25, v73
    v_fmac_f32 v25, s62, v81
    v_add_f32 v26, v26, v74
    v_fmac_f32 v26, s62, v82
    v_add_f32 v27, v27, v75
    v_fmac_f32 v27, s62, v83
    v_cvt_pk_bf16_f32 v88, v24, v25
    v_cvt_pk_bf16_f32 v89, v26, v27
    buffer_store_dwordx2 v[88:89], v9, s[8:11], 0 offen offset:1024 sc0 sc1
    v_and_b32 v80, s77, v63
    v_lshlrev_b32 v81, 16, v63
    v_and_b32 v82, s77, v62
    v_lshlrev_b32 v83, 16, v62
    v_add_f32 v28, v28, v76
    v_fmac_f32 v28, s62, v80
    v_add_f32 v29, v29, v77
    v_fmac_f32 v29, s62, v81
    v_add_f32 v30, v30, v78
    v_fmac_f32 v30, s62, v82
    v_add_f32 v31, v31, v79
    v_fmac_f32 v31, s62, v83
    v_cvt_pk_bf16_f32 v90, v28, v29
    v_cvt_pk_bf16_f32 v91, v30, v31
    buffer_store_dwordx2 v[90:91], v9, s[8:11], 0 offen offset:1536 sc0 sc1
    s_branch CV_1_9
CV_1_8:
    ds_write_b128 v3, v[16:19] offset:0
    ds_write_b128 v3, v[20:23] offset:1024
    ds_write_b128 v3, v[24:27] offset:2048
    ds_write_b128 v3, v[28:31] offset:3072
    s_waitcnt lgkmcnt(0)
    s_barrier
    ds_read_b128 v[64:67], v4 offset:0
    ds_read_b128 v[68:71], v4 offset:1024
    ds_read_b128 v[72:75], v4 offset:2048
    ds_read_b128 v[76:79], v4 offset:3072
    s_waitcnt lgkmcnt(0)
    v_and_b32 v80, s77, v57
    v_lshlrev_b32 v81, 16, v57
    v_and_b32 v82, s77, v56
    v_lshlrev_b32 v83, 16, v56
    v_add_f32 v32, v32, v64
    v_fmac_f32 v32, s62, v80
    v_add_f32 v33, v33, v65
    v_fmac_f32 v33, s62, v81
    v_add_f32 v34, v34, v66
    v_fmac_f32 v34, s62, v82
    v_add_f32 v35, v35, v67
    v_fmac_f32 v35, s62, v83
    v_cvt_pk_bf16_f32 v84, v32, v33
    v_cvt_pk_bf16_f32 v85, v34, v35
    buffer_store_dwordx2 v[84:85], v9, s[8:11], 0 offen offset:0 sc0 sc1
    v_and_b32 v80, s77, v59
    v_lshlrev_b32 v81, 16, v59
    v_and_b32 v82, s77, v58
    v_lshlrev_b32 v83, 16, v58
    v_add_f32 v36, v36, v68
    v_fmac_f32 v36, s62, v80
    v_add_f32 v37, v37, v69
    v_fmac_f32 v37, s62, v81
    v_add_f32 v38, v38, v70
    v_fmac_f32 v38, s62, v82
    v_add_f32 v39, v39, v71
    v_fmac_f32 v39, s62, v83
    v_cvt_pk_bf16_f32 v86, v36, v37
    v_cvt_pk_bf16_f32 v87, v38, v39
    buffer_store_dwordx2 v[86:87], v9, s[8:11], 0 offen offset:512 sc0 sc1
    v_and_b32 v80, s77, v61
    v_lshlrev_b32 v81, 16, v61
    v_and_b32 v82, s77, v60
    v_lshlrev_b32 v83, 16, v60
    v_add_f32 v40, v40, v72
    v_fmac_f32 v40, s62, v80
    v_add_f32 v41, v41, v73
    v_fmac_f32 v41, s62, v81
    v_add_f32 v42, v42, v74
    v_fmac_f32 v42, s62, v82
    v_add_f32 v43, v43, v75
    v_fmac_f32 v43, s62, v83
    v_cvt_pk_bf16_f32 v88, v40, v41
    v_cvt_pk_bf16_f32 v89, v42, v43
    buffer_store_dwordx2 v[88:89], v9, s[8:11], 0 offen offset:1024 sc0 sc1
    v_and_b32 v80, s77, v63
    v_lshlrev_b32 v81, 16, v63
    v_and_b32 v82, s77, v62
    v_lshlrev_b32 v83, 16, v62
    v_add_f32 v44, v44, v76
    v_fmac_f32 v44, s62, v80
    v_add_f32 v45, v45, v77
    v_fmac_f32 v45, s62, v81
    v_add_f32 v46, v46, v78
    v_fmac_f32 v46, s62, v82
    v_add_f32 v47, v47, v79
    v_fmac_f32 v47, s62, v83
    v_cvt_pk_bf16_f32 v90, v44, v45
    v_cvt_pk_bf16_f32 v91, v46, v47
    buffer_store_dwordx2 v[90:91], v9, s[8:11], 0 offen offset:1536 sc0 sc1
CV_1_9:
    s_waitcnt vmcnt(0)
    s_barrier
    s_lshl_b32 s40, s2, 3
    s_add_u32 s40, s40, 25411584
    s_cmp_eq_u32 s36, 0
    s_cbranch_scc0 FL_1_10
    v_mov_b32 v2, s96
    v_mov_b32 v3, s97
    v_mov_b32 v4, s40
    s_mov_b64 s[60:61], exec
    s_mov_b64 exec, 1
    buffer_store_dwordx2 v[2:3], v4, s[8:11], 0 offen sc0 sc1
    s_mov_b64 exec, s[60:61]
FL_1_10:
    v_mov_b32 v10, s96
    v_mov_b32 v11, s97
    v_accvgpr_read_b32 v152, a0
    v_accvgpr_read_b32 v153, a1
    v_accvgpr_read_b32 v154, a2
    v_accvgpr_read_b32 v155, a3
    v_accvgpr_read_b32 v156, a4
    v_accvgpr_read_b32 v157, a5
    v_accvgpr_read_b32 v158, a6
    v_accvgpr_read_b32 v159, a7
    v_and_b32 v128, 31, v0
    s_lshl_b32 s80, s68, 5
    v_add_u32 v130, s80, v128
    v_lshrrev_b32 v129, 5, v0
    v_lshlrev_b32 v5, 1, v130
    v_lshl_add_u32 v5, v129, 14, v5
    v_lshlrev_b32 v168, 3, v130
    s_lshl_b32 s80, s69, 7
    s_lshl_b32 s81, s5, 6
    s_add_u32 s80, s80, s81
    s_add_u32 s80, s80, 25411584
    v_lshlrev_b32 v169, 3, v0
    v_add_u32 v169, s80, v169
    s_lshr_b32 s80, s68, 1
    s_lshl_b32 s80, s80, 3
    s_add_u32 s80, s80, 25415680
    v_mov_b32 v131, s80
    v_cmp_gt_u32 vcc, 8, v0
    s_nop 1
    v_cndmask_b32 v169, v131, v169, vcc
    v_add_u32 v131, 16, v131
    v_cmp_lt_u32 vcc, 8, v0
    s_nop 1
    v_cndmask_b32 v169, v169, v131, vcc
    v_lshrrev_b32 v128, 5, v0
    v_lshrrev_b32 v129, 4, v0
    v_and_b32 v129, 1, v129
    v_lshrrev_b32 v130, 2, v0
    v_and_b32 v130, 3, v130
    v_and_b32 v131, 3, v0
    v_lshrrev_b32 v132, 1, v131
    s_and_b32 s80, s36, 1
    s_lshl_b32 s80, s80, 1
    v_add_u32 v132, s80, v132
    v_lshlrev_b32 v133, 1, v129
    v_xor_b32 v132, v132, v133
    v_lshl_add_u32 v132, v130, 2, v132
    s_lshr_b32 s80, s36, 1
    s_lshl_b32 s80, s80, 1
    v_add_u32 v133, s80, v128
    v_lshl_add_u32 v132, v133, 4, v132
    v_lshlrev_b32 v132, 4, v132
    v_and_b32 v133, 1, v131
    v_lshl_add_u32 v132, v133, 3, v132
    v_mul_u32_u24 v133, 57344, v129
    v_add_u32 v3, v132, v133
    ds_read_b64_tr_b16 a[224:225], v3 offset:0
    ds_read_b64_tr_b16 a[226:227], v3 offset:1024
    ds_read_b64_tr_b16 a[228:229], v3 offset:2048
    ds_read_b64_tr_b16 a[230:231], v3 offset:3072
    ds_read_b64_tr_b16 a[232:233], v3 offset:4096
    ds_read_b64_tr_b16 a[234:235], v3 offset:5120
    ds_read_b64_tr_b16 a[236:237], v3 offset:6144
    ds_read_b64_tr_b16 a[238:239], v3 offset:7168
    ds_read_b64_tr_b16 a[240:241], v3 offset:8192
    ds_read_b64_tr_b16 a[242:243], v3 offset:9216
    ds_read_b64_tr_b16 a[244:245], v3 offset:10240
    ds_read_b64_tr_b16 a[246:247], v3 offset:11264
    ds_read_b64_tr_b16 a[248:249], v3 offset:12288
    ds_read_b64_tr_b16 a[250:251], v3 offset:13312
    s_waitcnt lgkmcnt(0)
    ds_read_b64_tr_b16 a[252:253], v3 offset:14336
    ds_read_b64_tr_b16 a[254:255], v3 offset:15360
    ds_read_b64_tr_b16 v[176:177], v3 offset:16384
    ds_read_b64_tr_b16 v[178:179], v3 offset:17408
    ds_read_b64_tr_b16 v[180:181], v3 offset:18432
    ds_read_b64_tr_b16 v[182:183], v3 offset:19456
    ds_read_b64_tr_b16 v[184:185], v3 offset:20480
    ds_read_b64_tr_b16 v[186:187], v3 offset:21504
    ds_read_b64_tr_b16 v[188:189], v3 offset:22528
    ds_read_b64_tr_b16 v[190:191], v3 offset:23552
    ds_read_b64_tr_b16 v[192:193], v3 offset:24576
    ds_read_b64_tr_b16 v[194:195], v3 offset:25600
    ds_read_b64_tr_b16 v[196:197], v3 offset:26624
    ds_read_b64_tr_b16 v[198:199], v3 offset:27648
    s_waitcnt lgkmcnt(0)
    ds_read_b64_tr_b16 v[200:201], v3 offset:28672
    ds_read_b64_tr_b16 v[202:203], v3 offset:29696
    ds_read_b64_tr_b16 v[204:205], v3 offset:30720
    ds_read_b64_tr_b16 v[206:207], v3 offset:31744
    ds_read_b64_tr_b16 v[208:209], v3 offset:32768
    ds_read_b64_tr_b16 v[210:211], v3 offset:33792
    ds_read_b64_tr_b16 v[212:213], v3 offset:34816
    ds_read_b64_tr_b16 v[214:215], v3 offset:35840
    ds_read_b64_tr_b16 v[216:217], v3 offset:36864
    ds_read_b64_tr_b16 v[218:219], v3 offset:37888
    ds_read_b64_tr_b16 v[220:221], v3 offset:38912
    ds_read_b64_tr_b16 v[222:223], v3 offset:39936
    ds_read_b64_tr_b16 v[224:225], v3 offset:40960
    ds_read_b64_tr_b16 v[226:227], v3 offset:41984
    s_waitcnt lgkmcnt(0)
    ds_read_b64_tr_b16 v[228:229], v3 offset:43008
    ds_read_b64_tr_b16 v[230:231], v3 offset:44032
    ds_read_b64_tr_b16 v[232:233], v3 offset:45056
    ds_read_b64_tr_b16 v[234:235], v3 offset:46080
    ds_read_b64_tr_b16 v[236:237], v3 offset:47104
    ds_read_b64_tr_b16 v[238:239], v3 offset:48128
    ds_read_b64_tr_b16 v[240:241], v3 offset:49152
    ds_read_b64_tr_b16 v[242:243], v3 offset:50176
    ds_read_b64_tr_b16 v[244:245], v3 offset:51200
    ds_read_b64_tr_b16 v[246:247], v3 offset:52224
    ds_read_b64_tr_b16 v[248:249], v3 offset:53248
    ds_read_b64_tr_b16 v[250:251], v3 offset:54272
    ds_read_b64_tr_b16 v[252:253], v3 offset:55296
    ds_read_b64_tr_b16 v[254:255], v3 offset:56320
    s_waitcnt lgkmcnt(0)
    v_mov_b32 v136, 0x3f803f80
    v_mov_b32 v137, 0x3f803f80
    v_mov_b32 v138, 0x3f803f80
    v_mov_b32 v139, 0x3f803f80
    s_nop 1
    v_mfma_f32_32x32x16_bf16 v[48:63], a[224:227], v[136:139], 0
    v_mfma_f32_32x32x16_bf16 v[48:63], a[228:231], v[136:139], v[48:63]
    v_mfma_f32_32x32x16_bf16 v[48:63], a[232:235], v[136:139], v[48:63]
    v_mfma_f32_32x32x16_bf16 v[48:63], a[236:239], v[136:139], v[48:63]
    v_mfma_f32_32x32x16_bf16 v[48:63], a[240:243], v[136:139], v[48:63]
    v_mfma_f32_32x32x16_bf16 v[48:63], a[244:247], v[136:139], v[48:63]
    v_mfma_f32_32x32x16_bf16 v[48:63], a[248:251], v[136:139], v[48:63]
    v_mfma_f32_32x32x16_bf16 v[48:63], a[252:255], v[136:139], v[48:63]
    v_mfma_f32_32x32x16_bf16 v[48:63], v[176:179], v[136:139], v[48:63]
    v_mfma_f32_32x32x16_bf16 v[48:63], v[180:183], v[136:139], v[48:63]
    v_mfma_f32_32x32x16_bf16 v[48:63], v[184:187], v[136:139], v[48:63]
    v_mfma_f32_32x32x16_bf16 v[48:63], v[188:191], v[136:139], v[48:63]
    v_mfma_f32_32x32x16_bf16 v[48:63], v[192:195], v[136:139], v[48:63]
    v_mfma_f32_32x32x16_bf16 v[48:63], v[196:199], v[136:139], v[48:63]
    v_mfma_f32_32x32x16_bf16 v[48:63], v[200:203], v[136:139], v[48:63]
    v_mfma_f32_32x32x16_bf16 v[48:63], v[204:207], v[136:139], v[48:63]
    v_mfma_f32_32x32x16_bf16 v[48:63], v[208:211], v[136:139], v[48:63]
    v_mfma_f32_32x32x16_bf16 v[48:63], v[212:215], v[136:139], v[48:63]
    v_mfma_f32_32x32x16_bf16 v[48:63], v[216:219], v[136:139], v[48:63]
    v_mfma_f32_32x32x16_bf16 v[48:63], v[220:223], v[136:139], v[48:63]
    v_mfma_f32_32x32x16_bf16 v[48:63], v[224:227], v[136:139], v[48:63]
    v_mfma_f32_32x32x16_bf16 v[48:63], v[228:231], v[136:139], v[48:63]
    v_mfma_f32_32x32x16_bf16 v[48:63], v[232:235], v[136:139], v[48:63]
    v_mfma_f32_32x32x16_bf16 v[48:63], v[236:239], v[136:139], v[48:63]
    v_mfma_f32_32x32x16_bf16 v[48:63], v[240:243], v[136:139], v[48:63]
    v_mfma_f32_32x32x16_bf16 v[48:63], v[244:247], v[136:139], v[48:63]
    v_mfma_f32_32x32x16_bf16 v[48:63], v[248:251], v[136:139], v[48:63]
    v_mfma_f32_32x32x16_bf16 v[48:63], v[252:255], v[136:139], v[48:63]
    v_mov_b32 v3, v168
    v_mov_b32 v4, v169
    buffer_load_dwordx2 v[132:133], v4, s[8:11], 0 offen sc1
    s_waitcnt vmcnt(0)
    v_cmp_ne_u64 vcc, s[96:97], v[132:133]
    s_cbranch_vccz FSD_1_12
    s_mov_b32 s80, 0
FS_1_11:
    buffer_load_dwordx2 v[132:133], v4, s[8:11], 0 offen sc1
    s_waitcnt vmcnt(0)
    v_cmp_ne_u64 vcc, s[96:97], v[132:133]
    s_cbranch_vccz FSD_1_12
    s_add_u32 s80, s80, 1
    s_cmp_lt_u32 s80, 20000
    s_cbranch_scc0 FSD_1_12_to
    s_sleep 1
    s_branch FS_1_11
FSD_1_12_to:
    s_or_b32 s39, s39, 1
FSD_1_12:
    s_mov_b32 s80, 23855104
    buffer_load_dwordx2 v[144:145], v3, s[8:11], s80 offen
    buffer_load_dwordx2 v[146:147], v3, s[8:11], s80 offen offset:1024
    v_mov_b32 v160, 0
    v_mov_b32 v161, 0
    v_mov_b32 v162, 0
    v_mov_b32 v163, 0
    v_mov_b32 v164, 0
    v_mov_b32 v165, 0
    v_mov_b32 v166, 0
    v_mov_b32 v167, 0
    v_mov_b32 v168, 0
    v_mov_b32 v169, 0
    v_mov_b32 v170, 0
    v_mov_b32 v171, 0
    v_mov_b32 v172, 0
    v_mov_b32 v173, 0
    v_mov_b32 v174, 0
    v_mov_b32 v175, 0
    s_lshl_b32 s81, s69, 17
    s_lshl_b32 s82, s5, 16
    s_add_u32 s81, s81, s82
    s_add_u32 s81, s81, 3670016
    s_add_u32 s80, s81, 0
    buffer_load_short_d16_hi v160, v5, s[8:11], s80 offen offset:0
    s_add_u32 s80, s81, 4096
    buffer_load_short_d16_hi v161, v5, s[8:11], s80 offen offset:0
    s_add_u32 s80, s81, 8192
    buffer_load_short_d16_hi v162, v5, s[8:11], s80 offen offset:0
    s_add_u32 s80, s81, 12288
    buffer_load_short_d16_hi v163, v5, s[8:11], s80 offen offset:0
    s_add_u32 s80, s81, 32768
    buffer_load_short_d16_hi v164, v5, s[8:11], s80 offen offset:0
    s_add_u32 s80, s81, 36864
    buffer_load_short_d16_hi v165, v5, s[8:11], s80 offen offset:0
    s_add_u32 s80, s81, 40960
    buffer_load_short_d16_hi v166, v5, s[8:11], s80 offen offset:0
    s_add_u32 s80, s81, 45056
    buffer_load_short_d16_hi v167, v5, s[8:11], s80 offen offset:0
    s_add_u32 s80, s81, 0
    buffer_load_short_d16_hi v168, v5, s[8:11], s80 offen offset:256
    s_add_u32 s80, s81, 4096
    buffer_load_short_d16_hi v169, v5, s[8:11], s80 offen offset:256
    s_add_u32 s80, s81, 8192
    buffer_load_short_d16_hi v170, v5, s[8:11], s80 offen offset:256
    s_add_u32 s80, s81, 12288
    buffer_load_short_d16_hi v171, v5, s[8:11], s80 offen offset:256
    s_add_u32 s80, s81, 32768
    buffer_load_short_d16_hi v172, v5, s[8:11], s80 offen offset:256
    s_add_u32 s80, s81, 36864
    buffer_load_short_d16_hi v173, v5, s[8:11], s80 offen offset:256
    s_add_u32 s80, s81, 40960
    buffer_load_short_d16_hi v174, v5, s[8:11], s80 offen offset:256
    s_add_u32 s80, s81, 45056
    buffer_load_short_d16_hi v175, v5, s[8:11], s80 offen offset:256
    s_lshl_b32 s81, s64, 8
    s_add_u32 s81, s81, 25416704
    v_min_u32 v136, 27, v0
    v_lshlrev_b32 v136, 3, v136
    v_add_u32 v136, s81, v136
    s_mov_b32 s80, 0
CC_1_13:
    buffer_load_dwordx2 v[134:135], v136, s[8:11], 0 offen sc1
    s_waitcnt vmcnt(0)
    v_xor_b32 v135, s97, v135
    v_cmp_ne_u32 vcc, s96, v134
    v_cmp_lt_u32 s[88:89], 15, v135
    s_nop 0
    s_or_b64 vcc, vcc, s[88:89]
    s_cbranch_vccz CCD_1_14
    s_add_u32 s80, s80, 1
    s_cmp_lt_u32 s80, 20000
    s_cbranch_scc0 CCD_1_14_to
    s_sleep 1
    s_branch CC_1_13
CCD_1_14_to:
    s_or_b32 s39, s39, 256
CCD_1_14:
    v_cmp_ne_u32 vcc, s38, v135
    s_nop 0
    s_cmp_eq_u64 vcc, 0
    s_cselect_b32 s37, 1, 0
    v_cvt_pk_bf16_f32 v120, v160, v161
    v_cvt_pk_bf16_f32 v121, v162, v163
    v_cvt_pk_bf16_f32 v122, v164, v165
    v_cvt_pk_bf16_f32 v123, v166, v167
    v_cvt_pk_bf16_f32 v124, v168, v169
    v_cvt_pk_bf16_f32 v125, v170, v171
    v_cvt_pk_bf16_f32 v126, v172, v173
    v_cvt_pk_bf16_f32 v127, v174, v175
    s_barrier
    s_cmp_eq_u32 s37, 0
    s_cbranch_scc1 KB_slow
    v_and_b32 v14, 31, v0
    v_lshlrev_b32 v14, 3, v14
    s_lshl_b32 s80, s36, 8
    s_add_u32 s80, s80, 151552
    v_add_u32 v14, s80, v14
    v_lshlrev_b32 v160, 16, v152
    v_and_b32 v161, s77, v152
    v_lshlrev_b32 v162, 16, v153
    v_and_b32 v163, s77, v153
    v_lshlrev_b32 v164, 16, v154
    v_and_b32 v165, s77, v154
    v_lshlrev_b32 v166, 16, v155
    v_and_b32 v167, s77, v155
    v_mul_f32 v136, v144, v145
    v_lshlrev_b32 v137, 16, v120
    v_and_b32 v138, s77, v120
    v_fma_f32 v139, v160, v145, -v136
    v_fma_f32 v140, v161, v145, -v136
    v_fmac_f32 v160, v137, v139
    v_fmac_f32 v161, v138, v140
    v_lshlrev_b32 v137, 16, v121
    v_and_b32 v138, s77, v121
    v_fma_f32 v139, v162, v145, -v136
    v_fma_f32 v140, v163, v145, -v136
    v_fmac_f32 v162, v137, v139
    v_fmac_f32 v163, v138, v140
    v_lshlrev_b32 v137, 16, v122
    v_and_b32 v138, s77, v122
    v_fma_f32 v139, v164, v145, -v136
    v_fma_f32 v140, v165, v145, -v136
    v_fmac_f32 v164, v137, v139
    v_fmac_f32 v165, v138, v140
    v_lshlrev_b32 v137, 16, v123
    v_and_b32 v138, s77, v123
    v_fma_f32 v139, v166, v145, -v136
    v_fma_f32 v140, v167, v145, -v136
    v_fmac_f32 v166, v137, v139
    v_fmac_f32 v167, v138, v140
    v_cvt_pk_bf16_f32 v112, v160, v161
    v_cvt_pk_bf16_f32 v113, v162, v163
    v_cvt_pk_bf16_f32 v114, v164, v165
    v_cvt_pk_bf16_f32 v115, v166, v167
    s_add_u32 s80, s3, 5505024
    buffer_store_dwordx4 v[112:115], v1, s[8:11], s80 offen
    v_add_f32 v128, v160, v161
    v_mul_f32 v129, v160, v160
    v_fmac_f32 v129, v161, v161
    v_add_f32 v128, v128, v162
    v_fmac_f32 v129, v162, v162
    v_add_f32 v128, v128, v163
    v_fmac_f32 v129, v163, v163
    v_add_f32 v128, v128, v164
    v_fmac_f32 v129, v164, v164
    v_add_f32 v128, v128, v165
    v_fmac_f32 v129, v165, v165
    v_add_f32 v128, v128, v166
    v_fmac_f32 v129, v166, v166
    v_add_f32 v128, v128, v167
    v_fmac_f32 v129, v167, v167
    v_mov_b32 v130, v128
    v_mov_b32 v131, v129
    s_nop 0
    v_permlane32_swap_b32 v130, v128
    v_permlane32_swap_b32 v131, v129
    v_add_f32 v128, v128, v130
    v_add_f32 v129, v129, v131
    ds_write_b64 v14, v[128:129] offset:2048
    v_lshlrev_b32 v160, 16, v156
    v_and_b32 v161, s77, v156
    v_lshlrev_b32 v162, 16, v157
    v_and_b32 v163, s77, v157
    v_lshlrev_b32 v164, 16, v158
    v_and_b32 v165, s77, v158
    v_lshlrev_b32 v166, 16, v159
    v_and_b32 v167, s77, v159
    v_mul_f32 v136, v146, v147
    v_lshlrev_b32 v137, 16, v124
    v_and_b32 v138, s77, v124
    v_fma_f32 v139, v160, v147, -v136
    v_fma_f32 v140, v161, v147, -v136
    v_fmac_f32 v160, v137, v139
    v_fmac_f32 v161, v138, v140
    v_lshlrev_b32 v137, 16, v125
    v_and_b32 v138, s77, v125
    v_fma_f32 v139, v162, v147, -v136
    v_fma_f32 v140, v163, v147, -v136
    v_fmac_f32 v162, v137, v139
    v_fmac_f32 v163, v138, v140
    v_lshlrev_b32 v137, 16, v126
    v_and_b32 v138, s77, v126
    v_fma_f32 v139, v164, v147, -v136
    v_fma_f32 v140, v165, v147, -v136
    v_fmac_f32 v164, v137, v139
    v_fmac_f32 v165, v138, v140
    v_lshlrev_b32 v137, 16, v127
    v_and_b32 v138, s77, v127
    v_fma_f32 v139, v166, v147, -v136
    v_fma_f32 v140, v167, v147, -v136
    v_fmac_f32 v166, v137, v139
    v_fmac_f32 v167, v138, v140
    v_cvt_pk_bf16_f32 v116, v160, v161
    v_cvt_pk_bf16_f32 v117, v162, v163
    v_cvt_pk_bf16_f32 v118, v164, v165
    v_cvt_pk_bf16_f32 v119, v166, v167
    s_add_u32 s80, s3, 5619712
    buffer_store_dwordx4 v[116:119], v1, s[8:11], s80 offen
    v_add_f32 v144, v160, v161
    v_mul_f32 v145, v160, v160
    v_fmac_f32 v145, v161, v161
    v_add_f32 v144, v144, v162
    v_fmac_f32 v145, v162, v162
    v_add_f32 v144, v144, v163
    v_fmac_f32 v145, v163, v163
    v_add_f32 v144, v144, v164
    v_fmac_f32 v145, v164, v164
    v_add_f32 v144, v144, v165
    v_fmac_f32 v145, v165, v165
    v_add_f32 v144, v144, v166
    v_fmac_f32 v145, v166, v166
    v_add_f32 v144, v144, v167
    v_fmac_f32 v145, v167, v167
    v_mov_b32 v146, v144
    v_mov_b32 v147, v145
    s_nop 0
    v_permlane32_swap_b32 v146, v144
    v_permlane32_swap_b32 v147, v145
    v_add_f32 v144, v144, v146
    v_add_f32 v145, v145, v147
    ds_write_b64 v14, v[144:145] offset:3072
    s_waitcnt vmcnt(0) lgkmcnt(0)
    s_barrier
    ds_read_b64 v[132:133], v14 offset:2560
    s_waitcnt lgkmcnt(0)
    s_cmp_eq_u32 s5, 0
    s_cbranch_scc0 GP_1_15
    v_add_f32 v128, v128, v132
    v_add_f32 v129, v129, v133
    v_mov_b32 v130, s96
    v_mov_b32 v131, s97
    s_add_u32 s80, s4, 23920640
    s_mov_b32 exec_hi, 0
    buffer_store_dwordx4 v[128:131], v1, s[8:11], s80 offen
    s_mov_b32 exec_hi, -1
GP_1_15:
    ds_read_b64 v[148:149], v14 offset:3584
    s_waitcnt lgkmcnt(0)
    s_cmp_eq_u32 s5, 0
    s_cbranch_scc0 GP_1_16
    v_add_f32 v144, v144, v148
    v_add_f32 v145, v145, v149
    v_mov_b32 v146, s96
    v_mov_b32 v147, s97
    s_add_u32 s80, s4, 23920640
    s_add_u32 s80, s80, 28672
    s_mov_b32 exec_hi, 0
    buffer_store_dwordx4 v[144:147], v1, s[8:11], s80 offen
    s_mov_b32 exec_hi, -1
GP_1_16:
    s_xor_b32 s100, s96, 1
    s_mov_b32 s101, s97
    s_mov_b32 s70, 0
    s_mov_b32 s72, 9175040
    s_mov_b32 s74, 25296896
    s_mov_b32 s71, 5505024
    v_and_b32 v5, 31, v0
    v_lshlrev_b32 v5, 4, v5
    v_add_u32 v5, 114688, v5
    v_add_u32 v2, 0, v1
    v_add_u32 v7, 57344, v1
    s_mul_i32 s80, s76, 112
    s_add_u32 s80, s80, s63
    s_lshl_b32 s79, s80, 10
    s_add_u32 s79, s79, s72
    s_lshl_b32 s80, s80, 3
    s_add_u32 s80, s80, s74
    v_mov_b32 v8, s80
    v_add_u32 v9, 3584, v8
    s_mul_i32 s84, s36, 7168
    s_mul_i32 s85, s76, 28672
    s_add_u32 s85, s85, s71
    s_add_u32 s85, s85, s84
    s_add_u32 s82, s76, s36
    s_mul_i32 s83, s82, 7168
    s_add_u32 s83, s83, 23920640
    v_and_b32 v4, 31, v0
    v_lshlrev_b32 v4, 4, v4
    v_lshrrev_b32 v6, 5, v0
    v_lshl_add_u32 v4, v6, 9, v4
    v_add_u32 v4, s83, v4
    buffer_load_dwordx4 v[64:67], v4, s[8:11], 0 offen offset:0 sc1
    buffer_load_dwordx4 v[68:71], v4, s[8:11], 0 offen offset:1024 sc1
    buffer_load_dwordx4 v[72:75], v4, s[8:11], 0 offen offset:2048 sc1
    buffer_load_dwordx4 v[76:79], v4, s[8:11], 0 offen offset:3072 sc1
    buffer_load_dwordx4 v[80:83], v4, s[8:11], s78 offen offset:0 sc1
    buffer_load_dwordx4 v[84:87], v4, s[8:11], s78 offen offset:1024 sc1
    buffer_load_dwordx4 v[88:91], v4, s[8:11], s78 offen offset:2048 sc1
    v_add_u32 v6, 28672, v4
    buffer_load_dwordx4 v[92:95], v6, s[8:11], 0 offen offset:0 sc1
    buffer_load_dwordx4 v[96:99], v6, s[8:11], 0 offen offset:1024 sc1
    buffer_load_dwordx4 v[100:103], v6, s[8:11], 0 offen offset:2048 sc1
    buffer_load_dwordx4 v[104:107], v6, s[8:11], 0 offen offset:3072 sc1
    buffer_load_dwordx4 v[108:111], v6, s[8:11], s78 offen offset:0 sc1
    buffer_load_dwordx4 v[168:171], v6, s[8:11], s78 offen offset:1024 sc1
    buffer_load_dwordx4 v[172:175], v6, s[8:11], s78 offen offset:2048 sc1
    s_waitcnt vmcnt(7)
    s_mov_b32 s80, 0
GC_1_17:
    v_cmpx_eq_u64 vcc, s[96:97], v[66:67]
    v_cmpx_eq_u64 vcc, s[96:97], v[70:71]
    v_cmpx_eq_u64 vcc, s[96:97], v[74:75]
    v_cmpx_eq_u64 vcc, s[96:97], v[78:79]
    v_cmpx_eq_u64 vcc, s[96:97], v[82:83]
    v_cmpx_eq_u64 vcc, s[96:97], v[86:87]
    v_cmpx_eq_u64 vcc, s[96:97], v[90:91]
    s_nop 4
    s_cmp_eq_u64 exec, -1
    s_mov_b64 exec, -1
    s_cbranch_scc1 GCD_1_18
    buffer_load_dwordx4 v[64:67], v4, s[8:11], 0 offen offset:0 sc1
    buffer_load_dwordx4 v[68:71], v4, s[8:11], 0 offen offset:1024 sc1
    buffer_load_dwordx4 v[72:75], v4, s[8:11], 0 offen offset:2048 sc1
    buffer_load_dwordx4 v[76:79], v4, s[8:11], 0 offen offset:3072 sc1
    buffer_load_dwordx4 v[80:83], v4, s[8:11], s78 offen offset:0 sc1
    buffer_load_dwordx4 v[84:87], v4, s[8:11], s78 offen offset:1024 sc1
    buffer_load_dwordx4 v[88:91], v4, s[8:11], s78 offen offset:2048 sc1
    s_waitcnt vmcnt(0)
    s_add_u32 s80, s80, 1
    s_cmp_lt_u32 s80, 20000
    s_cbranch_scc0 GCD_1_18_to
    s_sleep 1
    s_branch GC_1_17
GCD_1_18_to:
    s_or_b32 s39, s39, 4
GCD_1_18:
    s_waitcnt vmcnt(0)
    s_mov_b32 s80, 0
GC_1_19:
    v_cmpx_eq_u64 vcc, s[96:97], v[94:95]
    v_cmpx_eq_u64 vcc, s[96:97], v[98:99]
    v_cmpx_eq_u64 vcc, s[96:97], v[102:103]
    v_cmpx_eq_u64 vcc, s[96:97], v[106:107]
    v_cmpx_eq_u64 vcc, s[96:97], v[110:111]
    v_cmpx_eq_u64 vcc, s[96:97], v[170:171]
    v_cmpx_eq_u64 vcc, s[96:97], v[174:175]
    s_nop 4
    s_cmp_eq_u64 exec, -1
    s_mov_b64 exec, -1
    s_cbranch_scc1 GCD_1_20
    buffer_load_dwordx4 v[92:95], v6, s[8:11], 0 offen offset:0 sc1
    buffer_load_dwordx4 v[96:99], v6, s[8:11], 0 offen offset:1024 sc1
    buffer_load_dwordx4 v[100:103], v6, s[8:11], 0 offen offset:2048 sc1
    buffer_load_dwordx4 v[104:107], v6, s[8:11], 0 offen offset:3072 sc1
    buffer_load_dwordx4 v[108:111], v6, s[8:11], s78 offen offset:0 sc1
    buffer_load_dwordx4 v[168:171], v6, s[8:11], s78 offen offset:1024 sc1
    buffer_load_dwordx4 v[172:175], v6, s[8:11], s78 offen offset:2048 sc1
    s_waitcnt vmcnt(0)
    s_add_u32 s80, s80, 1
    s_cmp_lt_u32 s80, 20000
    s_cbranch_scc0 GCD_1_20_to
    s_sleep 1
    s_branch GC_1_19
GCD_1_20_to:
    s_or_b32 s39, s39, 64
GCD_1_20:
    v_add_u32 v4, 28672, v4
    s_barrier
    s_add_u32 s83, s85, 0
    s_add_u32 m0, s84, 0
    s_nop 0
    buffer_load_dwordx4 v1, s[8:11], s83 offen offset:0 sc1 lds
    buffer_load_dwordx4 v1, s[8:11], s83 offen offset:1024 sc1 lds
    buffer_load_dwordx4 v1, s[8:11], s83 offen offset:2048 sc1 lds
    buffer_load_dwordx4 v1, s[8:11], s83 offen offset:3072 sc1 lds
    s_add_u32 s83, s83, 4096
    s_add_u32 m0, s84, 4096
    s_nop 0
    buffer_load_dwordx4 v1, s[8:11], s83 offen offset:0 sc1 lds
    buffer_load_dwordx4 v1, s[8:11], s83 offen offset:1024 sc1 lds
    buffer_load_dwordx4 v1, s[8:11], s83 offen offset:2048 sc1 lds
    s_add_u32 s83, s85, 28672
    s_add_u32 m0, s84, 28672
    s_nop 0
    buffer_load_dwordx4 v1, s[8:11], s83 offen offset:0 sc1 lds
    buffer_load_dwordx4 v1, s[8:11], s83 offen offset:1024 sc1 lds
    buffer_load_dwordx4 v1, s[8:11], s83 offen offset:2048 sc1 lds
    buffer_load_dwordx4 v1, s[8:11], s83 offen offset:3072 sc1 lds
    s_add_u32 s83, s83, 4096
    s_add_u32 m0, s84, 32768
    s_nop 0
    buffer_load_dwordx4 v1, s[8:11], s83 offen offset:0 sc1 lds
    buffer_load_dwordx4 v1, s[8:11], s83 offen offset:1024 sc1 lds
    buffer_load_dwordx4 v1, s[8:11], s83 offen offset:2048 sc1 lds
    v_add_f32 v66, v64, v68
    v_add_f32 v67, v65, v69
    v_add_f32 v66, v66, v72
    v_add_f32 v67, v67, v73
    v_add_f32 v66, v66, v76
    v_add_f32 v67, v67, v77
    v_add_f32 v66, v66, v80
    v_add_f32 v67, v67, v81
    v_add_f32 v66, v66, v84
    v_add_f32 v67, v67, v85
    v_add_f32 v66, v66, v88
    v_add_f32 v67, v67, v89
    v_mov_b32 v70, v66
    v_mov_b32 v71, v67
    s_nop 0
    v_permlane32_swap_b32 v70, v66
    v_permlane32_swap_b32 v71, v67
    v_add_f32 v66, v66, v70
    v_add_f32 v67, v67, v71
    v_mul_f32 v72, 0x3b124925, v66
    v_mul_f32 v77, 0x3b124925, v67
    v_fma_f32 v77, -v72, v72, v77
    v_max_f32 v77, 0, v77
    v_add_f32 v77, 0x3727c5ac, v77
    v_rsq_f32 v76, v77
    v_mov_b32 v75, 0
    v_mul_f32 v73, 0xbfb8aa3b, v76
    v_mul_f32 v74, v76, v76
    s_lshl_b32 s80, s36, 9
    v_add_u32 v80, s80, v5
    ds_write_b128 v80, v[72:75] offset:0
    s_lshl_b32 s94, s66, 2
    s_add_u32 s94, s94, s36
    s_lshl_b32 s80, s94, 3
    s_add_u32 s80, s80, 25419776
    v_mov_b32 v3, s80
    buffer_load_dwordx2 v[160:161], v3, s[8:11], 0 offen sc1
    s_mul_i32 s94, s94, 57344
    s_add_u32 s94, s94, 25420800
    s_waitcnt vmcnt(0)
    v_cmp_ne_u64 vcc, s[96:97], v[160:161]
    s_cbranch_vccz FSD_1_22
    s_mov_b32 s80, 0
FS_1_21:
    buffer_load_dwordx2 v[160:161], v3, s[8:11], 0 offen sc1
    s_waitcnt vmcnt(0)
    v_cmp_ne_u64 vcc, s[96:97], v[160:161]
    s_cbranch_vccz FSD_1_22
    s_add_u32 s80, s80, 1
    s_cmp_lt_u32 s80, 20000
    s_cbranch_scc0 FSD_1_22_to
    s_sleep 1
    s_branch FS_1_21
FSD_1_22_to:
    s_or_b32 s39, s39, 4096
FSD_1_22:
    s_waitcnt lgkmcnt(0)
    s_barrier
    ds_read_b128 v[64:67], v2 offset:0
    ds_read_b128 v[68:71], v2 offset:1024
    ds_read_b128 v[72:75], v2 offset:2048
    ds_read_b128 v[76:79], v2 offset:3072
    ds_read_b128 v[80:83], v2 offset:4096
    ds_read_b128 v[84:87], v2 offset:5120
    s_waitcnt lgkmcnt(4)
    v_mfma_f32_32x32x16_bf16 v[16:31], a[224:227], v[64:67], 0
    ds_read_b128 v[88:91], v2 offset:6144
    v_mfma_f32_32x32x16_bf16 v[16:31], a[228:231], v[68:71], v[16:31]
    ds_read_b128 v[64:67], v2 offset:7168
    s_waitcnt lgkmcnt(4)
    v_mfma_f32_32x32x16_bf16 v[16:31], a[232:235], v[72:75], v[16:31]
    v_add_f32 v94, v92, v96
    v_add_f32 v95, v93, v97
    v_add_f32 v94, v94, v100
    v_add_f32 v95, v95, v101
    ds_read_b128 v[68:71], v2 offset:8192
    v_mfma_f32_32x32x16_bf16 v[16:31], a[236:239], v[76:79], v[16:31]
    v_add_f32 v94, v94, v104
    v_add_f32 v95, v95, v105
    v_add_f32 v94, v94, v108
    ds_read_b128 v[72:75], v2 offset:9216
    s_waitcnt lgkmcnt(4)
    v_mfma_f32_32x32x16_bf16 v[16:31], a[240:243], v[80:83], v[16:31]
    v_add_f32 v95, v95, v109
    v_add_f32 v94, v94, v168
    v_add_f32 v95, v95, v169
    v_add_f32 v94, v94, v172
    ds_read_b128 v[76:79], v2 offset:10240
    v_mfma_f32_32x32x16_bf16 v[16:31], a[244:247], v[84:87], v[16:31]
    v_add_f32 v95, v95, v173
    v_mov_b32 v98, v94
    v_mov_b32 v99, v95
    ds_read_b128 v[80:83], v2 offset:11264
    s_waitcnt lgkmcnt(4)
    v_mfma_f32_32x32x16_bf16 v[16:31], a[248:251], v[88:91], v[16:31]
    s_nop 0
    v_permlane32_swap_b32 v98, v94
    v_permlane32_swap_b32 v99, v95
    v_add_f32 v94, v94, v98
    ds_read_b128 v[84:87], v2 offset:12288
    v_mfma_f32_32x32x16_bf16 v[16:31], a[252:255], v[64:67], v[16:31]
    v_add_f32 v95, v95, v99
    v_mul_f32 v100, 0x3b124925, v94
    v_mul_f32 v105, 0x3b124925, v95
    ds_read_b128 v[88:91], v2 offset:13312
    s_waitcnt lgkmcnt(4)
    v_mfma_f32_32x32x16_bf16 v[16:31], v[176:179], v[68:71], v[16:31]
    v_fma_f32 v105, -v100, v100, v105
    v_max_f32 v105, 0, v105
    v_add_f32 v105, 0x3727c5ac, v105
    ds_read_b128 v[64:67], v2 offset:14336
    v_mfma_f32_32x32x16_bf16 v[16:31], v[180:183], v[72:75], v[16:31]
    v_rsq_f32 v104, v105
    v_mov_b32 v103, 0
    ds_read_b128 v[68:71], v2 offset:15360
    s_waitcnt lgkmcnt(4)
    v_mfma_f32_32x32x16_bf16 v[16:31], v[184:187], v[76:79], v[16:31]
    v_mul_f32 v101, 0xbfb8aa3b, v104
    v_mul_f32 v102, v104, v104
    ds_read_b128 v[72:75], v2 offset:16384
    v_mfma_f32_32x32x16_bf16 v[16:31], v[188:191], v[80:83], v[16:31]
    s_lshl_b32 s80, s36, 9
    v_add_u32 v108, s80, v5
    ds_write_b128 v108, v[100:103] offset:2048
    ds_read_b128 v[76:79], v2 offset:17408
    s_waitcnt lgkmcnt(5)
    v_mfma_f32_32x32x16_bf16 v[16:31], v[192:195], v[84:87], v[16:31]
    ds_read_b128 v[80:83], v2 offset:18432
    v_mfma_f32_32x32x16_bf16 v[16:31], v[196:199], v[88:91], v[16:31]
    ds_read_b128 v[84:87], v2 offset:19456
    s_waitcnt lgkmcnt(5)
    v_mfma_f32_32x32x16_bf16 v[16:31], v[200:203], v[64:67], v[16:31]
    s_add_u32 s83, s85, 57344
    s_add_u32 m0, s84, 57344
    s_nop 0
    buffer_load_dwordx4 v1, s[8:11], s83 offen offset:0 sc1 lds
    ds_read_b128 v[88:91], v2 offset:20480
    v_mfma_f32_32x32x16_bf16 v[16:31], v[204:207], v[68:71], v[16:31]
    ds_read_b128 v[64:67], v2 offset:21504
    s_waitcnt lgkmcnt(4)
    v_mfma_f32_32x32x16_bf16 v[16:31], v[208:211], v[72:75], v[16:31]
    s_add_u32 m0, s84, 57344
    s_nop 0
    buffer_load_dwordx4 v1, s[8:11], s83 offen offset:1024 sc1 lds
    ds_read_b128 v[68:71], v2 offset:22528
    v_mfma_f32_32x32x16_bf16 v[16:31], v[212:215], v[76:79], v[16:31]
    ds_read_b128 v[72:75], v2 offset:23552
    s_waitcnt lgkmcnt(4)
    v_mfma_f32_32x32x16_bf16 v[16:31], v[216:219], v[80:83], v[16:31]
    s_add_u32 m0, s84, 57344
    s_nop 0
    buffer_load_dwordx4 v1, s[8:11], s83 offen offset:2048 sc1 lds
    ds_read_b128 v[76:79], v2 offset:24576
    v_mfma_f32_32x32x16_bf16 v[16:31], v[220:223], v[84:87], v[16:31]
    ds_read_b128 v[80:83], v2 offset:25600
    s_waitcnt lgkmcnt(4)
    v_mfma_f32_32x32x16_bf16 v[16:31], v[224:227], v[88:91], v[16:31]
    s_add_u32 m0, s84, 57344
    s_nop 0
    buffer_load_dwordx4 v1, s[8:11], s83 offen offset:3072 sc1 lds
    ds_read_b128 v[84:87], v2 offset:26624
    v_mfma_f32_32x32x16_bf16 v[16:31], v[228:231], v[64:67], v[16:31]
    s_barrier
    ds_read_b128 v[88:91], v2 offset:27648
    s_waitcnt lgkmcnt(4)
    v_mfma_f32_32x32x16_bf16 v[16:31], v[232:235], v[68:71], v[16:31]
    s_add_u32 s83, s83, 4096
    s_add_u32 m0, s84, 61440
    s_nop 0
    buffer_load_dwordx4 v1, s[8:11], s83 offen offset:0 sc1 lds
    ds_read_b128 v[64:67], v2 offset:28672
    v_mfma_f32_32x32x16_bf16 v[16:31], v[236:239], v[72:75], v[16:31]
    ds_read_b128 v[68:71], v2 offset:29696
    s_waitcnt lgkmcnt(4)
    v_mfma_f32_32x32x16_bf16 v[16:31], v[240:243], v[76:79], v[16:31]
    s_add_u32 m0, s84, 61440
    s_nop 0
    buffer_load_dwordx4 v1, s[8:11], s83 offen offset:1024 sc1 lds
    ds_read_b128 v[72:75], v2 offset:30720
    v_mfma_f32_32x32x16_bf16 v[16:31], v[244:247], v[80:83], v[16:31]
    ds_read_b128 v[76:79], v2 offset:31744
    s_waitcnt lgkmcnt(4)
    v_mfma_f32_32x32x16_bf16 v[16:31], v[248:251], v[84:87], v[16:31]
    s_add_u32 m0, s84, 61440
    s_nop 0
    buffer_load_dwordx4 v1, s[8:11], s83 offen offset:2048 sc1 lds
    ds_read_b128 v[80:83], v2 offset:32768
    v_mfma_f32_32x32x16_bf16 v[16:31], v[252:255], v[88:91], v[16:31]
    ds_read_b128 v[84:87], v2 offset:33792
    s_waitcnt lgkmcnt(4)
    v_mfma_f32_32x32x16_bf16 v[32:47], a[224:227], v[64:67], 0
    s_add_u32 s95, s94, 0
    buffer_load_dwordx4 a[0:3], v1, s[8:11], s95 offen offset:0
    ds_read_b64 v[152:153], v5 offset:0
    ds_read_b128 v[88:91], v2 offset:34816
    v_mfma_f32_32x32x16_bf16 v[32:47], a[228:231], v[68:71], v[32:47]
    buffer_load_dwordx4 a[4:7], v1, s[8:11], s95 offen offset:1024
    ds_read_b128 v[64:67], v2 offset:35840
    s_waitcnt lgkmcnt(5)
    v_mfma_f32_32x32x16_bf16 v[32:47], a[232:235], v[72:75], v[32:47]
    s_waitcnt lgkmcnt(2)
    v_fma_f32 v128, -v152, v48, v16
    v_fma_f32 v136, -v152, v56, v24
    v_fma_f32 v129, -v152, v49, v17
    ds_read_b128 v[68:71], v2 offset:36864
    v_mfma_f32_32x32x16_bf16 v[32:47], a[236:239], v[76:79], v[32:47]
    buffer_load_dwordx4 a[8:11], v1, s[8:11], s95 offen offset:2048
    ds_read_b128 v[72:75], v2 offset:37888
    v_mfma_f32_32x32x16_bf16 v[32:47], a[240:243], v[80:83], v[32:47]
    buffer_load_dwordx4 a[12:15], v1, s[8:11], s95 offen offset:3072
    ds_read_b128 v[76:79], v2 offset:38912
    v_mfma_f32_32x32x16_bf16 v[32:47], a[244:247], v[84:87], v[32:47]
    v_fma_f32 v137, -v152, v57, v25
    v_mul_f32 v144, v128, v153
    v_mul_f32 v128, v128, v136
    ds_read_b128 v[80:83], v2 offset:39936
    s_waitcnt lgkmcnt(4)
    v_mfma_f32_32x32x16_bf16 v[32:47], a[248:251], v[88:91], v[32:47]
    s_add_u32 s95, s94, 4096
    buffer_load_dwordx4 a[16:19], v1, s[8:11], s95 offen offset:0
    ds_read_b128 v[84:87], v2 offset:40960
    v_mfma_f32_32x32x16_bf16 v[32:47], a[252:255], v[64:67], v[32:47]
    buffer_load_dwordx4 a[20:23], v1, s[8:11], s95 offen offset:1024
    ds_read_b128 v[88:91], v2 offset:41984
    s_waitcnt lgkmcnt(4)
    v_mfma_f32_32x32x16_bf16 v[32:47], v[176:179], v[68:71], v[32:47]
    v_fma_f32 v130, -v152, v50, v18
    v_exp_f32 v144, v144
    v_fma_f32 v138, -v152, v58, v26
    ds_read_b128 v[64:67], v2 offset:43008
    v_mfma_f32_32x32x16_bf16 v[32:47], v[180:183], v[72:75], v[32:47]
    buffer_load_dwordx4 a[24:27], v1, s[8:11], s95 offen offset:2048
    ds_read_b128 v[68:71], v2 offset:44032
    s_waitcnt lgkmcnt(4)
    v_mfma_f32_32x32x16_bf16 v[32:47], v[184:187], v[76:79], v[32:47]
    buffer_load_dwordx4 a[28:31], v1, s[8:11], s95 offen offset:3072
    ds_read_b128 v[72:75], v2 offset:45056
    v_mfma_f32_32x32x16_bf16 v[32:47], v[188:191], v[80:83], v[32:47]
    v_mul_f32 v145, v129, v153
    v_mul_f32 v129, v129, v137
    v_fma_f32 v131, -v152, v51, v19
    ds_read_b128 v[76:79], v2 offset:46080
    s_waitcnt lgkmcnt(4)
    v_mfma_f32_32x32x16_bf16 v[32:47], v[192:195], v[84:87], v[32:47]
    s_add_u32 s95, s94, 8192
    buffer_load_dwordx4 a[32:35], v1, s[8:11], s95 offen offset:0
    ds_read_b128 v[80:83], v2 offset:47104
    v_mfma_f32_32x32x16_bf16 v[32:47], v[196:199], v[88:91], v[32:47]
    v_exp_f32 v145, v145
    v_fma_f32 v139, -v152, v59, v27
    ds_read_b128 v[84:87], v2 offset:48128
    s_waitcnt lgkmcnt(4)
    v_mfma_f32_32x32x16_bf16 v[32:47], v[200:203], v[64:67], v[32:47]
    s_add_u32 s83, s85, 86016
    s_add_u32 m0, s84, 86016
    s_nop 0
    buffer_load_dwordx4 v1, s[8:11], s83 offen offset:0 sc1 lds
    ds_read_b128 v[88:91], v2 offset:49152
    v_mfma_f32_32x32x16_bf16 v[32:47], v[204:207], v[68:71], v[32:47]
    v_mul_f32 v146, v130, v153
    v_mul_f32 v130, v130, v138
    v_fma_f32 v132, -v152, v52, v20
    ds_read_b128 v[64:67], v2 offset:50176
    s_waitcnt lgkmcnt(4)
    v_mfma_f32_32x32x16_bf16 v[32:47], v[208:211], v[72:75], v[32:47]
    s_add_u32 m0, s84, 86016
    s_nop 0
    buffer_load_dwordx4 v1, s[8:11], s83 offen offset:1024 sc1 lds
    ds_read_b128 v[68:71], v2 offset:51200
    v_mfma_f32_32x32x16_bf16 v[32:47], v[212:215], v[76:79], v[32:47]
    v_exp_f32 v146, v146
    v_fma_f32 v140, -v152, v60, v28
    ds_read_b128 v[72:75], v2 offset:52224
    s_waitcnt lgkmcnt(4)
    v_mfma_f32_32x32x16_bf16 v[32:47], v[216:219], v[80:83], v[32:47]
    s_add_u32 m0, s84, 86016
    s_nop 0
    buffer_load_dwordx4 v1, s[8:11], s83 offen offset:2048 sc1 lds
    v_mul_f32 v147, v131, v153
    ds_read_b128 v[76:79], v2 offset:53248
    v_mfma_f32_32x32x16_bf16 v[32:47], v[220:223], v[84:87], v[32:47]
    v_mul_f32 v131, v131, v139
    v_add_f32 v144, 1.0, v144
    v_fma_f32 v133, -v152, v53, v21
    ds_read_b128 v[80:83], v2 offset:54272
    s_waitcnt lgkmcnt(4)
    v_mfma_f32_32x32x16_bf16 v[32:47], v[224:227], v[88:91], v[32:47]
    s_add_u32 m0, s84, 86016
    s_nop 0
    buffer_load_dwordx4 v1, s[8:11], s83 offen offset:3072 sc1 lds
    s_waitcnt vmcnt(13)
    ds_read_b128 v[84:87], v2 offset:55296
    v_mfma_f32_32x32x16_bf16 v[32:47], v[228:231], v[64:67], v[32:47]
    s_barrier
    v_exp_f32 v147, v147
    ds_read_b128 v[88:91], v2 offset:56320
    s_waitcnt lgkmcnt(4)
    v_mfma_f32_32x32x16_bf16 v[32:47], v[232:235], v[68:71], v[32:47]
    s_add_u32 s83, s83, 4096
    s_add_u32 m0, s84, 90112
    s_nop 0
    buffer_load_dwordx4 v1, s[8:11], s83 offen offset:0 sc1 lds
    ds_read_b128 v[64:67], v7 offset:0
    v_mfma_f32_32x32x16_bf16 v[32:47], v[236:239], v[72:75], v[32:47]
    v_fma_f32 v141, -v152, v61, v29
    v_mul_f32 v148, v132, v153
    ds_read_b128 v[68:71], v7 offset:1024
    s_waitcnt lgkmcnt(4)
    v_mfma_f32_32x32x16_bf16 v[32:47], v[240:243], v[76:79], v[32:47]
    s_add_u32 m0, s84, 90112
    s_nop 0
    buffer_load_dwordx4 v1, s[8:11], s83 offen offset:1024 sc1 lds
    ds_read_b128 v[72:75], v7 offset:2048
    v_mfma_f32_32x32x16_bf16 v[32:47], v[244:247], v[80:83], v[32:47]
    v_rcp_f32 v144, v144
    v_mul_f32 v132, v132, v140
    ds_read_b128 v[76:79], v7 offset:3072
    s_waitcnt lgkmcnt(4)
    v_mfma_f32_32x32x16_bf16 v[32:47], v[248:251], v[84:87], v[32:47]
    s_add_u32 m0, s84, 90112
    s_nop 0
    buffer_load_dwordx4 v1, s[8:11], s83 offen offset:2048 sc1 lds
    v_add_f32 v145, 1.0, v145
    ds_read_b128 v[80:83], v7 offset:4096
    v_mfma_f32_32x32x16_bf16 v[32:47], v[252:255], v[88:91], v[32:47]
    v_fma_f32 v134, -v152, v54, v22
    v_exp_f32 v148, v148
    v_fma_f32 v142, -v152, v62, v30
    v_mul_f32 v149, v133, v153
    v_rcp_f32 v145, v145
    v_mul_f32 v133, v133, v141
    v_add_f32 v146, 1.0, v146
    v_fma_f32 v135, -v152, v55, v23
    v_exp_f32 v149, v149
    v_fma_f32 v143, -v152, v63, v31
    v_mul_f32 v150, v134, v153
    v_rcp_f32 v146, v146
    v_mul_f32 v134, v134, v142
    v_add_f32 v147, 1.0, v147
    v_mul_f32 v136, v128, v144
    v_exp_f32 v150, v150
    v_mul_f32 v151, v135, v153
    v_rcp_f32 v147, v147
    v_mul_f32 v135, v135, v143
    v_add_f32 v148, 1.0, v148
    v_mul_f32 v137, v129, v145
    v_exp_f32 v151, v151
    v_rcp_f32 v148, v148
    v_add_f32 v149, 1.0, v149
    v_mul_f32 v138, v130, v146
    v_cvt_pk_bf16_f32 v156, v136, v137
    v_rcp_f32 v149, v149
    v_add_f32 v150, 1.0, v150
    v_mul_f32 v139, v131, v147
    v_rcp_f32 v150, v150
    v_add_f32 v151, 1.0, v151
    v_mul_f32 v140, v132, v148
    v_cvt_pk_bf16_f32 v157, v138, v139
    v_rcp_f32 v151, v151
    v_mul_f32 v141, v133, v149
    v_mul_f32 v142, v134, v150
    v_cvt_pk_bf16_f32 v158, v140, v141
    v_mul_f32 v143, v135, v151
    v_cvt_pk_bf16_f32 v159, v142, v143
    s_add_u32 s82, s79, 0
    buffer_store_dwordx4 v[156:159], v1, s[8:11], s82 offen
    ds_read_b128 v[84:87], v7 offset:5120
    s_waitcnt lgkmcnt(4)
    v_mfma_f32_32x32x16_bf16 v[16:31], a[224:227], v[64:67], 0
    s_add_u32 s95, s94, 8192
    buffer_load_dwordx4 a[36:39], v1, s[8:11], s95 offen offset:1024
    ds_read_b64 v[152:153], v5 offset:512
    ds_read_b128 v[88:91], v7 offset:6144
    v_mfma_f32_32x32x16_bf16 v[16:31], a[228:231], v[68:71], v[16:31]
    buffer_load_dwordx4 a[40:43], v1, s[8:11], s95 offen offset:2048
    ds_read_b128 v[64:67], v7 offset:7168
    s_waitcnt lgkmcnt(5)
    v_mfma_f32_32x32x16_bf16 v[16:31], a[232:235], v[72:75], v[16:31]
    s_waitcnt lgkmcnt(2)
    v_fma_f32 v128, -v152, v48, v32
    v_fma_f32 v136, -v152, v56, v40
    v_fma_f32 v129, -v152, v49, v33
    ds_read_b128 v[68:71], v7 offset:8192
    v_mfma_f32_32x32x16_bf16 v[16:31], a[236:239], v[76:79], v[16:31]
    buffer_load_dwordx4 a[44:47], v1, s[8:11], s95 offen offset:3072
    ds_read_b128 v[72:75], v7 offset:9216
    v_mfma_f32_32x32x16_bf16 v[16:31], a[240:243], v[80:83], v[16:31]
    s_add_u32 s95, s94, 12288
    buffer_load_dwordx4 a[48:51], v1, s[8:11], s95 offen offset:0
    ds_read_b128 v[76:79], v7 offset:10240
    v_mfma_f32_32x32x16_bf16 v[16:31], a[244:247], v[84:87], v[16:31]
    v_fma_f32 v137, -v152, v57, v41
    v_mul_f32 v144, v128, v153
    v_mul_f32 v128, v128, v136
    ds_read_b128 v[80:83], v7 offset:11264
    s_waitcnt lgkmcnt(4)
    v_mfma_f32_32x32x16_bf16 v[16:31], a[248:251], v[88:91], v[16:31]
    buffer_load_dwordx4 a[52:55], v1, s[8:11], s95 offen offset:1024
    ds_read_b128 v[84:87], v7 offset:12288
    v_mfma_f32_32x32x16_bf16 v[16:31], a[252:255], v[64:67], v[16:31]
    buffer_load_dwordx4 a[56:59], v1, s[8:11], s95 offen offset:2048
    ds_read_b128 v[88:91], v7 offset:13312
    s_waitcnt lgkmcnt(4)
    v_mfma_f32_32x32x16_bf16 v[16:31], v[176:179], v[68:71], v[16:31]
    v_fma_f32 v130, -v152, v50, v34
    v_exp_f32 v144, v144
    v_fma_f32 v138, -v152, v58, v42
    ds_read_b128 v[64:67], v7 offset:14336
    v_mfma_f32_32x32x16_bf16 v[16:31], v[180:183], v[72:75], v[16:31]
    buffer_load_dwordx4 a[60:63], v1, s[8:11], s95 offen offset:3072
    ds_read_b128 v[68:71], v7 offset:15360
    s_waitcnt lgkmcnt(4)
    v_mfma_f32_32x32x16_bf16 v[16:31], v[184:187], v[76:79], v[16:31]
    s_add_u32 s95, s94, 16384
    buffer_load_dwordx4 a[64:67], v1, s[8:11], s95 offen offset:0
    ds_read_b128 v[72:75], v7 offset:16384
    v_mfma_f32_32x32x16_bf16 v[16:31], v[188:191], v[80:83], v[16:31]
    v_mul_f32 v145, v129, v153
    v_mul_f32 v129, v129, v137
    v_fma_f32 v131, -v152, v51, v35
    ds_read_b128 v[76:79], v7 offset:17408
    s_waitcnt lgkmcnt(4)
    v_mfma_f32_32x32x16_bf16 v[16:31], v[192:195], v[84:87], v[16:31]
    buffer_load_dwordx4 a[68:71], v1, s[8:11], s95 offen offset:1024
    ds_read_b128 v[80:83], v7 offset:18432
    v_mfma_f32_32x32x16_bf16 v[16:31], v[196:199], v[88:91], v[16:31]
    v_exp_f32 v145, v145
    v_fma_f32 v139, -v152, v59, v43
    ds_read_b128 v[84:87], v7 offset:19456
    s_waitcnt lgkmcnt(4)
    v_mfma_f32_32x32x16_bf16 v[16:31], v[200:203], v[64:67], v[16:31]
    s_add_u32 s83, s85, 114688
    s_add_u32 m0, s84, 0
    s_nop 0
    buffer_load_dwordx4 v1, s[8:11], s83 offen offset:0 sc1 lds
    ds_read_b128 v[88:91], v7 offset:20480
    v_mfma_f32_32x32x16_bf16 v[16:31], v[204:207], v[68:71], v[16:31]
    v_mul_f32 v146, v130, v153
    v_mul_f32 v130, v130, v138
    v_fma_f32 v132, -v152, v52, v36
    ds_read_b128 v[64:67], v7 offset:21504
    s_waitcnt lgkmcnt(4)
    v_mfma_f32_32x32x16_bf16 v[16:31], v[208:211], v[72:75], v[16:31]
    s_add_u32 m0, s84, 0
    s_nop 0
    buffer_load_dwordx4 v1, s[8:11], s83 offen offset:1024 sc1 lds
    ds_read_b128 v[68:71], v7 offset:22528
    v_mfma_f32_32x32x16_bf16 v[16:31], v[212:215], v[76:79], v[16:31]
    v_exp_f32 v146, v146
    v_fma_f32 v140, -v152, v60, v44
    ds_read_b128 v[72:75], v7 offset:23552
    s_waitcnt lgkmcnt(4)
    v_mfma_f32_32x32x16_bf16 v[16:31], v[216:219], v[80:83], v[16:31]
    s_add_u32 m0, s84, 0
    s_nop 0
    buffer_load_dwordx4 v1, s[8:11], s83 offen offset:2048 sc1 lds
    v_mul_f32 v147, v131, v153
    ds_read_b128 v[76:79], v7 offset:24576
    v_mfma_f32_32x32x16_bf16 v[16:31], v[220:223], v[84:87], v[16:31]
    v_mul_f32 v131, v131, v139
    v_add_f32 v144, 1.0, v144
    v_fma_f32 v133, -v152, v53, v37
    ds_read_b128 v[80:83], v7 offset:25600
    s_waitcnt lgkmcnt(4)
    v_mfma_f32_32x32x16_bf16 v[16:31], v[224:227], v[88:91], v[16:31]
    s_add_u32 m0, s84, 0
    s_nop 0
    buffer_load_dwordx4 v1, s[8:11], s83 offen offset:3072 sc1 lds
    s_waitcnt vmcnt(13)
    buffer_store_dwordx2 v[10:11], v8, s[8:11], 0 offen offset:0
    ds_read_b128 v[84:87], v7 offset:26624
    v_mfma_f32_32x32x16_bf16 v[16:31], v[228:231], v[64:67], v[16:31]
    s_barrier
    v_exp_f32 v147, v147
    ds_read_b128 v[88:91], v7 offset:27648
    s_waitcnt lgkmcnt(4)
    v_mfma_f32_32x32x16_bf16 v[16:31], v[232:235], v[68:71], v[16:31]
    s_add_u32 s83, s83, 4096
    s_add_u32 m0, s84, 4096
    s_nop 0
    buffer_load_dwordx4 v1, s[8:11], s83 offen offset:0 sc1 lds
    ds_read_b128 v[64:67], v7 offset:28672
    v_mfma_f32_32x32x16_bf16 v[16:31], v[236:239], v[72:75], v[16:31]
    v_fma_f32 v141, -v152, v61, v45
    v_mul_f32 v148, v132, v153
    ds_read_b128 v[68:71], v7 offset:29696
    s_waitcnt lgkmcnt(4)
    v_mfma_f32_32x32x16_bf16 v[16:31], v[240:243], v[76:79], v[16:31]
    s_add_u32 m0, s84, 4096
    s_nop 0
    buffer_load_dwordx4 v1, s[8:11], s83 offen offset:1024 sc1 lds
    ds_read_b128 v[72:75], v7 offset:30720
    v_mfma_f32_32x32x16_bf16 v[16:31], v[244:247], v[80:83], v[16:31]
    v_rcp_f32 v144, v144
    v_mul_f32 v132, v132, v140
    ds_read_b128 v[76:79], v7 offset:31744
    s_waitcnt lgkmcnt(4)
    v_mfma_f32_32x32x16_bf16 v[16:31], v[248:251], v[84:87], v[16:31]
    s_add_u32 m0, s84, 4096
    s_nop 0
    buffer_load_dwordx4 v1, s[8:11], s83 offen offset:2048 sc1 lds
    v_add_f32 v145, 1.0, v145
    ds_read_b128 v[80:83], v7 offset:32768
    v_mfma_f32_32x32x16_bf16 v[16:31], v[252:255], v[88:91], v[16:31]
    v_fma_f32 v134, -v152, v54, v38
    v_exp_f32 v148, v148
    v_fma_f32 v142, -v152, v62, v46
    v_mul_f32 v149, v133, v153
    v_rcp_f32 v145, v145
    v_mul_f32 v133, v133, v141
    v_add_f32 v146, 1.0, v146
    v_fma_f32 v135, -v152, v55, v39
    v_exp_f32 v149, v149
    v_fma_f32 v143, -v152, v63, v47
    v_mul_f32 v150, v134, v153
    v_rcp_f32 v146, v146
    v_mul_f32 v134, v134, v142
    v_add_f32 v147, 1.0, v147
    v_mul_f32 v136, v128, v144
    v_exp_f32 v150, v150
    v_mul_f32 v151, v135, v153
    v_rcp_f32 v147, v147
    v_mul_f32 v135, v135, v143
    v_add_f32 v148, 1.0, v148
    v_mul_f32 v137, v129, v145
    v_exp_f32 v151, v151
    v_rcp_f32 v148, v148
    v_add_f32 v149, 1.0, v149
    v_mul_f32 v138, v130, v146
    v_cvt_pk_bf16_f32 v156, v136, v137
    v_rcp_f32 v149, v149
    v_add_f32 v150, 1.0, v150
    v_mul_f32 v139, v131, v147
    v_rcp_f32 v150, v150
    v_add_f32 v151, 1.0, v151
    v_mul_f32 v140, v132, v148
    v_cvt_pk_bf16_f32 v157, v138, v139
    v_rcp_f32 v151, v151
    v_mul_f32 v141, v133, v149
    v_mul_f32 v142, v134, v150
    v_cvt_pk_bf16_f32 v158, v140, v141
    v_mul_f32 v143, v135, v151
    v_cvt_pk_bf16_f32 v159, v142, v143
    s_add_u32 s82, s79, 114688
    buffer_store_dwordx4 v[156:159], v1, s[8:11], s82 offen
    ds_read_b128 v[84:87], v7 offset:33792
    s_waitcnt lgkmcnt(4)
    v_mfma_f32_32x32x16_bf16 v[32:47], a[224:227], v[64:67], 0
    s_add_u32 s95, s94, 16384
    buffer_load_dwordx4 a[72:75], v1, s[8:11], s95 offen offset:2048
    ds_read_b64 v[152:153], v5 offset:1024
    ds_read_b128 v[88:91], v7 offset:34816
    v_mfma_f32_32x32x16_bf16 v[32:47], a[228:231], v[68:71], v[32:47]
    buffer_load_dwordx4 a[76:79], v1, s[8:11], s95 offen offset:3072
    ds_read_b128 v[64:67], v7 offset:35840
    s_waitcnt lgkmcnt(5)
    v_mfma_f32_32x32x16_bf16 v[32:47], a[232:235], v[72:75], v[32:47]
    s_waitcnt lgkmcnt(2)
    v_fma_f32 v128, -v152, v48, v16
    v_fma_f32 v136, -v152, v56, v24
    v_fma_f32 v129, -v152, v49, v17
    ds_read_b128 v[68:71], v7 offset:36864
    v_mfma_f32_32x32x16_bf16 v[32:47], a[236:239], v[76:79], v[32:47]
    s_add_u32 s95, s94, 20480
    buffer_load_dwordx4 a[80:83], v1, s[8:11], s95 offen offset:0
    ds_read_b128 v[72:75], v7 offset:37888
    v_mfma_f32_32x32x16_bf16 v[32:47], a[240:243], v[80:83], v[32:47]
    buffer_load_dwordx4 a[84:87], v1, s[8:11], s95 offen offset:1024
    ds_read_b128 v[76:79], v7 offset:38912
    v_mfma_f32_32x32x16_bf16 v[32:47], a[244:247], v[84:87], v[32:47]
    v_fma_f32 v137, -v152, v57, v25
    v_mul_f32 v144, v128, v153
    v_mul_f32 v128, v128, v136
    ds_read_b128 v[80:83], v7 offset:39936
    s_waitcnt lgkmcnt(4)
    v_mfma_f32_32x32x16_bf16 v[32:47], a[248:251], v[88:91], v[32:47]
    buffer_load_dwordx4 a[88:91], v1, s[8:11], s95 offen offset:2048
    ds_read_b128 v[84:87], v7 offset:40960
    v_mfma_f32_32x32x16_bf16 v[32:47], a[252:255], v[64:67], v[32:47]
    buffer_load_dwordx4 a[92:95], v1, s[8:11], s95 offen offset:3072
    ds_read_b128 v[88:91], v7 offset:41984
    s_waitcnt lgkmcnt(4)
    v_mfma_f32_32x32x16_bf16 v[32:47], v[176:179], v[68:71], v[32:47]
    v_fma_f32 v130, -v152, v50, v18
    v_exp_f32 v144, v144
    v_fma_f32 v138, -v152, v58, v26
    ds_read_b128 v[64:67], v7 offset:43008
    v_mfma_f32_32x32x16_bf16 v[32:47], v[180:183], v[72:75], v[32:47]
    s_add_u32 s95, s94, 24576
    buffer_load_dwordx4 a[96:99], v1, s[8:11], s95 offen offset:0
    ds_read_b128 v[68:71], v7 offset:44032
    s_waitcnt lgkmcnt(4)
    v_mfma_f32_32x32x16_bf16 v[32:47], v[184:187], v[76:79], v[32:47]
    buffer_load_dwordx4 a[100:103], v1, s[8:11], s95 offen offset:1024
    ds_read_b128 v[72:75], v7 offset:45056
    v_mfma_f32_32x32x16_bf16 v[32:47], v[188:191], v[80:83], v[32:47]
    v_mul_f32 v145, v129, v153
    v_mul_f32 v129, v129, v137
    v_fma_f32 v131, -v152, v51, v19
    ds_read_b128 v[76:79], v7 offset:46080
    s_waitcnt lgkmcnt(4)
    v_mfma_f32_32x32x16_bf16 v[32:47], v[192:195], v[84:87], v[32:47]
    buffer_load_dwordx4 a[104:107], v1, s[8:11], s95 offen offset:2048
    ds_read_b128 v[80:83], v7 offset:47104
    v_mfma_f32_32x32x16_bf16 v[32:47], v[196:199], v[88:91], v[32:47]
    v_exp_f32 v145, v145
    v_fma_f32 v139, -v152, v59, v27
    ds_read_b128 v[84:87], v7 offset:48128
    s_waitcnt lgkmcnt(4)
    v_mfma_f32_32x32x16_bf16 v[32:47], v[200:203], v[64:67], v[32:47]
    s_add_u32 s83, s85, 143360
    s_add_u32 m0, s84, 28672
    s_nop 0
    buffer_load_dwordx4 v1, s[8:11], s83 offen offset:0 sc1 lds
    ds_read_b128 v[88:91], v7 offset:49152
    v_mfma_f32_32x32x16_bf16 v[32:47], v[204:207], v[68:71], v[32:47]
    v_mul_f32 v146, v130, v153
    v_mul_f32 v130, v130, v138
    v_fma_f32 v132, -v152, v52, v20
    ds_read_b128 v[64:67], v7 offset:50176
    s_waitcnt lgkmcnt(4)
    v_mfma_f32_32x32x16_bf16 v[32:47], v[208:211], v[72:75], v[32:47]
    s_add_u32 m0, s84, 28672
    s_nop 0
    buffer_load_dwordx4 v1, s[8:11], s83 offen offset:1024 sc1 lds
    ds_read_b128 v[68:71], v7 offset:51200
    v_mfma_f32_32x32x16_bf16 v[32:47], v[212:215], v[76:79], v[32:47]
    v_exp_f32 v146, v146
    v_fma_f32 v140, -v152, v60, v28
    ds_read_b128 v[72:75], v7 offset:52224
    s_waitcnt lgkmcnt(4)
    v_mfma_f32_32x32x16_bf16 v[32:47], v[216:219], v[80:83], v[32:47]
    s_add_u32 m0, s84, 28672
    s_nop 0
    buffer_load_dwordx4 v1, s[8:11], s83 offen offset:2048 sc1 lds
    v_mul_f32 v147, v131, v153
    ds_read_b128 v[76:79], v7 offset:53248
    v_mfma_f32_32x32x16_bf16 v[32:47], v[220:223], v[84:87], v[32:47]
    v_mul_f32 v131, v131, v139
    v_add_f32 v144, 1.0, v144
    v_fma_f32 v133, -v152, v53, v21
    ds_read_b128 v[80:83], v7 offset:54272
    s_waitcnt lgkmcnt(4)
    v_mfma_f32_32x32x16_bf16 v[32:47], v[224:227], v[88:91], v[32:47]
    s_add_u32 m0, s84, 28672
    s_nop 0
    buffer_load_dwordx4 v1, s[8:11], s83 offen offset:3072 sc1 lds
    s_waitcnt vmcnt(13)
    buffer_store_dwordx2 v[10:11], v8, s[8:11], 0 offen offset:896
    ds_read_b128 v[84:87], v7 offset:55296
    v_mfma_f32_32x32x16_bf16 v[32:47], v[228:231], v[64:67], v[32:47]
    s_barrier
    v_exp_f32 v147, v147
    ds_read_b128 v[88:91], v7 offset:56320
    s_waitcnt lgkmcnt(4)
    v_mfma_f32_32x32x16_bf16 v[32:47], v[232:235], v[68:71], v[32:47]
    s_add_u32 s83, s83, 4096
    s_add_u32 m0, s84, 32768
    s_nop 0
    buffer_load_dwordx4 v1, s[8:11], s83 offen offset:0 sc1 lds
    ds_read_b128 v[64:67], v2 offset:0
    v_mfma_f32_32x32x16_bf16 v[32:47], v[236:239], v[72:75], v[32:47]
    v_fma_f32 v141, -v152, v61, v29
    v_mul_f32 v148, v132, v153
    ds_read_b128 v[68:71], v2 offset:1024
    s_waitcnt lgkmcnt(4)
    v_mfma_f32_32x32x16_bf16 v[32:47], v[240:243], v[76:79], v[32:47]
    s_add_u32 m0, s84, 32768
    s_nop 0
    buffer_load_dwordx4 v1, s[8:11], s83 offen offset:1024 sc1 lds
    ds_read_b128 v[72:75], v2 offset:2048
    v_mfma_f32_32x32x16_bf16 v[32:47], v[244:247], v[80:83], v[32:47]
    v_rcp_f32 v144, v144
    v_mul_f32 v132, v132, v140
    ds_read_b128 v[76:79], v2 offset:3072
    s_waitcnt lgkmcnt(4)
    v_mfma_f32_32x32x16_bf16 v[32:47], v[248:251], v[84:87], v[32:47]
    s_add_u32 m0, s84, 32768
    s_nop 0
    buffer_load_dwordx4 v1, s[8:11], s83 offen offset:2048 sc1 lds
    v_add_f32 v145, 1.0, v145
    ds_read_b128 v[80:83], v2 offset:4096
    v_mfma_f32_32x32x16_bf16 v[32:47], v[252:255], v[88:91], v[32:47]
    v_fma_f32 v134, -v152, v54, v22
    v_exp_f32 v148, v148
    v_fma_f32 v142, -v152, v62, v30
    v_mul_f32 v149, v133, v153
    v_rcp_f32 v145, v145
    v_mul_f32 v133, v133, v141
    v_add_f32 v146, 1.0, v146
    v_fma_f32 v135, -v152, v55, v23
    v_exp_f32 v149, v149
    v_fma_f32 v143, -v152, v63, v31
    v_mul_f32 v150, v134, v153
    v_rcp_f32 v146, v146
    v_mul_f32 v134, v134, v142
    v_add_f32 v147, 1.0, v147
    v_mul_f32 v136, v128, v144
    v_exp_f32 v150, v150
    v_mul_f32 v151, v135, v153
    v_rcp_f32 v147, v147
    v_mul_f32 v135, v135, v143
    v_add_f32 v148, 1.0, v148
    v_mul_f32 v137, v129, v145
    v_exp_f32 v151, v151
    v_rcp_f32 v148, v148
    v_add_f32 v149, 1.0, v149
    v_mul_f32 v138, v130, v146
    v_cvt_pk_bf16_f32 v156, v136, v137
    v_rcp_f32 v149, v149
    v_add_f32 v150, 1.0, v150
    v_mul_f32 v139, v131, v147
    v_rcp_f32 v150, v150
    v_add_f32 v151, 1.0, v151
    v_mul_f32 v140, v132, v148
    v_cvt_pk_bf16_f32 v157, v138, v139
    v_rcp_f32 v151, v151
    v_mul_f32 v141, v133, v149
    v_mul_f32 v142, v134, v150
    v_cvt_pk_bf16_f32 v158, v140, v141
    v_mul_f32 v143, v135, v151
    v_cvt_pk_bf16_f32 v159, v142, v143
    s_add_u32 s82, s79, 229376
    buffer_store_dwordx4 v[156:159], v1, s[8:11], s82 offen
    ds_read_b128 v[84:87], v2 offset:5120
    s_waitcnt lgkmcnt(4)
    v_mfma_f32_32x32x16_bf16 v[16:31], a[224:227], v[64:67], 0
    s_add_u32 s95, s94, 24576
    buffer_load_dwordx4 a[108:111], v1, s[8:11], s95 offen offset:3072
    ds_read_b64 v[152:153], v5 offset:1536
    ds_read_b128 v[88:91], v2 offset:6144
    v_mfma_f32_32x32x16_bf16 v[16:31], a[228:231], v[68:71], v[16:31]
    s_add_u32 s95, s94, 28672
    buffer_load_dwordx4 a[112:115], v1, s[8:11], s95 offen offset:0
    ds_read_b128 v[64:67], v2 offset:7168
    s_waitcnt lgkmcnt(5)
    v_mfma_f32_32x32x16_bf16 v[16:31], a[232:235], v[72:75], v[16:31]
    s_waitcnt lgkmcnt(2)
    v_fma_f32 v128, -v152, v48, v32
    v_fma_f32 v136, -v152, v56, v40
    v_fma_f32 v129, -v152, v49, v33
    ds_read_b128 v[68:71], v2 offset:8192
    v_mfma_f32_32x32x16_bf16 v[16:31], a[236:239], v[76:79], v[16:31]
    buffer_load_dwordx4 a[116:119], v1, s[8:11], s95 offen offset:1024
    ds_read_b128 v[72:75], v2 offset:9216
    v_mfma_f32_32x32x16_bf16 v[16:31], a[240:243], v[80:83], v[16:31]
    buffer_load_dwordx4 a[120:123], v1, s[8:11], s95 offen offset:2048
    ds_read_b128 v[76:79], v2 offset:10240
    v_mfma_f32_32x32x16_bf16 v[16:31], a[244:247], v[84:87], v[16:31]
    v_fma_f32 v137, -v152, v57, v41
    v_mul_f32 v144, v128, v153
    v_mul_f32 v128, v128, v136
    ds_read_b128 v[80:83], v2 offset:11264
    s_waitcnt lgkmcnt(4)
    v_mfma_f32_32x32x16_bf16 v[16:31], a[248:251], v[88:91], v[16:31]
    buffer_load_dwordx4 a[124:127], v1, s[8:11], s95 offen offset:3072
    ds_read_b128 v[84:87], v2 offset:12288
    v_mfma_f32_32x32x16_bf16 v[16:31], a[252:255], v[64:67], v[16:31]
    s_add_u32 s95, s94, 32768
    buffer_load_dwordx4 a[128:131], v1, s[8:11], s95 offen offset:0
    ds_read_b128 v[88:91], v2 offset:13312
    s_waitcnt lgkmcnt(4)
    v_mfma_f32_32x32x16_bf16 v[16:31], v[176:179], v[68:71], v[16:31]
    v_fma_f32 v130, -v152, v50, v34
    v_exp_f32 v144, v144
    v_fma_f32 v138, -v152, v58, v42
    ds_read_b128 v[64:67], v2 offset:14336
    v_mfma_f32_32x32x16_bf16 v[16:31], v[180:183], v[72:75], v[16:31]
    buffer_load_dwordx4 a[132:135], v1, s[8:11], s95 offen offset:1024
    ds_read_b128 v[68:71], v2 offset:15360
    s_waitcnt lgkmcnt(4)
    v_mfma_f32_32x32x16_bf16 v[16:31], v[184:187], v[76:79], v[16:31]
    buffer_load_dwordx4 a[136:139], v1, s[8:11], s95 offen offset:2048
    ds_read_b128 v[72:75], v2 offset:16384
    v_mfma_f32_32x32x16_bf16 v[16:31], v[188:191], v[80:83], v[16:31]
    v_mul_f32 v145, v129, v153
    v_mul_f32 v129, v129, v137
    v_fma_f32 v131, -v152, v51, v35
    ds_read_b128 v[76:79], v2 offset:17408
    s_waitcnt lgkmcnt(4)
    v_mfma_f32_32x32x16_bf16 v[16:31], v[192:195], v[84:87], v[16:31]
    buffer_load_dwordx4 a[140:143], v1, s[8:11], s95 offen offset:3072
    ds_read_b128 v[80:83], v2 offset:18432
    v_mfma_f32_32x32x16_bf16 v[16:31], v[196:199], v[88:91], v[16:31]
    v_exp_f32 v145, v145
    v_fma_f32 v139, -v152, v59, v43
    ds_read_b128 v[84:87], v2 offset:19456
    s_waitcnt lgkmcnt(4)
    v_mfma_f32_32x32x16_bf16 v[16:31], v[200:203], v[64:67], v[16:31]
    s_add_u32 s83, s85, 172032
    s_add_u32 m0, s84, 57344
    s_nop 0
    buffer_load_dwordx4 v1, s[8:11], s83 offen offset:0 sc1 lds
    ds_read_b128 v[88:91], v2 offset:20480
    v_mfma_f32_32x32x16_bf16 v[16:31], v[204:207], v[68:71], v[16:31]
    v_mul_f32 v146, v130, v153
    v_mul_f32 v130, v130, v138
    v_fma_f32 v132, -v152, v52, v36
    ds_read_b128 v[64:67], v2 offset:21504
    s_waitcnt lgkmcnt(4)
    v_mfma_f32_32x32x16_bf16 v[16:31], v[208:211], v[72:75], v[16:31]
    s_add_u32 m0, s84, 57344
    s_nop 0
    buffer_load_dwordx4 v1, s[8:11], s83 offen offset:1024 sc1 lds
    ds_read_b128 v[68:71], v2 offset:22528
    v_mfma_f32_32x32x16_bf16 v[16:31], v[212:215], v[76:79], v[16:31]
    v_exp_f32 v146, v146
    v_fma_f32 v140, -v152, v60, v44
    ds_read_b128 v[72:75], v2 offset:23552
    s_waitcnt lgkmcnt(4)
    v_mfma_f32_32x32x16_bf16 v[16:31], v[216:219], v[80:83], v[16:31]
    s_add_u32 m0, s84, 57344
    s_nop 0
    buffer_load_dwordx4 v1, s[8:11], s83 offen offset:2048 sc1 lds
    v_mul_f32 v147, v131, v153
    ds_read_b128 v[76:79], v2 offset:24576
    v_mfma_f32_32x32x16_bf16 v[16:31], v[220:223], v[84:87], v[16:31]
    v_mul_f32 v131, v131, v139
    v_add_f32 v144, 1.0, v144
    v_fma_f32 v133, -v152, v53, v37
    ds_read_b128 v[80:83], v2 offset:25600
    s_waitcnt lgkmcnt(4)
    v_mfma_f32_32x32x16_bf16 v[16:31], v[224:227], v[88:91], v[16:31]
    s_add_u32 m0, s84, 57344
    s_nop 0
    buffer_load_dwordx4 v1, s[8:11], s83 offen offset:3072 sc1 lds
    s_waitcnt vmcnt(13)
    buffer_store_dwordx2 v[10:11], v8, s[8:11], 0 offen offset:1792
    ds_read_b128 v[84:87], v2 offset:26624
    v_mfma_f32_32x32x16_bf16 v[16:31], v[228:231], v[64:67], v[16:31]
    s_barrier
    v_exp_f32 v147, v147
    ds_read_b128 v[88:91], v2 offset:27648
    s_waitcnt lgkmcnt(4)
    v_mfma_f32_32x32x16_bf16 v[16:31], v[232:235], v[68:71], v[16:31]
    s_add_u32 s83, s83, 4096
    s_add_u32 m0, s84, 61440
    s_nop 0
    buffer_load_dwordx4 v1, s[8:11], s83 offen offset:0 sc1 lds
    ds_read_b128 v[64:67], v2 offset:28672
    v_mfma_f32_32x32x16_bf16 v[16:31], v[236:239], v[72:75], v[16:31]
    v_fma_f32 v141, -v152, v61, v45
    v_mul_f32 v148, v132, v153
    ds_read_b128 v[68:71], v2 offset:29696
    s_waitcnt lgkmcnt(4)
    v_mfma_f32_32x32x16_bf16 v[16:31], v[240:243], v[76:79], v[16:31]
    s_add_u32 m0, s84, 61440
    s_nop 0
    buffer_load_dwordx4 v1, s[8:11], s83 offen offset:1024 sc1 lds
    ds_read_b128 v[72:75], v2 offset:30720
    v_mfma_f32_32x32x16_bf16 v[16:31], v[244:247], v[80:83], v[16:31]
    v_rcp_f32 v144, v144
    v_mul_f32 v132, v132, v140
    ds_read_b128 v[76:79], v2 offset:31744
    s_waitcnt lgkmcnt(4)
    v_mfma_f32_32x32x16_bf16 v[16:31], v[248:251], v[84:87], v[16:31]
    s_add_u32 m0, s84, 61440
    s_nop 0
    buffer_load_dwordx4 v1, s[8:11], s83 offen offset:2048 sc1 lds
    v_add_f32 v145, 1.0, v145
    ds_read_b128 v[80:83], v2 offset:32768
    v_mfma_f32_32x32x16_bf16 v[16:31], v[252:255], v[88:91], v[16:31]
    v_fma_f32 v134, -v152, v54, v38
    v_exp_f32 v148, v148
    v_fma_f32 v142, -v152, v62, v46
    v_mul_f32 v149, v133, v153
    v_rcp_f32 v145, v145
    v_mul_f32 v133, v133, v141
    v_add_f32 v146, 1.0, v146
    v_fma_f32 v135, -v152, v55, v39
    v_exp_f32 v149, v149
    v_fma_f32 v143, -v152, v63, v47
    v_mul_f32 v150, v134, v153
    v_rcp_f32 v146, v146
    v_mul_f32 v134, v134, v142
    v_add_f32 v147, 1.0, v147
    v_mul_f32 v136, v128, v144
    v_exp_f32 v150, v150
    v_mul_f32 v151, v135, v153
    v_rcp_f32 v147, v147
    v_mul_f32 v135, v135, v143
    v_add_f32 v148, 1.0, v148
    v_mul_f32 v137, v129, v145
    v_exp_f32 v151, v151
    v_rcp_f32 v148, v148
    v_add_f32 v149, 1.0, v149
    v_mul_f32 v138, v130, v146
    v_cvt_pk_bf16_f32 v156, v136, v137
    v_rcp_f32 v149, v149
    v_add_f32 v150, 1.0, v150
    v_mul_f32 v139, v131, v147
    v_rcp_f32 v150, v150
    v_add_f32 v151, 1.0, v151
    v_mul_f32 v140, v132, v148
    v_cvt_pk_bf16_f32 v157, v138, v139
    v_rcp_f32 v151, v151
    v_mul_f32 v141, v133, v149
    v_mul_f32 v142, v134, v150
    v_cvt_pk_bf16_f32 v158, v140, v141
    v_mul_f32 v143, v135, v151
    v_cvt_pk_bf16_f32 v159, v142, v143
    s_add_u32 s82, s79, 344064
    buffer_store_dwordx4 v[156:159], v1, s[8:11], s82 offen
    ds_read_b128 v[84:87], v2 offset:33792
    s_waitcnt lgkmcnt(4)
    v_mfma_f32_32x32x16_bf16 v[32:47], a[224:227], v[64:67], 0
    s_add_u32 s95, s94, 36864
    buffer_load_dwordx4 a[144:147], v1, s[8:11], s95 offen offset:0
    ds_read_b64 v[152:153], v5 offset:2048
    ds_read_b128 v[88:91], v2 offset:34816
    v_mfma_f32_32x32x16_bf16 v[32:47], a[228:231], v[68:71], v[32:47]
    buffer_load_dwordx4 a[148:151], v1, s[8:11], s95 offen offset:1024
    ds_read_b128 v[64:67], v2 offset:35840
    s_waitcnt lgkmcnt(5)
    v_mfma_f32_32x32x16_bf16 v[32:47], a[232:235], v[72:75], v[32:47]
    buffer_load_dwordx4 a[152:155], v1, s[8:11], s95 offen offset:2048
    ds_read_b128 v[68:71], v2 offset:36864
    v_mfma_f32_32x32x16_bf16 v[32:47], a[236:239], v[76:79], v[32:47]
    s_waitcnt lgkmcnt(3)
    v_fma_f32 v128, -v152, v48, v16
    v_fma_f32 v136, -v152, v56, v24
    ds_read_b128 v[72:75], v2 offset:37888
    v_mfma_f32_32x32x16_bf16 v[32:47], a[240:243], v[80:83], v[32:47]
    buffer_load_dwordx4 a[156:159], v1, s[8:11], s95 offen offset:3072
    ds_read_b128 v[76:79], v2 offset:38912
    v_mfma_f32_32x32x16_bf16 v[32:47], a[244:247], v[84:87], v[32:47]
    s_add_u32 s95, s94, 40960
    buffer_load_dwordx4 a[160:163], v1, s[8:11], s95 offen offset:0
    ds_read_b128 v[80:83], v2 offset:39936
    s_waitcnt lgkmcnt(4)
    v_mfma_f32_32x32x16_bf16 v[32:47], a[248:251], v[88:91], v[32:47]
    v_fma_f32 v129, -v152, v49, v17
    v_fma_f32 v137, -v152, v57, v25
    v_mul_f32 v144, v128, v153
    v_mul_f32 v128, v128, v136
    ds_read_b128 v[84:87], v2 offset:40960
    v_mfma_f32_32x32x16_bf16 v[32:47], a[252:255], v[64:67], v[32:47]
    buffer_load_dwordx4 a[164:167], v1, s[8:11], s95 offen offset:1024
    ds_read_b128 v[88:91], v2 offset:41984
    s_waitcnt lgkmcnt(4)
    v_mfma_f32_32x32x16_bf16 v[32:47], v[176:179], v[68:71], v[32:47]
    buffer_load_dwordx4 a[168:171], v1, s[8:11], s95 offen offset:2048
    ds_read_b128 v[64:67], v2 offset:43008
    v_mfma_f32_32x32x16_bf16 v[32:47], v[180:183], v[72:75], v[32:47]
    buffer_load_dwordx4 a[172:175], v1, s[8:11], s95 offen offset:3072
    ds_read_b128 v[68:71], v2 offset:44032
    s_waitcnt lgkmcnt(4)
    v_mfma_f32_32x32x16_bf16 v[32:47], v[184:187], v[76:79], v[32:47]
    v_fma_f32 v130, -v152, v50, v18
    v_exp_f32 v144, v144
    v_fma_f32 v138, -v152, v58, v26
    ds_read_b128 v[72:75], v2 offset:45056
    v_mfma_f32_32x32x16_bf16 v[32:47], v[188:191], v[80:83], v[32:47]
    s_add_u32 s95, s94, 45056
    buffer_load_dwordx4 a[176:179], v1, s[8:11], s95 offen offset:0
    ds_read_b128 v[76:79], v2 offset:46080
    s_waitcnt lgkmcnt(4)
    v_mfma_f32_32x32x16_bf16 v[32:47], v[192:195], v[84:87], v[32:47]
    buffer_load_dwordx4 a[180:183], v1, s[8:11], s95 offen offset:1024
    ds_read_b128 v[80:83], v2 offset:47104
    v_mfma_f32_32x32x16_bf16 v[32:47], v[196:199], v[88:91], v[32:47]
    v_mul_f32 v145, v129, v153
    v_mul_f32 v129, v129, v137
    v_fma_f32 v131, -v152, v51, v19
    ds_read_b128 v[84:87], v2 offset:48128
    s_waitcnt lgkmcnt(4)
    v_mfma_f32_32x32x16_bf16 v[32:47], v[200:203], v[64:67], v[32:47]
    s_add_u32 s83, s85, 200704
    s_add_u32 m0, s84, 86016
    s_nop 0
    buffer_load_dwordx4 v1, s[8:11], s83 offen offset:0 sc1 lds
    ds_read_b128 v[88:91], v2 offset:49152
    v_mfma_f32_32x32x16_bf16 v[32:47], v[204:207], v[68:71], v[32:47]
    v_exp_f32 v145, v145
    v_fma_f32 v139, -v152, v59, v27
    ds_read_b128 v[64:67], v2 offset:50176
    s_waitcnt lgkmcnt(4)
    v_mfma_f32_32x32x16_bf16 v[32:47], v[208:211], v[72:75], v[32:47]
    s_add_u32 m0, s84, 86016
    s_nop 0
    buffer_load_dwordx4 v1, s[8:11], s83 offen offset:1024 sc1 lds
    v_mul_f32 v146, v130, v153
    ds_read_b128 v[68:71], v2 offset:51200
    v_mfma_f32_32x32x16_bf16 v[32:47], v[212:215], v[76:79], v[32:47]
    v_mul_f32 v130, v130, v138
    v_fma_f32 v132, -v152, v52, v20
    ds_read_b128 v[72:75], v2 offset:52224
    s_waitcnt lgkmcnt(4)
    v_mfma_f32_32x32x16_bf16 v[32:47], v[216:219], v[80:83], v[32:47]
    s_add_u32 m0, s84, 86016
    s_nop 0
    buffer_load_dwordx4 v1, s[8:11], s83 offen offset:2048 sc1 lds
    ds_read_b128 v[76:79], v2 offset:53248
    v_mfma_f32_32x32x16_bf16 v[32:47], v[220:223], v[84:87], v[32:47]
    v_exp_f32 v146, v146
    v_fma_f32 v140, -v152, v60, v28
    ds_read_b128 v[80:83], v2 offset:54272
    s_waitcnt lgkmcnt(4)
    v_mfma_f32_32x32x16_bf16 v[32:47], v[224:227], v[88:91], v[32:47]
    s_add_u32 m0, s84, 86016
    s_nop 0
    buffer_load_dwordx4 v1, s[8:11], s83 offen offset:3072 sc1 lds
    s_waitcnt vmcnt(14)
    buffer_store_dwordx2 v[10:11], v8, s[8:11], 0 offen offset:2688
    ds_read_b128 v[84:87], v2 offset:55296
    v_mfma_f32_32x32x16_bf16 v[32:47], v[228:231], v[64:67], v[32:47]
    s_barrier
    v_mul_f32 v147, v131, v153
    v_mul_f32 v131, v131, v139
    ds_read_b128 v[88:91], v2 offset:56320
    s_waitcnt lgkmcnt(4)
    v_mfma_f32_32x32x16_bf16 v[32:47], v[232:235], v[68:71], v[32:47]
    s_add_u32 s83, s83, 4096
    s_add_u32 m0, s84, 90112
    s_nop 0
    buffer_load_dwordx4 v1, s[8:11], s83 offen offset:0 sc1 lds
    ds_read_b128 v[64:67], v7 offset:0
    v_mfma_f32_32x32x16_bf16 v[32:47], v[236:239], v[72:75], v[32:47]
    v_add_f32 v144, 1.0, v144
    v_fma_f32 v133, -v152, v53, v21
    ds_read_b128 v[68:71], v7 offset:1024
    s_waitcnt lgkmcnt(4)
    v_mfma_f32_32x32x16_bf16 v[32:47], v[240:243], v[76:79], v[32:47]
    s_add_u32 m0, s84, 90112
    s_nop 0
    buffer_load_dwordx4 v1, s[8:11], s83 offen offset:1024 sc1 lds
    ds_read_b128 v[72:75], v7 offset:2048
    v_mfma_f32_32x32x16_bf16 v[32:47], v[244:247], v[80:83], v[32:47]
    v_exp_f32 v147, v147
    v_fma_f32 v141, -v152, v61, v29
    ds_read_b128 v[76:79], v7 offset:3072
    s_waitcnt lgkmcnt(4)
    v_mfma_f32_32x32x16_bf16 v[32:47], v[248:251], v[84:87], v[32:47]
    s_add_u32 m0, s84, 90112
    s_nop 0
    buffer_load_dwordx4 v1, s[8:11], s83 offen offset:2048 sc1 lds
    v_mul_f32 v148, v132, v153
    ds_read_b128 v[80:83], v7 offset:4096
    v_mfma_f32_32x32x16_bf16 v[32:47], v[252:255], v[88:91], v[32:47]
    v_rcp_f32 v144, v144
    v_mul_f32 v132, v132, v140
    v_add_f32 v145, 1.0, v145
    v_fma_f32 v134, -v152, v54, v22
    v_exp_f32 v148, v148
    v_fma_f32 v142, -v152, v62, v30
    v_mul_f32 v149, v133, v153
    v_rcp_f32 v145, v145
    v_mul_f32 v133, v133, v141
    v_add_f32 v146, 1.0, v146
    v_fma_f32 v135, -v152, v55, v23
    v_exp_f32 v149, v149
    v_fma_f32 v143, -v152, v63, v31
    v_mul_f32 v150, v134, v153
    v_rcp_f32 v146, v146
    v_mul_f32 v134, v134, v142
    v_add_f32 v147, 1.0, v147
    v_mul_f32 v136, v128, v144
    v_exp_f32 v150, v150
    v_mul_f32 v151, v135, v153
    v_rcp_f32 v147, v147
    v_mul_f32 v135, v135, v143
    v_add_f32 v148, 1.0, v148
    v_mul_f32 v137, v129, v145
    v_exp_f32 v151, v151
    v_rcp_f32 v148, v148
    v_add_f32 v149, 1.0, v149
    v_mul_f32 v138, v130, v146
    v_cvt_pk_bf16_f32 v156, v136, v137
    v_rcp_f32 v149, v149
    v_add_f32 v150, 1.0, v150
    v_mul_f32 v139, v131, v147
    v_rcp_f32 v150, v150
    v_add_f32 v151, 1.0, v151
    v_mul_f32 v140, v132, v148
    v_cvt_pk_bf16_f32 v157, v138, v139
    v_rcp_f32 v151, v151
    v_mul_f32 v141, v133, v149
    v_mul_f32 v142, v134, v150
    v_cvt_pk_bf16_f32 v158, v140, v141
    v_mul_f32 v143, v135, v151
    v_cvt_pk_bf16_f32 v159, v142, v143
    s_add_u32 s82, s79, 458752
    buffer_store_dwordx4 v[156:159], v1, s[8:11], s82 offen
    ds_read_b128 v[84:87], v7 offset:5120
    s_waitcnt lgkmcnt(4)
    v_mfma_f32_32x32x16_bf16 v[16:31], a[224:227], v[64:67], 0
    s_add_u32 s95, s94, 45056
    buffer_load_dwordx4 a[184:187], v1, s[8:11], s95 offen offset:2048
    ds_read_b64 v[152:153], v5 offset:2560
    ds_read_b128 v[88:91], v7 offset:6144
    v_mfma_f32_32x32x16_bf16 v[16:31], a[228:231], v[68:71], v[16:31]
    buffer_load_dwordx4 a[188:191], v1, s[8:11], s95 offen offset:3072
    ds_read_b128 v[64:67], v7 offset:7168
    s_waitcnt lgkmcnt(5)
    v_mfma_f32_32x32x16_bf16 v[16:31], a[232:235], v[72:75], v[16:31]
    s_add_u32 s95, s94, 49152
    buffer_load_dwordx4 a[192:195], v1, s[8:11], s95 offen offset:0
    ds_read_b128 v[68:71], v7 offset:8192
    v_mfma_f32_32x32x16_bf16 v[16:31], a[236:239], v[76:79], v[16:31]
    s_waitcnt lgkmcnt(3)
    v_fma_f32 v128, -v152, v48, v32
    v_fma_f32 v136, -v152, v56, v40
    ds_read_b128 v[72:75], v7 offset:9216
    v_mfma_f32_32x32x16_bf16 v[16:31], a[240:243], v[80:83], v[16:31]
    buffer_load_dwordx4 a[196:199], v1, s[8:11], s95 offen offset:1024
    ds_read_b128 v[76:79], v7 offset:10240
    v_mfma_f32_32x32x16_bf16 v[16:31], a[244:247], v[84:87], v[16:31]
    buffer_load_dwordx4 a[200:203], v1, s[8:11], s95 offen offset:2048
    ds_read_b128 v[80:83], v7 offset:11264
    s_waitcnt lgkmcnt(4)
    v_mfma_f32_32x32x16_bf16 v[16:31], a[248:251], v[88:91], v[16:31]
    v_fma_f32 v129, -v152, v49, v33
    v_fma_f32 v137, -v152, v57, v41
    v_mul_f32 v144, v128, v153
    v_mul_f32 v128, v128, v136
    ds_read_b128 v[84:87], v7 offset:12288
    v_mfma_f32_32x32x16_bf16 v[16:31], a[252:255], v[64:67], v[16:31]
    buffer_load_dwordx4 a[204:207], v1, s[8:11], s95 offen offset:3072
    ds_read_b128 v[88:91], v7 offset:13312
    s_waitcnt lgkmcnt(4)
    v_mfma_f32_32x32x16_bf16 v[16:31], v[176:179], v[68:71], v[16:31]
    s_add_u32 s95, s94, 53248
    buffer_load_dwordx4 a[208:211], v1, s[8:11], s95 offen offset:0
    ds_read_b128 v[64:67], v7 offset:14336
    v_mfma_f32_32x32x16_bf16 v[16:31], v[180:183], v[72:75], v[16:31]
    buffer_load_dwordx4 a[212:215], v1, s[8:11], s95 offen offset:1024
    ds_read_b128 v[68:71], v7 offset:15360
    s_waitcnt lgkmcnt(4)
    v_mfma_f32_32x32x16_bf16 v[16:31], v[184:187], v[76:79], v[16:31]
    v_fma_f32 v130, -v152, v50, v34
    v_exp_f32 v144, v144
    v_fma_f32 v138, -v152, v58, v42
    ds_read_b128 v[72:75], v7 offset:16384
    v_mfma_f32_32x32x16_bf16 v[16:31], v[188:191], v[80:83], v[16:31]
    buffer_load_dwordx4 a[216:219], v1, s[8:11], s95 offen offset:2048
    ds_read_b128 v[76:79], v7 offset:17408
    s_waitcnt lgkmcnt(4)
    v_mfma_f32_32x32x16_bf16 v[16:31], v[192:195], v[84:87], v[16:31]
    buffer_load_dwordx4 a[220:223], v1, s[8:11], s95 offen offset:3072
    ds_read_b128 v[80:83], v7 offset:18432
    v_mfma_f32_32x32x16_bf16 v[16:31], v[196:199], v[88:91], v[16:31]
    v_mul_f32 v145, v129, v153
    v_mul_f32 v129, v129, v137
    v_fma_f32 v131, -v152, v51, v35
    ds_read_b128 v[84:87], v7 offset:19456
    s_waitcnt lgkmcnt(4)
    v_mfma_f32_32x32x16_bf16 v[16:31], v[200:203], v[64:67], v[16:31]
    v_exp_f32 v145, v145
    v_fma_f32 v139, -v152, v59, v43
    v_mul_f32 v146, v130, v153
    ds_read_b128 v[88:91], v7 offset:20480
    v_mfma_f32_32x32x16_bf16 v[16:31], v[204:207], v[68:71], v[16:31]
    v_mul_f32 v130, v130, v138
    v_fma_f32 v132, -v152, v52, v36
    ds_read_b128 v[64:67], v7 offset:21504
    s_waitcnt lgkmcnt(4)
    v_mfma_f32_32x32x16_bf16 v[16:31], v[208:211], v[72:75], v[16:31]
    v_exp_f32 v146, v146
    v_fma_f32 v140, -v152, v60, v44
    v_mul_f32 v147, v131, v153
    ds_read_b128 v[68:71], v7 offset:22528
    v_mfma_f32_32x32x16_bf16 v[16:31], v[212:215], v[76:79], v[16:31]
    v_mul_f32 v131, v131, v139
    v_add_f32 v144, 1.0, v144
    v_fma_f32 v133, -v152, v53, v37
    ds_read_b128 v[72:75], v7 offset:23552
    s_waitcnt lgkmcnt(4)
    v_mfma_f32_32x32x16_bf16 v[16:31], v[216:219], v[80:83], v[16:31]
    v_exp_f32 v147, v147
    v_fma_f32 v141, -v152, v61, v45
    v_mul_f32 v148, v132, v153
    ds_read_b128 v[76:79], v7 offset:24576
    v_mfma_f32_32x32x16_bf16 v[16:31], v[220:223], v[84:87], v[16:31]
    v_rcp_f32 v144, v144
    v_mul_f32 v132, v132, v140
    ds_read_b128 v[80:83], v7 offset:25600
    s_waitcnt lgkmcnt(4)
    v_mfma_f32_32x32x16_bf16 v[16:31], v[224:227], v[88:91], v[16:31]
    s_waitcnt vmcnt(10)
    buffer_store_dwordx2 v[10:11], v9, s[8:11], 0 offen offset:0
    ds_read_b128 v[84:87], v7 offset:26624
    v_mfma_f32_32x32x16_bf16 v[16:31], v[228:231], v[64:67], v[16:31]
    s_barrier
    v_add_f32 v145, 1.0, v145
    v_fma_f32 v134, -v152, v54, v38
    ds_read_b128 v[88:91], v7 offset:27648
    s_waitcnt lgkmcnt(4)
    v_mfma_f32_32x32x16_bf16 v[16:31], v[232:235], v[68:71], v[16:31]
    v_exp_f32 v148, v148
    v_fma_f32 v142, -v152, v62, v46
    v_mul_f32 v149, v133, v153
    ds_read_b128 v[64:67], v7 offset:28672
    v_mfma_f32_32x32x16_bf16 v[16:31], v[236:239], v[72:75], v[16:31]
    v_rcp_f32 v145, v145
    v_mul_f32 v133, v133, v141
    ds_read_b128 v[68:71], v7 offset:29696
    s_waitcnt lgkmcnt(4)
    v_mfma_f32_32x32x16_bf16 v[16:31], v[240:243], v[76:79], v[16:31]
    v_add_f32 v146, 1.0, v146
    v_fma_f32 v135, -v152, v55, v39
    v_exp_f32 v149, v149
    ds_read_b128 v[72:75], v7 offset:30720
    v_mfma_f32_32x32x16_bf16 v[16:31], v[244:247], v[80:83], v[16:31]
    v_fma_f32 v143, -v152, v63, v47
    v_mul_f32 v150, v134, v153
    ds_read_b128 v[76:79], v7 offset:31744
    s_waitcnt lgkmcnt(4)
    v_mfma_f32_32x32x16_bf16 v[16:31], v[248:251], v[84:87], v[16:31]
    v_rcp_f32 v146, v146
    v_mul_f32 v134, v134, v142
    v_add_f32 v147, 1.0, v147
    ds_read_b128 v[80:83], v7 offset:32768
    v_mfma_f32_32x32x16_bf16 v[16:31], v[252:255], v[88:91], v[16:31]
    v_mul_f32 v136, v128, v144
    v_exp_f32 v150, v150
    v_mul_f32 v151, v135, v153
    v_rcp_f32 v147, v147
    v_mul_f32 v135, v135, v143
    v_add_f32 v148, 1.0, v148
    v_mul_f32 v137, v129, v145
    v_exp_f32 v151, v151
    v_rcp_f32 v148, v148
    v_add_f32 v149, 1.0, v149
    v_mul_f32 v138, v130, v146
    v_cvt_pk_bf16_f32 v156, v136, v137
    v_rcp_f32 v149, v149
    v_add_f32 v150, 1.0, v150
    v_mul_f32 v139, v131, v147
    v_rcp_f32 v150, v150
    v_add_f32 v151, 1.0, v151
    v_mul_f32 v140, v132, v148
    v_cvt_pk_bf16_f32 v157, v138, v139
    v_rcp_f32 v151, v151
    v_mul_f32 v141, v133, v149
    v_mul_f32 v142, v134, v150
    v_cvt_pk_bf16_f32 v158, v140, v141
    v_mul_f32 v143, v135, v151
    v_cvt_pk_bf16_f32 v159, v142, v143
    s_add_u32 s82, s79, 573440
    buffer_store_dwordx4 v[156:159], v1, s[8:11], s82 offen
    ds_read_b128 v[84:87], v7 offset:33792
    s_waitcnt lgkmcnt(4)
    v_mfma_f32_32x32x16_bf16 v[32:47], a[224:227], v[64:67], 0
    ds_read_b64 v[152:153], v5 offset:3072
    ds_read_b128 v[88:91], v7 offset:34816
    v_mfma_f32_32x32x16_bf16 v[32:47], a[228:231], v[68:71], v[32:47]
    s_add_u32 s82, s76, s67
    s_mul_i32 s82, s82, 112
    s_mul_i32 s83, s36, 28
    s_add_u32 s82, s82, s83
    s_lshl_b32 s83, s82, 3
    s_add_u32 s83, s83, s74
    v_min_u32 v3, 27, v0
    v_lshlrev_b32 v3, 3, v3
    v_add_u32 v3, s83, v3
    s_lshl_b32 s94, s82, 10
    s_add_u32 s94, s94, s72
    buffer_load_dwordx2 v[168:169], v3, s[8:11], 0 offen sc1
    ds_read_b128 v[64:67], v7 offset:35840
    s_waitcnt lgkmcnt(5)
    v_mfma_f32_32x32x16_bf16 v[32:47], a[232:235], v[72:75], v[32:47]
    s_waitcnt lgkmcnt(2)
    v_fma_f32 v128, -v152, v48, v16
    v_fma_f32 v136, -v152, v56, v24
    v_fma_f32 v129, -v152, v49, v17
    ds_read_b128 v[68:71], v7 offset:36864
    v_mfma_f32_32x32x16_bf16 v[32:47], a[236:239], v[76:79], v[32:47]
    v_fma_f32 v137, -v152, v57, v25
    v_mul_f32 v144, v128, v153
    v_mul_f32 v128, v128, v136
    ds_read_b128 v[72:75], v7 offset:37888
    v_mfma_f32_32x32x16_bf16 v[32:47], a[240:243], v[80:83], v[32:47]
    v_fma_f32 v130, -v152, v50, v18
    v_exp_f32 v144, v144
    v_fma_f32 v138, -v152, v58, v26
    ds_read_b128 v[76:79], v7 offset:38912
    v_mfma_f32_32x32x16_bf16 v[32:47], a[244:247], v[84:87], v[32:47]
    v_mul_f32 v145, v129, v153
    v_mul_f32 v129, v129, v137
    v_fma_f32 v131, -v152, v51, v19
    s_add_u32 s82, s76, s67
    s_add_u32 s82, s82, 4
    s_mul_i32 s82, s82, 112
    s_mul_i32 s83, s36, 28
    s_add_u32 s82, s82, s83
    s_lshl_b32 s83, s82, 3
    s_add_u32 s83, s83, s74
    v_min_u32 v4, 27, v0
    v_lshlrev_b32 v4, 3, v4
    v_add_u32 v4, s83, v4
    s_lshl_b32 s95, s82, 10
    s_add_u32 s95, s95, s72
    ds_read_b128 v[80:83], v7 offset:39936
    s_waitcnt lgkmcnt(4)
    v_mfma_f32_32x32x16_bf16 v[32:47], a[248:251], v[88:91], v[32:47]
    v_exp_f32 v145, v145
    v_fma_f32 v139, -v152, v59, v27
    v_mul_f32 v146, v130, v153
    ds_read_b128 v[84:87], v7 offset:40960
    v_mfma_f32_32x32x16_bf16 v[32:47], a[252:255], v[64:67], v[32:47]
    v_mul_f32 v130, v130, v138
    v_fma_f32 v132, -v152, v52, v20
    ds_read_b128 v[88:91], v7 offset:41984
    s_waitcnt lgkmcnt(4)
    v_mfma_f32_32x32x16_bf16 v[32:47], v[176:179], v[68:71], v[32:47]
    v_exp_f32 v146, v146
    v_fma_f32 v140, -v152, v60, v28
    v_mul_f32 v147, v131, v153
    s_waitcnt vmcnt(0)
    v_cmp_ne_u64 vcc, s[96:97], v[168:169]
    s_cbranch_vccz FSD_1_24
    s_mov_b32 s80, 0
FS_1_23:
    buffer_load_dwordx2 v[168:169], v3, s[8:11], 0 offen sc1
    s_waitcnt vmcnt(0)
    v_cmp_ne_u64 vcc, s[96:97], v[168:169]
    s_cbranch_vccz FSD_1_24
    s_add_u32 s80, s80, 1
    s_cmp_lt_u32 s80, 20000
    s_cbranch_scc0 FSD_1_24_to
    s_sleep 1
    s_branch FS_1_23
FSD_1_24_to:
    s_or_b32 s39, s39, 8
FSD_1_24:
    ds_read_b128 v[64:67], v7 offset:43008
    v_mfma_f32_32x32x16_bf16 v[32:47], v[180:183], v[72:75], v[32:47]
    v_mul_f32 v131, v131, v139
    v_add_f32 v144, 1.0, v144
    v_fma_f32 v133, -v152, v53, v21
    s_lshl_b32 s80, s67, 9
    s_add_u32 s80, s80, 8
    v_add_u32 v6, s80, v5
    s_lshl_b32 s80, s36, 11
    s_add_u32 s80, s80, 118784
    v_add_u32 v12, s80, v1
    s_lshl_b32 s80, s36, 13
    s_add_u32 s80, s80, 118784
    v_add_u32 v13, s80, v1
    s_add_u32 s83, s94, 0
    buffer_load_dwordx4 v[92:95], v1, s[8:11], s83 offen offset:0 sc1
    ds_read_b128 v[68:71], v7 offset:44032
    s_waitcnt lgkmcnt(4)
    v_mfma_f32_32x32x16_bf16 v[32:47], v[184:187], v[76:79], v[32:47]
    v_exp_f32 v147, v147
    v_fma_f32 v141, -v152, v61, v29
    v_mul_f32 v148, v132, v153
    ds_read_b128 v[72:75], v7 offset:45056
    v_mfma_f32_32x32x16_bf16 v[32:47], v[188:191], v[80:83], v[32:47]
    v_rcp_f32 v144, v144
    v_mul_f32 v132, v132, v140
    s_add_u32 s83, s94, 0
    buffer_load_dwordx4 v[96:99], v1, s[8:11], s83 offen offset:1024 sc1
    ds_read_b128 v[76:79], v7 offset:46080
    s_waitcnt lgkmcnt(4)
    v_mfma_f32_32x32x16_bf16 v[32:47], v[192:195], v[84:87], v[32:47]
    v_add_f32 v145, 1.0, v145
    v_fma_f32 v134, -v152, v54, v22
    v_exp_f32 v148, v148
    ds_read_b128 v[80:83], v7 offset:47104
    v_mfma_f32_32x32x16_bf16 v[32:47], v[196:199], v[88:91], v[32:47]
    v_fma_f32 v142, -v152, v62, v30
    v_mul_f32 v149, v133, v153
    ds_read_b128 v[84:87], v7 offset:48128
    s_waitcnt lgkmcnt(4)
    v_mfma_f32_32x32x16_bf16 v[32:47], v[200:203], v[64:67], v[32:47]
    v_rcp_f32 v145, v145
    v_mul_f32 v133, v133, v141
    v_add_f32 v146, 1.0, v146
    s_add_u32 s83, s94, 0
    buffer_load_dwordx4 v[100:103], v1, s[8:11], s83 offen offset:2048 sc1
    ds_read_b128 v[88:91], v7 offset:49152
    v_mfma_f32_32x32x16_bf16 v[32:47], v[204:207], v[68:71], v[32:47]
    v_fma_f32 v135, -v152, v55, v23
    v_exp_f32 v149, v149
    ds_read_b128 v[64:67], v7 offset:50176
    s_waitcnt lgkmcnt(4)
    v_mfma_f32_32x32x16_bf16 v[32:47], v[208:211], v[72:75], v[32:47]
    v_fma_f32 v143, -v152, v63, v31
    v_mul_f32 v150, v134, v153
    v_rcp_f32 v146, v146
    s_add_u32 s83, s94, 0
    buffer_load_dwordx4 v[104:107], v1, s[8:11], s83 offen offset:3072 sc1
    ds_read_b128 v[68:71], v7 offset:51200
    v_mfma_f32_32x32x16_bf16 v[32:47], v[212:215], v[76:79], v[32:47]
    v_mul_f32 v134, v134, v142
    v_add_f32 v147, 1.0, v147
    v_mul_f32 v136, v128, v144
    ds_read_b128 v[72:75], v7 offset:52224
    s_waitcnt lgkmcnt(4)
    v_mfma_f32_32x32x16_bf16 v[32:47], v[216:219], v[80:83], v[32:47]
    v_exp_f32 v150, v150
    v_mul_f32 v151, v135, v153
    s_add_u32 s83, s94, 4096
    buffer_load_dwordx4 v[108:111], v1, s[8:11], s83 offen offset:0 sc1
    ds_read_b128 v[76:79], v7 offset:53248
    v_mfma_f32_32x32x16_bf16 v[32:47], v[220:223], v[84:87], v[32:47]
    v_rcp_f32 v147, v147
    v_mul_f32 v135, v135, v143
    ds_read_b128 v[80:83], v7 offset:54272
    s_waitcnt lgkmcnt(4)
    v_mfma_f32_32x32x16_bf16 v[32:47], v[224:227], v[88:91], v[32:47]
    buffer_store_dwordx2 v[10:11], v9, s[8:11], 0 offen offset:896
    v_add_f32 v148, 1.0, v148
    ds_read_b128 v[84:87], v7 offset:55296
    v_mfma_f32_32x32x16_bf16 v[32:47], v[228:231], v[64:67], v[32:47]
    s_barrier
    v_mul_f32 v137, v129, v145
    s_add_u32 s83, s94, 4096
    buffer_load_dwordx4 v[64:67], v1, s[8:11], s83 offen offset:1024 sc1
    ds_read_b128 v[88:91], v7 offset:56320
    s_waitcnt lgkmcnt(4)
    v_mfma_f32_32x32x16_bf16 v[32:47], v[232:235], v[68:71], v[32:47]
    v_exp_f32 v151, v151
    v_rcp_f32 v148, v148
    v_add_f32 v149, 1.0, v149
    v_mfma_f32_32x32x16_bf16 v[32:47], v[236:239], v[72:75], v[32:47]
    v_mul_f32 v138, v130, v146
    v_cvt_pk_bf16_f32 v156, v136, v137
    v_rcp_f32 v149, v149
    s_add_u32 s83, s94, 4096
    buffer_load_dwordx4 v[68:71], v1, s[8:11], s83 offen offset:2048 sc1
    s_waitcnt lgkmcnt(2)
    v_mfma_f32_32x32x16_bf16 v[32:47], v[240:243], v[76:79], v[32:47]
    v_add_f32 v150, 1.0, v150
    v_mul_f32 v139, v131, v147
    v_rcp_f32 v150, v150
    v_add_f32 v151, 1.0, v151
    v_mfma_f32_32x32x16_bf16 v[32:47], v[244:247], v[80:83], v[32:47]
    v_mul_f32 v140, v132, v148
    v_cvt_pk_bf16_f32 v157, v138, v139
    v_rcp_f32 v151, v151
    s_add_u32 s83, s94, 4096
    buffer_load_dwordx4 v[72:75], v1, s[8:11], s83 offen offset:3072 sc1
    s_waitcnt lgkmcnt(0)
    v_mfma_f32_32x32x16_bf16 v[32:47], v[248:251], v[84:87], v[32:47]
    v_mul_f32 v141, v133, v149
    v_mul_f32 v142, v134, v150
    v_cvt_pk_bf16_f32 v158, v140, v141
    v_mul_f32 v143, v135, v151
    v_cvt_pk_bf16_f32 v159, v142, v143
    v_mfma_f32_32x32x16_bf16 v[32:47], v[252:255], v[88:91], v[32:47]
    s_add_u32 s82, s79, 688128
    buffer_store_dwordx4 v[156:159], v1, s[8:11], s82 offen
    s_add_u32 s83, s94, 8192
    buffer_load_dwordx4 v[76:79], v1, s[8:11], s83 offen offset:0 sc1
    s_waitcnt vmcnt(10)
    v_mfma_f32_32x32x16_bf16 v[16:31], a[0:3], v[92:95], 0
    ds_read_b64 v[152:153], v5 offset:3584
    s_waitcnt lgkmcnt(0)
    s_nop 3
    v_fma_f32 v128, -v152, v48, v32
    v_fma_f32 v136, -v152, v56, v40
    v_fma_f32 v129, -v152, v49, v33
    v_fma_f32 v137, -v152, v57, v41
    v_mfma_f32_32x32x16_bf16 v[160:175], a[4:7], v[92:95], 0
    s_add_u32 s83, s94, 8192
    buffer_load_dwordx4 v[80:83], v1, s[8:11], s83 offen offset:1024 sc1
    s_add_u32 s83, s94, 8192
    buffer_load_dwordx4 v[84:87], v1, s[8:11], s83 offen offset:2048 sc1
    s_add_u32 s83, s94, 12288
    buffer_load_dwordx4 v[92:95], v1, s[8:11], s83 offen offset:0 sc1
    s_waitcnt vmcnt(12)
    v_mfma_f32_32x32x16_bf16 v[16:31], a[8:11], v[96:99], v[16:31]
    v_mul_f32 v144, v128, v153
    v_mul_f32 v128, v128, v136
    v_fma_f32 v130, -v152, v50, v34
    v_exp_f32 v144, v144
    v_fma_f32 v138, -v152, v58, v42
    v_mfma_f32_32x32x16_bf16 v[160:175], a[12:15], v[96:99], v[160:175]
    s_add_u32 s83, s94, 8192
    buffer_load_dwordx4 v[88:91], v1, s[8:11], s83 offen offset:3072 sc1
    s_add_u32 s83, s94, 12288
    buffer_load_dwordx4 v[96:99], v1, s[8:11], s83 offen offset:1024 sc1
    s_waitcnt vmcnt(13)
    v_mfma_f32_32x32x16_bf16 v[16:31], a[16:19], v[100:103], v[16:31]
    v_mul_f32 v145, v129, v153
    v_mul_f32 v129, v129, v137
    v_fma_f32 v131, -v152, v51, v35
    v_exp_f32 v145, v145
    v_fma_f32 v139, -v152, v59, v43
    v_mfma_f32_32x32x16_bf16 v[160:175], a[20:23], v[100:103], v[160:175]
    s_add_u32 s83, s94, 12288
    buffer_load_dwordx4 v[100:103], v1, s[8:11], s83 offen offset:2048 sc1
    v_mul_f32 v146, v130, v153
    v_mul_f32 v130, v130, v138
    s_waitcnt vmcnt(13)
    v_mfma_f32_32x32x16_bf16 v[16:31], a[24:27], v[104:107], v[16:31]
    v_fma_f32 v132, -v152, v52, v36
    v_exp_f32 v146, v146
    v_fma_f32 v140, -v152, v60, v44
    v_mul_f32 v147, v131, v153
    v_mul_f32 v131, v131, v139
    v_mfma_f32_32x32x16_bf16 v[160:175], a[28:31], v[104:107], v[160:175]
    s_add_u32 s83, s94, 12288
    buffer_load_dwordx4 v[104:107], v1, s[8:11], s83 offen offset:3072 sc1
    v_add_f32 v144, 1.0, v144
    v_fma_f32 v133, -v152, v53, v37
    s_waitcnt vmcnt(13)
    v_mfma_f32_32x32x16_bf16 v[16:31], a[32:35], v[108:111], v[16:31]
    v_exp_f32 v147, v147
    v_fma_f32 v141, -v152, v61, v45
    v_mul_f32 v148, v132, v153
    v_rcp_f32 v144, v144
    v_mfma_f32_32x32x16_bf16 v[160:175], a[36:39], v[108:111], v[160:175]
    s_add_u32 s83, s94, 16384
    buffer_load_dwordx4 v[108:111], v1, s[8:11], s83 offen offset:0 sc1
    v_mul_f32 v132, v132, v140
    v_add_f32 v145, 1.0, v145
    s_waitcnt vmcnt(12)
    v_mfma_f32_32x32x16_bf16 v[16:31], a[40:43], v[64:67], v[16:31]
    v_fma_f32 v134, -v152, v54, v38
    v_exp_f32 v148, v148
    v_fma_f32 v142, -v152, v62, v46
    v_mul_f32 v149, v133, v153
    v_mfma_f32_32x32x16_bf16 v[160:175], a[44:47], v[64:67], v[160:175]
    s_add_u32 s83, s94, 16384
    buffer_load_dwordx4 v[64:67], v1, s[8:11], s83 offen offset:1024 sc1
    v_rcp_f32 v145, v145
    s_waitcnt vmcnt(12)
    v_mfma_f32_32x32x16_bf16 v[16:31], a[48:51], v[68:71], v[16:31]
    s_waitcnt vmcnt(10)
    buffer_store_dwordx2 v[10:11], v9, s[8:11], 0 offen offset:1792
    v_mul_f32 v133, v133, v141
    v_add_f32 v146, 1.0, v146
    v_fma_f32 v135, -v152, v55, v39
    v_mfma_f32_32x32x16_bf16 v[160:175], a[52:55], v[68:71], v[160:175]
    s_add_u32 s83, s94, 16384
    buffer_load_dwordx4 v[68:71], v1, s[8:11], s83 offen offset:2048 sc1
    v_exp_f32 v149, v149
    v_mfma_f32_32x32x16_bf16 v[16:31], a[56:59], v[72:75], v[16:31]
    v_fma_f32 v143, -v152, v63, v47
    v_mul_f32 v150, v134, v153
    v_rcp_f32 v146, v146
    v_mul_f32 v134, v134, v142
    v_add_f32 v147, 1.0, v147
    v_mfma_f32_32x32x16_bf16 v[160:175], a[60:63], v[72:75], v[160:175]
    s_add_u32 s83, s94, 16384
    buffer_load_dwordx4 v[72:75], v1, s[8:11], s83 offen offset:3072 sc1
    v_mul_f32 v136, v128, v144
    s_waitcnt vmcnt(12)
    v_mfma_f32_32x32x16_bf16 v[16:31], a[64:67], v[76:79], v[16:31]
    v_exp_f32 v150, v150
    v_mul_f32 v151, v135, v153
    v_rcp_f32 v147, v147
    v_mul_f32 v135, v135, v143
    v_mfma_f32_32x32x16_bf16 v[160:175], a[68:71], v[76:79], v[160:175]
    s_add_u32 s83, s94, 20480
    buffer_load_dwordx4 v[76:79], v1, s[8:11], s83 offen offset:0 sc1
    v_add_f32 v148, 1.0, v148
    v_mul_f32 v137, v129, v145
    s_waitcnt vmcnt(12)
    v_mfma_f32_32x32x16_bf16 v[16:31], a[72:75], v[80:83], v[16:31]
    v_exp_f32 v151, v151
    v_rcp_f32 v148, v148
    v_add_f32 v149, 1.0, v149
    v_mul_f32 v138, v130, v146
    buffer_load_dwordx2 v[154:155], v4, s[8:11], 0 offen sc1
    v_mfma_f32_32x32x16_bf16 v[160:175], a[76:79], v[80:83], v[160:175]
    s_add_u32 s83, s94, 20480
    buffer_load_dwordx4 v[80:83], v1, s[8:11], s83 offen offset:1024 sc1
    v_cvt_pk_bf16_f32 v156, v136, v137
    s_waitcnt vmcnt(13)
    v_mfma_f32_32x32x16_bf16 v[16:31], a[80:83], v[84:87], v[16:31]
    v_rcp_f32 v149, v149
    v_add_f32 v150, 1.0, v150
    v_mul_f32 v139, v131, v147
    v_rcp_f32 v150, v150
    v_mfma_f32_32x32x16_bf16 v[160:175], a[84:87], v[84:87], v[160:175]
    s_add_u32 s83, s94, 20480
    buffer_load_dwordx4 v[84:87], v1, s[8:11], s83 offen offset:2048 sc1
    v_add_f32 v151, 1.0, v151
    v_mul_f32 v140, v132, v148
    s_waitcnt vmcnt(12)
    v_mfma_f32_32x32x16_bf16 v[16:31], a[88:91], v[88:91], v[16:31]
    v_cvt_pk_bf16_f32 v157, v138, v139
    v_rcp_f32 v151, v151
    v_mul_f32 v141, v133, v149
    v_mul_f32 v142, v134, v150
    v_cvt_pk_bf16_f32 v158, v140, v141
    v_mfma_f32_32x32x16_bf16 v[160:175], a[92:95], v[88:91], v[160:175]
    s_add_u32 s83, s94, 20480
    buffer_load_dwordx4 v[88:91], v1, s[8:11], s83 offen offset:3072 sc1
    v_mul_f32 v143, v135, v151
    v_cvt_pk_bf16_f32 v159, v142, v143
    v_mfma_f32_32x32x16_bf16 v[16:31], a[96:99], v[92:95], v[16:31]
    s_add_u32 s82, s79, 802816
    buffer_store_dwordx4 v[156:159], v1, s[8:11], s82 offen
    v_mfma_f32_32x32x16_bf16 v[160:175], a[100:103], v[92:95], v[160:175]
    s_add_u32 s83, s94, 24576
    buffer_load_dwordx4 v[92:95], v1, s[8:11], s83 offen offset:0 sc1
    s_waitcnt vmcnt(14)
    v_mfma_f32_32x32x16_bf16 v[16:31], a[104:107], v[96:99], v[16:31]
    v_mfma_f32_32x32x16_bf16 v[160:175], a[108:111], v[96:99], v[160:175]
    s_add_u32 s83, s94, 24576
    buffer_load_dwordx4 v[96:99], v1, s[8:11], s83 offen offset:1024 sc1
    s_waitcnt vmcnt(14)
    v_mfma_f32_32x32x16_bf16 v[16:31], a[112:115], v[100:103], v[16:31]
    v_mfma_f32_32x32x16_bf16 v[160:175], a[116:119], v[100:103], v[160:175]
    s_add_u32 s83, s94, 24576
    buffer_load_dwordx4 v[100:103], v1, s[8:11], s83 offen offset:2048 sc1
    s_waitcnt vmcnt(14)
    v_mfma_f32_32x32x16_bf16 v[16:31], a[120:123], v[104:107], v[16:31]
    v_mfma_f32_32x32x16_bf16 v[160:175], a[124:127], v[104:107], v[160:175]
    s_add_u32 s83, s94, 24576
    buffer_load_dwordx4 v[104:107], v1, s[8:11], s83 offen offset:3072 sc1
    s_waitcnt vmcnt(14)
    v_mfma_f32_32x32x16_bf16 v[16:31], a[128:131], v[108:111], v[16:31]
    s_waitcnt vmcnt(4)
    buffer_store_dwordx2 v[10:11], v9, s[8:11], 0 offen offset:2688
    v_mfma_f32_32x32x16_bf16 v[160:175], a[132:135], v[108:111], v[160:175]
    v_mfma_f32_32x32x16_bf16 v[16:31], a[136:139], v[64:67], v[16:31]
    v_mfma_f32_32x32x16_bf16 v[160:175], a[140:143], v[64:67], v[160:175]
    v_cmp_ne_u64 vcc, s[96:97], v[154:155]
    s_cbranch_vccz FSD_1_26
    s_mov_b32 s80, 0
FS_1_25:
    buffer_load_dwordx2 v[154:155], v4, s[8:11], 0 offen sc1
    s_waitcnt vmcnt(0)
    v_cmp_ne_u64 vcc, s[96:97], v[154:155]
    s_cbranch_vccz FSD_1_26
    s_add_u32 s80, s80, 1
    s_cmp_lt_u32 s80, 20000
    s_cbranch_scc0 FSD_1_26_to
    s_sleep 1
    s_branch FS_1_25
FSD_1_26_to:
    s_or_b32 s39, s39, 128
FSD_1_26:
    v_mfma_f32_32x32x16_bf16 v[16:31], a[144:147], v[68:71], v[16:31]
    v_mfma_f32_32x32x16_bf16 v[160:175], a[148:151], v[68:71], v[160:175]
    s_add_u32 s83, s95, 0
    buffer_load_dwordx4 v[108:111], v1, s[8:11], s83 offen offset:0 sc1
    s_add_u32 s83, s95, 0
    buffer_load_dwordx4 v[64:67], v1, s[8:11], s83 offen offset:1024 sc1
    v_mfma_f32_32x32x16_bf16 v[16:31], a[152:155], v[72:75], v[16:31]
    v_mfma_f32_32x32x16_bf16 v[160:175], a[156:159], v[72:75], v[160:175]
    s_add_u32 s83, s95, 0
    buffer_load_dwordx4 v[68:71], v1, s[8:11], s83 offen offset:2048 sc1
    s_add_u32 s83, s95, 0
    buffer_load_dwordx4 v[72:75], v1, s[8:11], s83 offen offset:3072 sc1
    v_mfma_f32_32x32x16_bf16 v[16:31], a[160:163], v[76:79], v[16:31]
    v_mfma_f32_32x32x16_bf16 v[160:175], a[164:167], v[76:79], v[160:175]
    s_add_u32 s83, s95, 4096
    buffer_load_dwordx4 v[76:79], v1, s[8:11], s83 offen offset:0 sc1
    v_mfma_f32_32x32x16_bf16 v[16:31], a[168:171], v[80:83], v[16:31]
    v_mfma_f32_32x32x16_bf16 v[160:175], a[172:175], v[80:83], v[160:175]
    s_add_u32 s83, s95, 4096
    buffer_load_dwordx4 v[80:83], v1, s[8:11], s83 offen offset:1024 sc1
    v_mfma_f32_32x32x16_bf16 v[16:31], a[176:179], v[84:87], v[16:31]
    v_mfma_f32_32x32x16_bf16 v[160:175], a[180:183], v[84:87], v[160:175]
    s_add_u32 s83, s95, 4096
    buffer_load_dwordx4 v[84:87], v1, s[8:11], s83 offen offset:2048 sc1
    v_mfma_f32_32x32x16_bf16 v[16:31], a[184:187], v[88:91], v[16:31]
    v_mfma_f32_32x32x16_bf16 v[160:175], a[188:191], v[88:91], v[160:175]
    s_add_u32 s83, s95, 4096
    buffer_load_dwordx4 v[88:91], v1, s[8:11], s83 offen offset:3072 sc1
    s_waitcnt vmcnt(12)
    v_mfma_f32_32x32x16_bf16 v[16:31], a[192:195], v[92:95], v[16:31]
    v_mfma_f32_32x32x16_bf16 v[160:175], a[196:199], v[92:95], v[160:175]
    s_add_u32 s83, s95, 8192
    buffer_load_dwordx4 v[92:95], v1, s[8:11], s83 offen offset:0 sc1
    s_waitcnt vmcnt(12)
    v_mfma_f32_32x32x16_bf16 v[16:31], a[200:203], v[96:99], v[16:31]
    v_mfma_f32_32x32x16_bf16 v[160:175], a[204:207], v[96:99], v[160:175]
    s_add_u32 s83, s95, 8192
    buffer_load_dwordx4 v[96:99], v1, s[8:11], s83 offen offset:1024 sc1
    s_waitcnt vmcnt(12)
    v_mfma_f32_32x32x16_bf16 v[16:31], a[208:211], v[100:103], v[16:31]
    v_mfma_f32_32x32x16_bf16 v[160:175], a[212:215], v[100:103], v[160:175]
    s_add_u32 s83, s95, 8192
    buffer_load_dwordx4 v[100:103], v1, s[8:11], s83 offen offset:2048 sc1
    s_waitcnt vmcnt(12)
    v_mfma_f32_32x32x16_bf16 v[16:31], a[216:219], v[104:107], v[16:31]
    v_mfma_f32_32x32x16_bf16 v[160:175], a[220:223], v[104:107], v[160:175]
    s_add_u32 s83, s95, 8192
    buffer_load_dwordx4 v[104:107], v1, s[8:11], s83 offen offset:3072 sc1
    s_waitcnt vmcnt(11)
    v_mfma_f32_32x32x16_bf16 v[32:47], a[0:3], v[108:111], 0
    v_mfma_f32_32x32x16_bf16 v[128:143], a[4:7], v[108:111], 0
    s_add_u32 s83, s95, 12288
    buffer_load_dwordx4 v[108:111], v1, s[8:11], s83 offen offset:0 sc1
    s_waitcnt vmcnt(11)
    v_mfma_f32_32x32x16_bf16 v[32:47], a[8:11], v[64:67], v[32:47]
    s_nop 1
    ds_write_b128 v12, v[16:19] offset:0
    ds_write_b128 v12, v[20:23] offset:1024
    ds_write_b128 v12, v[24:27] offset:16384
    v_mfma_f32_32x32x16_bf16 v[128:143], a[12:15], v[64:67], v[128:143]
    s_add_u32 s83, s95, 12288
    buffer_load_dwordx4 v[64:67], v1, s[8:11], s83 offen offset:1024 sc1
    ds_write_b128 v12, v[28:31] offset:17408
    s_waitcnt vmcnt(11)
    v_mfma_f32_32x32x16_bf16 v[32:47], a[16:19], v[68:71], v[32:47]
    ds_write_b128 v12, v[160:163] offset:8192
    ds_write_b128 v12, v[164:167] offset:9216
    ds_write_b128 v12, v[168:171] offset:24576
    v_mfma_f32_32x32x16_bf16 v[128:143], a[20:23], v[68:71], v[128:143]
    s_add_u32 s83, s95, 12288
    buffer_load_dwordx4 v[68:71], v1, s[8:11], s83 offen offset:2048 sc1
    ds_write_b128 v12, v[172:175] offset:25600
    s_waitcnt vmcnt(11)
    v_mfma_f32_32x32x16_bf16 v[32:47], a[24:27], v[72:75], v[32:47]
    v_mfma_f32_32x32x16_bf16 v[128:143], a[28:31], v[72:75], v[128:143]
    s_add_u32 s83, s95, 12288
    buffer_load_dwordx4 v[72:75], v1, s[8:11], s83 offen offset:3072 sc1
    s_waitcnt vmcnt(11)
    v_mfma_f32_32x32x16_bf16 v[32:47], a[32:35], v[76:79], v[32:47]
    v_mfma_f32_32x32x16_bf16 v[128:143], a[36:39], v[76:79], v[128:143]
    s_add_u32 s83, s95, 16384
    buffer_load_dwordx4 v[76:79], v1, s[8:11], s83 offen offset:0 sc1
    s_waitcnt lgkmcnt(0)
    s_barrier
    s_waitcnt vmcnt(11)
    v_mfma_f32_32x32x16_bf16 v[32:47], a[40:43], v[80:83], v[32:47]
    ds_read_b128 v[16:19], v13 offset:0
    ds_read_b128 v[20:23], v13 offset:1024
    ds_read_b128 v[24:27], v13 offset:2048
    ds_read_b128 v[28:31], v13 offset:3072
    ds_read_b128 v[160:163], v13 offset:4096
    ds_read_b128 v[164:167], v13 offset:5120
    v_mfma_f32_32x32x16_bf16 v[128:143], a[44:47], v[80:83], v[128:143]
    s_add_u32 s83, s95, 16384
    buffer_load_dwordx4 v[80:83], v1, s[8:11], s83 offen offset:1024 sc1
    ds_read_b128 v[168:171], v13 offset:6144
    ds_read_b128 v[172:175], v13 offset:7168
    s_waitcnt vmcnt(11)
    v_mfma_f32_32x32x16_bf16 v[32:47], a[48:51], v[84:87], v[32:47]
    ds_read_b32 v152, v6 offset:0
    v_mfma_f32_32x32x16_bf16 v[128:143], a[52:55], v[84:87], v[128:143]
    s_add_u32 s83, s95, 16384
    buffer_load_dwordx4 v[84:87], v1, s[8:11], s83 offen offset:2048 sc1
    s_waitcnt vmcnt(11)
    v_mfma_f32_32x32x16_bf16 v[32:47], a[56:59], v[88:91], v[32:47]
    v_mfma_f32_32x32x16_bf16 v[128:143], a[60:63], v[88:91], v[128:143]
    s_add_u32 s83, s95, 16384
    buffer_load_dwordx4 v[88:91], v1, s[8:11], s83 offen offset:3072 sc1
    s_waitcnt vmcnt(11)
    v_mfma_f32_32x32x16_bf16 v[32:47], a[64:67], v[92:95], v[32:47]
    s_waitcnt lgkmcnt(0)
    v_add_f32 v144, v16, v24
    v_add_f32 v145, v17, v25
    v_add_f32 v146, v18, v26
    v_add_f32 v147, v19, v27
    v_add_f32 v148, v20, v28
    v_mfma_f32_32x32x16_bf16 v[128:143], a[68:71], v[92:95], v[128:143]
    s_add_u32 s83, s95, 20480
    buffer_load_dwordx4 v[92:95], v1, s[8:11], s83 offen offset:0 sc1
    v_add_f32 v149, v21, v29
    v_add_f32 v150, v22, v30
    s_waitcnt vmcnt(11)
    v_mfma_f32_32x32x16_bf16 v[32:47], a[72:75], v[96:99], v[32:47]
    v_add_f32 v151, v23, v31
    v_add_f32 v160, v160, v168
    v_add_f32 v161, v161, v169
    v_add_f32 v162, v162, v170
    v_add_f32 v163, v163, v171
    v_add_f32 v164, v164, v172
    v_mfma_f32_32x32x16_bf16 v[128:143], a[76:79], v[96:99], v[128:143]
    s_add_u32 s83, s95, 20480
    buffer_load_dwordx4 v[96:99], v1, s[8:11], s83 offen offset:1024 sc1
    v_add_f32 v165, v165, v173
    v_add_f32 v166, v166, v174
    s_waitcnt vmcnt(11)
    v_mfma_f32_32x32x16_bf16 v[32:47], a[80:83], v[100:103], v[32:47]
    v_add_f32 v167, v167, v175
    v_add_f32 v144, v144, v160
    v_add_f32 v145, v145, v161
    v_add_f32 v146, v146, v162
    v_add_f32 v147, v147, v163
    v_add_f32 v148, v148, v164
    v_mfma_f32_32x32x16_bf16 v[128:143], a[84:87], v[100:103], v[128:143]
    s_add_u32 s83, s95, 20480
    buffer_load_dwordx4 v[100:103], v1, s[8:11], s83 offen offset:2048 sc1
    v_add_f32 v149, v149, v165
    v_add_f32 v150, v150, v166
    s_waitcnt vmcnt(11)
    v_mfma_f32_32x32x16_bf16 v[32:47], a[88:91], v[104:107], v[32:47]
    v_add_f32 v151, v151, v167
    v_lshlrev_b32 v153, 16, v112
    v_and_b32 v154, s77, v112
    v_fma_f32 v144, v144, v152, v153
    v_fma_f32 v145, v145, v152, v154
    v_lshlrev_b32 v153, 16, v113
    v_mfma_f32_32x32x16_bf16 v[128:143], a[92:95], v[104:107], v[128:143]
    s_add_u32 s83, s95, 20480
    buffer_load_dwordx4 v[104:107], v1, s[8:11], s83 offen offset:3072 sc1
    v_and_b32 v154, s77, v113
    v_fma_f32 v146, v146, v152, v153
    s_waitcnt vmcnt(11)
    v_mfma_f32_32x32x16_bf16 v[32:47], a[96:99], v[108:111], v[32:47]
    v_fma_f32 v147, v147, v152, v154
    v_lshlrev_b32 v153, 16, v114
    v_and_b32 v154, s77, v114
    v_fma_f32 v148, v148, v152, v153
    v_fma_f32 v149, v149, v152, v154
    v_lshlrev_b32 v153, 16, v115
    v_mfma_f32_32x32x16_bf16 v[128:143], a[100:103], v[108:111], v[128:143]
    s_add_u32 s83, s95, 24576
    buffer_load_dwordx4 v[108:111], v1, s[8:11], s83 offen offset:0 sc1
    v_and_b32 v154, s77, v115
    v_fma_f32 v150, v150, v152, v153
    s_waitcnt vmcnt(11)
    v_mfma_f32_32x32x16_bf16 v[32:47], a[104:107], v[64:67], v[32:47]
    v_fma_f32 v151, v151, v152, v154
    v_add_f32 v154, v144, v145
    v_mul_f32 v155, v144, v144
    v_fmac_f32 v155, v145, v145
    v_add_f32 v154, v154, v146
    v_fmac_f32 v155, v146, v146
    v_mfma_f32_32x32x16_bf16 v[128:143], a[108:111], v[64:67], v[128:143]
    s_add_u32 s83, s95, 24576
    buffer_load_dwordx4 v[64:67], v1, s[8:11], s83 offen offset:1024 sc1
    v_add_f32 v154, v154, v147
    v_fmac_f32 v155, v147, v147
    s_waitcnt vmcnt(11)
    v_mfma_f32_32x32x16_bf16 v[32:47], a[112:115], v[68:71], v[32:47]
    v_add_f32 v154, v154, v148
    v_fmac_f32 v155, v148, v148
    v_add_f32 v154, v154, v149
    v_fmac_f32 v155, v149, v149
    v_add_f32 v154, v154, v150
    v_fmac_f32 v155, v150, v150
    v_mfma_f32_32x32x16_bf16 v[128:143], a[116:119], v[68:71], v[128:143]
    s_add_u32 s83, s95, 24576
    buffer_load_dwordx4 v[68:71], v1, s[8:11], s83 offen offset:2048 sc1
    v_add_f32 v154, v154, v151
    v_fmac_f32 v155, v151, v151
    s_waitcnt vmcnt(11)
    v_mfma_f32_32x32x16_bf16 v[32:47], a[120:123], v[72:75], v[32:47]
    v_mov_b32 v156, v154
    v_mov_b32 v157, v155
    s_nop 0
    v_permlane32_swap_b32 v156, v154
    v_permlane32_swap_b32 v157, v155
    v_add_f32 v154, v154, v156
    v_mfma_f32_32x32x16_bf16 v[128:143], a[124:127], v[72:75], v[128:143]
    s_add_u32 s83, s95, 24576
    buffer_load_dwordx4 v[72:75], v1, s[8:11], s83 offen offset:3072 sc1
    v_add_f32 v155, v155, v157
    ds_write_b64 v14, v[154:155] offset:0
    s_waitcnt vmcnt(11)
    v_mfma_f32_32x32x16_bf16 v[32:47], a[128:131], v[76:79], v[32:47]
    v_mfma_f32_32x32x16_bf16 v[128:143], a[132:135], v[76:79], v[128:143]
    s_waitcnt vmcnt(10)
    v_mfma_f32_32x32x16_bf16 v[32:47], a[136:139], v[80:83], v[32:47]
    s_waitcnt lgkmcnt(0)
    s_barrier
    ds_read_b64 v[158:159], v14 offset:512
    v_mfma_f32_32x32x16_bf16 v[128:143], a[140:143], v[80:83], v[128:143]
    s_waitcnt vmcnt(9)
    v_mfma_f32_32x32x16_bf16 v[32:47], a[144:147], v[84:87], v[32:47]
    v_mfma_f32_32x32x16_bf16 v[128:143], a[148:151], v[84:87], v[128:143]
    s_waitcnt vmcnt(8)
    v_mfma_f32_32x32x16_bf16 v[32:47], a[152:155], v[88:91], v[32:47]
    v_mfma_f32_32x32x16_bf16 v[128:143], a[156:159], v[88:91], v[128:143]
    s_waitcnt vmcnt(7)
    v_mfma_f32_32x32x16_bf16 v[32:47], a[160:163], v[92:95], v[32:47]
    v_mfma_f32_32x32x16_bf16 v[128:143], a[164:167], v[92:95], v[128:143]
    s_waitcnt vmcnt(6)
    v_mfma_f32_32x32x16_bf16 v[32:47], a[168:171], v[96:99], v[32:47]
    v_mfma_f32_32x32x16_bf16 v[128:143], a[172:175], v[96:99], v[128:143]
    s_waitcnt vmcnt(5)
    v_mfma_f32_32x32x16_bf16 v[32:47], a[176:179], v[100:103], v[32:47]
    v_mfma_f32_32x32x16_bf16 v[128:143], a[180:183], v[100:103], v[128:143]
    s_waitcnt vmcnt(4)
    v_mfma_f32_32x32x16_bf16 v[32:47], a[184:187], v[104:107], v[32:47]
    v_mfma_f32_32x32x16_bf16 v[128:143], a[188:191], v[104:107], v[128:143]
    s_waitcnt vmcnt(3)
    v_mfma_f32_32x32x16_bf16 v[32:47], a[192:195], v[108:111], v[32:47]
    v_mfma_f32_32x32x16_bf16 v[128:143], a[196:199], v[108:111], v[128:143]
    s_waitcnt vmcnt(2)
    v_mfma_f32_32x32x16_bf16 v[32:47], a[200:203], v[64:67], v[32:47]
    v_mfma_f32_32x32x16_bf16 v[128:143], a[204:207], v[64:67], v[128:143]
    s_waitcnt vmcnt(1)
    v_mfma_f32_32x32x16_bf16 v[32:47], a[208:211], v[68:71], v[32:47]
    v_mfma_f32_32x32x16_bf16 v[128:143], a[212:215], v[68:71], v[128:143]
    s_waitcnt vmcnt(0)
    v_mfma_f32_32x32x16_bf16 v[32:47], a[216:219], v[72:75], v[32:47]
    v_mfma_f32_32x32x16_bf16 v[128:143], a[220:223], v[72:75], v[128:143]
    s_waitcnt lgkmcnt(0)
    s_cmp_eq_u32 s5, 0
    s_cbranch_scc0 GP_1_27
    v_add_f32 v154, v154, v158
    v_add_f32 v155, v155, v159
    v_mov_b32 v156, s96
    v_mov_b32 v157, s97
    s_add_u32 s80, s4, 24838144
    s_mov_b32 exec_hi, 0
    buffer_store_dwordx4 v[154:157], v1, s[8:11], s80 offen
    s_mov_b32 exec_hi, -1
GP_1_27:
    s_mul_i32 s80, s68, 7168
    s_add_u32 s80, s80, 24838144
    v_and_b32 v3, 31, v0
    v_lshlrev_b32 v3, 4, v3
    v_lshrrev_b32 v159, 5, v0
    v_lshl_add_u32 v3, v159, 9, v3
    v_add_u32 v3, s80, v3
    ds_write_b128 v12, v[32:35] offset:0
    ds_write_b128 v12, v[36:39] offset:1024
    ds_write_b128 v12, v[40:43] offset:16384
    ds_write_b128 v12, v[44:47] offset:17408
    ds_write_b128 v12, v[128:131] offset:8192
    ds_write_b128 v12, v[132:135] offset:9216
    ds_write_b128 v12, v[136:139] offset:24576
    ds_write_b128 v12, v[140:143] offset:25600
    buffer_load_dwordx4 v[16:19], v3, s[8:11], 0 offen offset:0 sc1
    buffer_load_dwordx4 v[20:23], v3, s[8:11], 0 offen offset:1024 sc1
    buffer_load_dwordx4 v[24:27], v3, s[8:11], 0 offen offset:2048 sc1
    buffer_load_dwordx4 v[28:31], v3, s[8:11], 0 offen offset:3072 sc1
    buffer_load_dwordx4 v[160:163], v3, s[8:11], s78 offen offset:0 sc1
    buffer_load_dwordx4 v[164:167], v3, s[8:11], s78 offen offset:1024 sc1
    buffer_load_dwordx4 v[168:171], v3, s[8:11], s78 offen offset:2048 sc1
    s_waitcnt lgkmcnt(0)
    s_barrier
    ds_read_b128 v[64:67], v13 offset:0
    ds_read_b128 v[68:71], v13 offset:1024
    ds_read_b128 v[72:75], v13 offset:2048
    ds_read_b128 v[76:79], v13 offset:3072
    ds_read_b128 v[80:83], v13 offset:4096
    ds_read_b128 v[84:87], v13 offset:5120
    ds_read_b128 v[88:91], v13 offset:6144
    ds_read_b128 v[92:95], v13 offset:7168
    ds_read_b32 v136, v6 offset:2048
    s_waitcnt lgkmcnt(0)
    v_add_f32 v32, v64, v72
    v_add_f32 v33, v65, v73
    v_add_f32 v34, v66, v74
    v_add_f32 v35, v67, v75
    v_add_f32 v36, v68, v76
    v_add_f32 v37, v69, v77
    v_add_f32 v38, v70, v78
    v_add_f32 v39, v71, v79
    v_add_f32 v80, v80, v88
    v_add_f32 v81, v81, v89
    v_add_f32 v82, v82, v90
    v_add_f32 v83, v83, v91
    v_add_f32 v84, v84, v92
    v_add_f32 v85, v85, v93
    v_add_f32 v86, v86, v94
    v_add_f32 v87, v87, v95
    v_add_f32 v32, v32, v80
    v_add_f32 v33, v33, v81
    v_add_f32 v34, v34, v82
    v_add_f32 v35, v35, v83
    v_add_f32 v36, v36, v84
    v_add_f32 v37, v37, v85
    v_add_f32 v38, v38, v86
    v_add_f32 v39, v39, v87
    v_lshlrev_b32 v137, 16, v116
    v_and_b32 v138, s77, v116
    v_fma_f32 v32, v32, v136, v137
    v_fma_f32 v33, v33, v136, v138
    v_lshlrev_b32 v137, 16, v117
    v_and_b32 v138, s77, v117
    v_fma_f32 v34, v34, v136, v137
    v_fma_f32 v35, v35, v136, v138
    v_lshlrev_b32 v137, 16, v118
    v_and_b32 v138, s77, v118
    v_fma_f32 v36, v36, v136, v137
    v_fma_f32 v37, v37, v136, v138
    v_lshlrev_b32 v137, 16, v119
    v_and_b32 v138, s77, v119
    v_fma_f32 v38, v38, v136, v137
    v_fma_f32 v39, v39, v136, v138
    v_add_f32 v128, v32, v33
    v_mul_f32 v129, v32, v32
    v_fmac_f32 v129, v33, v33
    v_add_f32 v128, v128, v34
    v_fmac_f32 v129, v34, v34
    v_add_f32 v128, v128, v35
    v_fmac_f32 v129, v35, v35
    v_add_f32 v128, v128, v36
    v_fmac_f32 v129, v36, v36
    v_add_f32 v128, v128, v37
    v_fmac_f32 v129, v37, v37
    v_add_f32 v128, v128, v38
    v_fmac_f32 v129, v38, v38
    v_add_f32 v128, v128, v39
    v_fmac_f32 v129, v39, v39
    v_mov_b32 v130, v128
    v_mov_b32 v131, v129
    s_nop 0
    v_permlane32_swap_b32 v130, v128
    v_permlane32_swap_b32 v131, v129
    v_add_f32 v128, v128, v130
    v_add_f32 v129, v129, v131
    ds_write_b64 v14, v[128:129] offset:1024
    s_waitcnt lgkmcnt(0)
    s_barrier
    ds_read_b64 v[132:133], v14 offset:1536
    s_waitcnt lgkmcnt(0)
    s_cmp_eq_u32 s5, 0
    s_cbranch_scc0 GP_1_28
    v_add_f32 v128, v128, v132
    v_add_f32 v129, v129, v133
    v_mov_b32 v130, s96
    v_mov_b32 v131, s97
    s_add_u32 s80, s4, 24838144
    s_add_u32 s80, s80, 28672
    s_mov_b32 exec_hi, 0
    buffer_store_dwordx4 v[128:131], v1, s[8:11], s80 offen
    s_mov_b32 exec_hi, -1
GP_1_28:
    s_waitcnt vmcnt(0)
    s_mov_b32 s80, 0
GC_1_29:
    v_cmpx_eq_u64 vcc, s[96:97], v[18:19]
    v_cmpx_eq_u64 vcc, s[96:97], v[22:23]
    v_cmpx_eq_u64 vcc, s[96:97], v[26:27]
    v_cmpx_eq_u64 vcc, s[96:97], v[30:31]
    v_cmpx_eq_u64 vcc, s[96:97], v[162:163]
    v_cmpx_eq_u64 vcc, s[96:97], v[166:167]
    v_cmpx_eq_u64 vcc, s[96:97], v[170:171]
    s_nop 4
    s_cmp_eq_u64 exec, -1
    s_mov_b64 exec, -1
    s_cbranch_scc1 GCD_1_30
    buffer_load_dwordx4 v[16:19], v3, s[8:11], 0 offen offset:0 sc1
    buffer_load_dwordx4 v[20:23], v3, s[8:11], 0 offen offset:1024 sc1
    buffer_load_dwordx4 v[24:27], v3, s[8:11], 0 offen offset:2048 sc1
    buffer_load_dwordx4 v[28:31], v3, s[8:11], 0 offen offset:3072 sc1
    buffer_load_dwordx4 v[160:163], v3, s[8:11], s78 offen offset:0 sc1
    buffer_load_dwordx4 v[164:167], v3, s[8:11], s78 offen offset:1024 sc1
    buffer_load_dwordx4 v[168:171], v3, s[8:11], s78 offen offset:2048 sc1
    s_waitcnt vmcnt(0)
    s_add_u32 s80, s80, 1
    s_cmp_lt_u32 s80, 20000
    s_cbranch_scc0 GCD_1_30_to
    s_sleep 1
    s_branch GC_1_29
GCD_1_30_to:
    s_or_b32 s39, s39, 16
GCD_1_30:
    v_add_f32 v18, v16, v20
    v_add_f32 v19, v17, v21
    v_add_f32 v18, v18, v24
    v_add_f32 v19, v19, v25
    v_add_f32 v18, v18, v28
    v_add_f32 v19, v19, v29
    v_add_f32 v18, v18, v160
    v_add_f32 v19, v19, v161
    v_add_f32 v18, v18, v164
    v_add_f32 v19, v19, v165
    v_add_f32 v18, v18, v168
    v_add_f32 v19, v19, v169
    v_mov_b32 v22, v18
    v_mov_b32 v23, v19
    s_nop 0
    v_permlane32_swap_b32 v22, v18
    v_permlane32_swap_b32 v23, v19
    v_add_f32 v18, v18, v22
    v_add_f32 v19, v19, v23
    v_mul_f32 v24, 0x3b124925, v18
    v_mul_f32 v26, 0x3b124925, v19
    v_fma_f32 v26, -v24, v24, v26
    v_max_f32 v26, 0, v26
    v_add_f32 v26, 0x3727c5ac, v26
    v_rsq_f32 v25, v26
    s_nop 0
    v_mul_f32 v28, v24, v25
    v_lshlrev_b32 v29, 16, v120
    v_and_b32 v30, s77, v120
    v_fma_f32 v31, v144, v25, -v28
    v_fma_f32 v160, v145, v25, -v28
    v_fmac_f32 v144, v29, v31
    v_fmac_f32 v145, v30, v160
    v_lshlrev_b32 v29, 16, v121
    v_and_b32 v30, s77, v121
    v_fma_f32 v31, v146, v25, -v28
    v_fma_f32 v160, v147, v25, -v28
    v_fmac_f32 v146, v29, v31
    v_fmac_f32 v147, v30, v160
    v_lshlrev_b32 v29, 16, v122
    v_and_b32 v30, s77, v122
    v_fma_f32 v31, v148, v25, -v28
    v_fma_f32 v160, v149, v25, -v28
    v_fmac_f32 v148, v29, v31
    v_fmac_f32 v149, v30, v160
    v_lshlrev_b32 v29, 16, v123
    v_and_b32 v30, s77, v123
    v_fma_f32 v31, v150, v25, -v28
    v_fma_f32 v160, v151, v25, -v28
    v_fmac_f32 v150, v29, v31
    v_fmac_f32 v151, v30, v160
    v_cvt_pk_bf16_f32 v112, v144, v145
    v_cvt_pk_bf16_f32 v113, v146, v147
    v_cvt_pk_bf16_f32 v114, v148, v149
    v_cvt_pk_bf16_f32 v115, v150, v151
    s_add_u32 s80, s3, 5505024
    buffer_store_dwordx4 v[112:115], v1, s[8:11], s80 offen
    v_add_f32 v164, v144, v145
    v_mul_f32 v165, v144, v144
    v_fmac_f32 v165, v145, v145
    v_add_f32 v164, v164, v146
    v_fmac_f32 v165, v146, v146
    v_add_f32 v164, v164, v147
    v_fmac_f32 v165, v147, v147
    v_add_f32 v164, v164, v148
    v_fmac_f32 v165, v148, v148
    v_add_f32 v164, v164, v149
    v_fmac_f32 v165, v149, v149
    v_add_f32 v164, v164, v150
    v_fmac_f32 v165, v150, v150
    v_add_f32 v164, v164, v151
    v_fmac_f32 v165, v151, v151
    v_mov_b32 v166, v164
    v_mov_b32 v167, v165
    s_nop 0
    v_permlane32_swap_b32 v166, v164
    v_permlane32_swap_b32 v167, v165
    v_add_f32 v164, v164, v166
    v_add_f32 v165, v165, v167
    s_waitcnt vmcnt(0)
    ds_write_b64 v14, v[164:165] offset:2048
    s_waitcnt lgkmcnt(0)
    s_barrier
    ds_read_b64 v[168:169], v14 offset:2560
    s_waitcnt lgkmcnt(0)
    s_cmp_eq_u32 s5, 0
    s_cbranch_scc0 GP_1_31
    v_add_f32 v164, v164, v168
    v_add_f32 v165, v165, v169
    v_mov_b32 v166, s100
    v_mov_b32 v167, s101
    s_add_u32 s80, s4, 23920640
    s_mov_b32 exec_hi, 0
    buffer_store_dwordx4 v[164:167], v1, s[8:11], s80 offen
    s_mov_b32 exec_hi, -1
GP_1_31:
    v_add_u32 v3, 28672, v3
    buffer_load_dwordx4 v[92:95], v3, s[8:11], 0 offen offset:0 sc1
    buffer_load_dwordx4 v[96:99], v3, s[8:11], 0 offen offset:1024 sc1
    buffer_load_dwordx4 v[100:103], v3, s[8:11], 0 offen offset:2048 sc1
    buffer_load_dwordx4 v[104:107], v3, s[8:11], 0 offen offset:3072 sc1
    buffer_load_dwordx4 v[108:111], v3, s[8:11], s78 offen offset:0 sc1
    buffer_load_dwordx4 v[168:171], v3, s[8:11], s78 offen offset:1024 sc1
    buffer_load_dwordx4 v[172:175], v3, s[8:11], s78 offen offset:2048 sc1
    s_mov_b32 s70, 1
    s_mov_b32 s72, 9175040
    s_mov_b32 s74, 25296896
    s_mov_b32 s71, 5505024
    v_xor_b32 v10, 1, v10
    s_add_u32 s82, s76, s36
    s_mul_i32 s83, s82, 7168
    s_add_u32 s83, s83, 23920640
    v_and_b32 v4, 31, v0
    v_lshlrev_b32 v4, 4, v4
    v_lshrrev_b32 v154, 5, v0
    v_lshl_add_u32 v4, v154, 9, v4
    v_add_u32 v4, s83, v4
    buffer_load_dwordx4 v[64:67], v4, s[8:11], 0 offen offset:0 sc1
    buffer_load_dwordx4 v[68:71], v4, s[8:11], 0 offen offset:1024 sc1
    buffer_load_dwordx4 v[72:75], v4, s[8:11], 0 offen offset:2048 sc1
    buffer_load_dwordx4 v[76:79], v4, s[8:11], 0 offen offset:3072 sc1
    buffer_load_dwordx4 v[80:83], v4, s[8:11], s78 offen offset:0 sc1
    buffer_load_dwordx4 v[84:87], v4, s[8:11], s78 offen offset:1024 sc1
    buffer_load_dwordx4 v[88:91], v4, s[8:11], s78 offen offset:2048 sc1
    s_waitcnt vmcnt(0)
    s_mov_b32 s80, 0
GC_1_32:
    v_cmpx_eq_u64 vcc, s[100:101], v[66:67]
    v_cmpx_eq_u64 vcc, s[100:101], v[70:71]
    v_cmpx_eq_u64 vcc, s[100:101], v[74:75]
    v_cmpx_eq_u64 vcc, s[100:101], v[78:79]
    v_cmpx_eq_u64 vcc, s[100:101], v[82:83]
    v_cmpx_eq_u64 vcc, s[100:101], v[86:87]
    v_cmpx_eq_u64 vcc, s[100:101], v[90:91]
    s_nop 4
    s_cmp_eq_u64 exec, -1
    s_mov_b64 exec, -1
    s_cbranch_scc1 GCD_1_33
    buffer_load_dwordx4 v[64:67], v4, s[8:11], 0 offen offset:0 sc1
    buffer_load_dwordx4 v[68:71], v4, s[8:11], 0 offen offset:1024 sc1
    buffer_load_dwordx4 v[72:75], v4, s[8:11], 0 offen offset:2048 sc1
    buffer_load_dwordx4 v[76:79], v4, s[8:11], 0 offen offset:3072 sc1
    buffer_load_dwordx4 v[80:83], v4, s[8:11], s78 offen offset:0 sc1
    buffer_load_dwordx4 v[84:87], v4, s[8:11], s78 offen offset:1024 sc1
    buffer_load_dwordx4 v[88:91], v4, s[8:11], s78 offen offset:2048 sc1
    s_waitcnt vmcnt(0)
    s_add_u32 s80, s80, 1
    s_cmp_lt_u32 s80, 20000
    s_cbranch_scc0 GCD_1_33_to
    s_sleep 1
    s_branch GC_1_32
GCD_1_33_to:
    s_or_b32 s39, s39, 4
GCD_1_33:
    v_add_u32 v4, 28672, v4
    s_barrier
    s_add_u32 s83, s85, 0
    s_add_u32 m0, s84, 0
    s_nop 0
    buffer_load_dwordx4 v1, s[8:11], s83 offen offset:0 sc1 lds
    buffer_load_dwordx4 v1, s[8:11], s83 offen offset:1024 sc1 lds
    buffer_load_dwordx4 v1, s[8:11], s83 offen offset:2048 sc1 lds
    buffer_load_dwordx4 v1, s[8:11], s83 offen offset:3072 sc1 lds
    s_add_u32 s83, s83, 4096
    s_add_u32 m0, s84, 4096
    s_nop 0
    buffer_load_dwordx4 v1, s[8:11], s83 offen offset:0 sc1 lds
    buffer_load_dwordx4 v1, s[8:11], s83 offen offset:1024 sc1 lds
    buffer_load_dwordx4 v1, s[8:11], s83 offen offset:2048 sc1 lds
    v_add_f32 v66, v64, v68
    v_add_f32 v67, v65, v69
    v_add_f32 v66, v66, v72
    v_add_f32 v67, v67, v73
    v_add_f32 v66, v66, v76
    v_add_f32 v67, v67, v77
    v_add_f32 v66, v66, v80
    v_add_f32 v67, v67, v81
    v_add_f32 v66, v66, v84
    v_add_f32 v67, v67, v85
    v_add_f32 v66, v66, v88
    v_add_f32 v67, v67, v89
    v_mov_b32 v70, v66
    v_mov_b32 v71, v67
    s_nop 0
    v_permlane32_swap_b32 v70, v66
    v_permlane32_swap_b32 v71, v67
    v_add_f32 v66, v66, v70
    v_add_f32 v67, v67, v71
    v_mul_f32 v72, 0x3b124925, v66
    v_mul_f32 v77, 0x3b124925, v67
    v_fma_f32 v77, -v72, v72, v77
    v_max_f32 v77, 0, v77
    v_add_f32 v77, 0x3727c5ac, v77
    v_rsq_f32 v76, v77
    v_mov_b32 v75, 0
    v_mul_f32 v73, 0xbfb8aa3b, v76
    v_mul_f32 v74, v76, v76
    s_lshl_b32 s80, s36, 9
    v_add_u32 v80, s80, v5
    ds_write_b128 v80, v[72:75] offset:0
    s_waitcnt vmcnt(0)
    s_waitcnt lgkmcnt(0)
    s_barrier
    ds_read_b128 v[64:67], v2 offset:0
    ds_read_b128 v[68:71], v2 offset:1024
    ds_read_b128 v[72:75], v2 offset:2048
    ds_read_b128 v[76:79], v2 offset:3072
    ds_read_b128 v[80:83], v2 offset:4096
    ds_read_b128 v[84:87], v2 offset:5120
    s_waitcnt lgkmcnt(4)
    v_mfma_f32_32x32x16_bf16 v[16:31], a[224:227], v[64:67], 0
    s_add_u32 s83, s85, 28672
    s_add_u32 m0, s84, 28672
    s_nop 0
    buffer_load_dwordx4 v1, s[8:11], s83 offen offset:0 sc1 lds
    ds_read_b128 v[88:91], v2 offset:6144
    v_mfma_f32_32x32x16_bf16 v[16:31], a[228:231], v[68:71], v[16:31]
    s_add_u32 m0, s84, 28672
    s_nop 0
    buffer_load_dwordx4 v1, s[8:11], s83 offen offset:1024 sc1 lds
    ds_read_b128 v[64:67], v2 offset:7168
    s_waitcnt lgkmcnt(4)
    v_mfma_f32_32x32x16_bf16 v[16:31], a[232:235], v[72:75], v[16:31]
    ds_read_b128 v[68:71], v2 offset:8192
    v_mfma_f32_32x32x16_bf16 v[16:31], a[236:239], v[76:79], v[16:31]
    s_add_u32 m0, s84, 28672
    s_nop 0
    buffer_load_dwordx4 v1, s[8:11], s83 offen offset:2048 sc1 lds
    ds_read_b128 v[72:75], v2 offset:9216
    s_waitcnt lgkmcnt(4)
    v_mfma_f32_32x32x16_bf16 v[16:31], a[240:243], v[80:83], v[16:31]
    ds_read_b128 v[76:79], v2 offset:10240
    v_mfma_f32_32x32x16_bf16 v[16:31], a[244:247], v[84:87], v[16:31]
    s_add_u32 m0, s84, 28672
    s_nop 0
    buffer_load_dwordx4 v1, s[8:11], s83 offen offset:3072 sc1 lds
    ds_read_b128 v[80:83], v2 offset:11264
    s_waitcnt lgkmcnt(4)
    v_mfma_f32_32x32x16_bf16 v[16:31], a[248:251], v[88:91], v[16:31]
    ds_read_b128 v[84:87], v2 offset:12288
    v_mfma_f32_32x32x16_bf16 v[16:31], a[252:255], v[64:67], v[16:31]
    s_add_u32 s83, s83, 4096
    s_add_u32 m0, s84, 32768
    s_nop 0
    buffer_load_dwordx4 v1, s[8:11], s83 offen offset:0 sc1 lds
    ds_read_b128 v[88:91], v2 offset:13312
    s_waitcnt lgkmcnt(4)
    v_mfma_f32_32x32x16_bf16 v[16:31], v[176:179], v[68:71], v[16:31]
    ds_read_b128 v[64:67], v2 offset:14336
    v_mfma_f32_32x32x16_bf16 v[16:31], v[180:183], v[72:75], v[16:31]
    s_add_u32 m0, s84, 32768
    s_nop 0
    buffer_load_dwordx4 v1, s[8:11], s83 offen offset:1024 sc1 lds
    ds_read_b128 v[68:71], v2 offset:15360
    s_waitcnt lgkmcnt(4)
    v_mfma_f32_32x32x16_bf16 v[16:31], v[184:187], v[76:79], v[16:31]
    ds_read_b128 v[72:75], v2 offset:16384
    v_mfma_f32_32x32x16_bf16 v[16:31], v[188:191], v[80:83], v[16:31]
    s_add_u32 m0, s84, 32768
    s_nop 0
    buffer_load_dwordx4 v1, s[8:11], s83 offen offset:2048 sc1 lds
    ds_read_b128 v[76:79], v2 offset:17408
    s_waitcnt lgkmcnt(4)
    v_mfma_f32_32x32x16_bf16 v[16:31], v[192:195], v[84:87], v[16:31]
    ds_read_b128 v[80:83], v2 offset:18432
    v_mfma_f32_32x32x16_bf16 v[16:31], v[196:199], v[88:91], v[16:31]
    ds_read_b128 v[84:87], v2 offset:19456
    s_waitcnt lgkmcnt(4)
    v_mfma_f32_32x32x16_bf16 v[16:31], v[200:203], v[64:67], v[16:31]
    s_add_u32 s83, s85, 57344
    s_add_u32 m0, s84, 57344
    s_nop 0
    buffer_load_dwordx4 v1, s[8:11], s83 offen offset:0 sc1 lds
    ds_read_b128 v[88:91], v2 offset:20480
    v_mfma_f32_32x32x16_bf16 v[16:31], v[204:207], v[68:71], v[16:31]
    ds_read_b128 v[64:67], v2 offset:21504
    s_waitcnt lgkmcnt(4)
    v_mfma_f32_32x32x16_bf16 v[16:31], v[208:211], v[72:75], v[16:31]
    s_add_u32 m0, s84, 57344
    s_nop 0
    buffer_load_dwordx4 v1, s[8:11], s83 offen offset:1024 sc1 lds
    ds_read_b128 v[68:71], v2 offset:22528
    v_mfma_f32_32x32x16_bf16 v[16:31], v[212:215], v[76:79], v[16:31]
    ds_read_b128 v[72:75], v2 offset:23552
    s_waitcnt lgkmcnt(4)
    v_mfma_f32_32x32x16_bf16 v[16:31], v[216:219], v[80:83], v[16:31]
    s_add_u32 m0, s84, 57344
    s_nop 0
    buffer_load_dwordx4 v1, s[8:11], s83 offen offset:2048 sc1 lds
    ds_read_b128 v[76:79], v2 offset:24576
    v_mfma_f32_32x32x16_bf16 v[16:31], v[220:223], v[84:87], v[16:31]
    ds_read_b128 v[80:83], v2 offset:25600
    s_waitcnt lgkmcnt(4)
    v_mfma_f32_32x32x16_bf16 v[16:31], v[224:227], v[88:91], v[16:31]
    s_add_u32 m0, s84, 57344
    s_nop 0
    buffer_load_dwordx4 v1, s[8:11], s83 offen offset:3072 sc1 lds
    s_waitcnt vmcnt(4)
    ds_read_b128 v[84:87], v2 offset:26624
    v_mfma_f32_32x32x16_bf16 v[16:31], v[228:231], v[64:67], v[16:31]
    s_barrier
    ds_read_b128 v[88:91], v2 offset:27648
    s_waitcnt lgkmcnt(4)
    v_mfma_f32_32x32x16_bf16 v[16:31], v[232:235], v[68:71], v[16:31]
    s_add_u32 s83, s83, 4096
    s_add_u32 m0, s84, 61440
    s_nop 0
    buffer_load_dwordx4 v1, s[8:11], s83 offen offset:0 sc1 lds
    ds_read_b128 v[64:67], v2 offset:28672
    v_mfma_f32_32x32x16_bf16 v[16:31], v[236:239], v[72:75], v[16:31]
    ds_read_b128 v[68:71], v2 offset:29696
    s_waitcnt lgkmcnt(4)
    v_mfma_f32_32x32x16_bf16 v[16:31], v[240:243], v[76:79], v[16:31]
    s_add_u32 m0, s84, 61440
    s_nop 0
    buffer_load_dwordx4 v1, s[8:11], s83 offen offset:1024 sc1 lds
    ds_read_b128 v[72:75], v2 offset:30720
    v_mfma_f32_32x32x16_bf16 v[16:31], v[244:247], v[80:83], v[16:31]
    ds_read_b128 v[76:79], v2 offset:31744
    s_waitcnt lgkmcnt(4)
    v_mfma_f32_32x32x16_bf16 v[16:31], v[248:251], v[84:87], v[16:31]
    s_add_u32 m0, s84, 61440
    s_nop 0
    buffer_load_dwordx4 v1, s[8:11], s83 offen offset:2048 sc1 lds
    ds_read_b128 v[80:83], v2 offset:32768
    v_mfma_f32_32x32x16_bf16 v[16:31], v[252:255], v[88:91], v[16:31]
    s_mov_b32 s80, 0
GC_1_34:
    v_cmpx_eq_u64 vcc, s[96:97], v[94:95]
    v_cmpx_eq_u64 vcc, s[96:97], v[98:99]
    v_cmpx_eq_u64 vcc, s[96:97], v[102:103]
    v_cmpx_eq_u64 vcc, s[96:97], v[106:107]
    v_cmpx_eq_u64 vcc, s[96:97], v[110:111]
    v_cmpx_eq_u64 vcc, s[96:97], v[170:171]
    v_cmpx_eq_u64 vcc, s[96:97], v[174:175]
    s_nop 4
    s_cmp_eq_u64 exec, -1
    s_mov_b64 exec, -1
    s_cbranch_scc1 GCD_1_35
    buffer_load_dwordx4 v[92:95], v3, s[8:11], 0 offen offset:0 sc1
    buffer_load_dwordx4 v[96:99], v3, s[8:11], 0 offen offset:1024 sc1
    buffer_load_dwordx4 v[100:103], v3, s[8:11], 0 offen offset:2048 sc1
    buffer_load_dwordx4 v[104:107], v3, s[8:11], 0 offen offset:3072 sc1
    buffer_load_dwordx4 v[108:111], v3, s[8:11], s78 offen offset:0 sc1
    buffer_load_dwordx4 v[168:171], v3, s[8:11], s78 offen offset:1024 sc1
    buffer_load_dwordx4 v[172:175], v3, s[8:11], s78 offen offset:2048 sc1
    s_waitcnt vmcnt(0)
    s_add_u32 s80, s80, 1
    s_cmp_lt_u32 s80, 20000
    s_cbranch_scc0 GCD_1_35_to
    s_sleep 1
    s_branch GC_1_34
GCD_1_35_to:
    s_or_b32 s39, s39, 16
GCD_1_35:
    v_add_f32 v94, v92, v96
    v_add_f32 v95, v93, v97
    v_add_f32 v94, v94, v100
    v_add_f32 v95, v95, v101
    v_add_f32 v94, v94, v104
    v_add_f32 v95, v95, v105
    v_add_f32 v94, v94, v108
    v_add_f32 v95, v95, v109
    v_add_f32 v94, v94, v168
    v_add_f32 v95, v95, v169
    v_add_f32 v94, v94, v172
    v_add_f32 v95, v95, v173
    v_mov_b32 v98, v94
    v_mov_b32 v99, v95
    s_nop 0
    v_permlane32_swap_b32 v98, v94
    v_permlane32_swap_b32 v99, v95
    v_add_f32 v94, v94, v98
    v_add_f32 v95, v95, v99
    v_mul_f32 v100, 0x3b124925, v94
    v_mul_f32 v102, 0x3b124925, v95
    v_fma_f32 v102, -v100, v100, v102
    v_max_f32 v102, 0, v102
    v_add_f32 v102, 0x3727c5ac, v102
    v_rsq_f32 v101, v102
    s_nop 0
    v_mul_f32 v104, v100, v101
    v_lshlrev_b32 v105, 16, v124
    v_and_b32 v106, s77, v124
    v_fma_f32 v107, v32, v101, -v104
    v_fma_f32 v108, v33, v101, -v104
    v_fmac_f32 v32, v105, v107
    v_fmac_f32 v33, v106, v108
    v_lshlrev_b32 v105, 16, v125
    v_and_b32 v106, s77, v125
    v_fma_f32 v107, v34, v101, -v104
    v_fma_f32 v108, v35, v101, -v104
    v_fmac_f32 v34, v105, v107
    v_fmac_f32 v35, v106, v108
    v_lshlrev_b32 v105, 16, v126
    v_and_b32 v106, s77, v126
    v_fma_f32 v107, v36, v101, -v104
    v_fma_f32 v108, v37, v101, -v104
    v_fmac_f32 v36, v105, v107
    v_fmac_f32 v37, v106, v108
    v_lshlrev_b32 v105, 16, v127
    v_and_b32 v106, s77, v127
    v_fma_f32 v107, v38, v101, -v104
    v_fma_f32 v108, v39, v101, -v104
    v_fmac_f32 v38, v105, v107
    v_fmac_f32 v39, v106, v108
    v_cvt_pk_bf16_f32 v116, v32, v33
    v_cvt_pk_bf16_f32 v117, v34, v35
    v_cvt_pk_bf16_f32 v118, v36, v37
    v_cvt_pk_bf16_f32 v119, v38, v39
    s_add_u32 s80, s3, 5619712
    buffer_store_dwordx4 v[116:119], v1, s[8:11], s80 offen
    v_add_f32 v168, v32, v33
    v_mul_f32 v169, v32, v32
    v_fmac_f32 v169, v33, v33
    v_add_f32 v168, v168, v34
    v_fmac_f32 v169, v34, v34
    v_add_f32 v168, v168, v35
    v_fmac_f32 v169, v35, v35
    v_add_f32 v168, v168, v36
    v_fmac_f32 v169, v36, v36
    v_add_f32 v168, v168, v37
    v_fmac_f32 v169, v37, v37
    v_add_f32 v168, v168, v38
    v_fmac_f32 v169, v38, v38
    v_add_f32 v168, v168, v39
    v_fmac_f32 v169, v39, v39
    v_mov_b32 v170, v168
    v_mov_b32 v171, v169
    s_nop 0
    v_permlane32_swap_b32 v170, v168
    v_permlane32_swap_b32 v171, v169
    v_add_f32 v168, v168, v170
    v_add_f32 v169, v169, v171
    s_waitcnt vmcnt(0)
    ds_write_b64 v14, v[168:169] offset:3072
    s_waitcnt lgkmcnt(0)
    s_barrier
    ds_read_b64 v[172:173], v14 offset:3584
    s_waitcnt lgkmcnt(0)
    s_cmp_eq_u32 s5, 0
    s_cbranch_scc0 GP_1_36
    v_add_f32 v168, v168, v172
    v_add_f32 v169, v169, v173
    v_mov_b32 v170, s100
    v_mov_b32 v171, s101
    s_add_u32 s80, s4, 23920640
    s_add_u32 s80, s80, 28672
    s_mov_b32 exec_hi, 0
    buffer_store_dwordx4 v[168:171], v1, s[8:11], s80 offen
    s_mov_b32 exec_hi, -1
GP_1_36:
    ds_read_b128 v[84:87], v2 offset:33792
    v_mfma_f32_32x32x16_bf16 v[32:47], a[224:227], v[64:67], 0
    s_add_u32 s83, s85, 86016
    s_add_u32 m0, s84, 86016
    s_nop 0
    buffer_load_dwordx4 v1, s[8:11], s83 offen offset:0 sc1 lds
    ds_read_b64 v[152:153], v5 offset:0
    ds_read_b128 v[88:91], v2 offset:34816
    v_mfma_f32_32x32x16_bf16 v[32:47], a[228:231], v[68:71], v[32:47]
    ds_read_b128 v[64:67], v2 offset:35840
    v_mfma_f32_32x32x16_bf16 v[32:47], a[232:235], v[72:75], v[32:47]
    s_add_u32 m0, s84, 86016
    s_nop 0
    buffer_load_dwordx4 v1, s[8:11], s83 offen offset:1024 sc1 lds
    s_waitcnt lgkmcnt(2)
    ds_read_b128 v[68:71], v2 offset:36864
    v_mfma_f32_32x32x16_bf16 v[32:47], a[236:239], v[76:79], v[32:47]
    v_fma_f32 v128, -v152, v48, v16
    v_fma_f32 v136, -v152, v56, v24
    v_fma_f32 v129, -v152, v49, v17
    ds_read_b128 v[72:75], v2 offset:37888
    v_mfma_f32_32x32x16_bf16 v[32:47], a[240:243], v[80:83], v[32:47]
    v_fma_f32 v137, -v152, v57, v25
    v_mul_f32 v144, v128, v153
    v_mul_f32 v128, v128, v136
    v_fma_f32 v130, -v152, v50, v18
    ds_read_b128 v[76:79], v2 offset:38912
    v_mfma_f32_32x32x16_bf16 v[32:47], a[244:247], v[84:87], v[32:47]
    s_add_u32 m0, s84, 86016
    s_nop 0
    buffer_load_dwordx4 v1, s[8:11], s83 offen offset:2048 sc1 lds
    ds_read_b128 v[80:83], v2 offset:39936
    s_waitcnt lgkmcnt(4)
    v_mfma_f32_32x32x16_bf16 v[32:47], a[248:251], v[88:91], v[32:47]
    v_exp_f32 v144, v144
    v_fma_f32 v138, -v152, v58, v26
    v_mul_f32 v145, v129, v153
    ds_read_b128 v[84:87], v2 offset:40960
    v_mfma_f32_32x32x16_bf16 v[32:47], a[252:255], v[64:67], v[32:47]
    v_mul_f32 v129, v129, v137
    v_fma_f32 v131, -v152, v51, v19
    ds_read_b128 v[88:91], v2 offset:41984
    s_waitcnt lgkmcnt(4)
    v_mfma_f32_32x32x16_bf16 v[32:47], v[176:179], v[68:71], v[32:47]
    s_add_u32 m0, s84, 86016
    s_nop 0
    buffer_load_dwordx4 v1, s[8:11], s83 offen offset:3072 sc1 lds
    ds_read_b128 v[64:67], v2 offset:43008
    v_mfma_f32_32x32x16_bf16 v[32:47], v[180:183], v[72:75], v[32:47]
    v_exp_f32 v145, v145
    v_fma_f32 v139, -v152, v59, v27
    ds_read_b128 v[68:71], v2 offset:44032
    s_waitcnt lgkmcnt(4)
    v_mfma_f32_32x32x16_bf16 v[32:47], v[184:187], v[76:79], v[32:47]
    v_mul_f32 v146, v130, v153
    v_mul_f32 v130, v130, v138
    v_fma_f32 v132, -v152, v52, v20
    ds_read_b128 v[72:75], v2 offset:45056
    v_mfma_f32_32x32x16_bf16 v[32:47], v[188:191], v[80:83], v[32:47]
    s_add_u32 s83, s83, 4096
    s_add_u32 m0, s84, 90112
    s_nop 0
    buffer_load_dwordx4 v1, s[8:11], s83 offen offset:0 sc1 lds
    ds_read_b128 v[76:79], v2 offset:46080
    s_waitcnt lgkmcnt(4)
    v_mfma_f32_32x32x16_bf16 v[32:47], v[192:195], v[84:87], v[32:47]
    v_exp_f32 v146, v146
    v_fma_f32 v140, -v152, v60, v28
    v_mul_f32 v147, v131, v153
    ds_read_b128 v[80:83], v2 offset:47104
    v_mfma_f32_32x32x16_bf16 v[32:47], v[196:199], v[88:91], v[32:47]
    v_mul_f32 v131, v131, v139
    v_add_f32 v144, 1.0, v144
    v_fma_f32 v133, -v152, v53, v21
    ds_read_b128 v[84:87], v2 offset:48128
    s_waitcnt lgkmcnt(4)
    v_mfma_f32_32x32x16_bf16 v[32:47], v[200:203], v[64:67], v[32:47]
    s_add_u32 m0, s84, 90112
    s_nop 0
    buffer_load_dwordx4 v1, s[8:11], s83 offen offset:1024 sc1 lds
    ds_read_b128 v[88:91], v2 offset:49152
    v_mfma_f32_32x32x16_bf16 v[32:47], v[204:207], v[68:71], v[32:47]
    v_exp_f32 v147, v147
    v_fma_f32 v141, -v152, v61, v29
    ds_read_b128 v[64:67], v2 offset:50176
    s_waitcnt lgkmcnt(4)
    v_mfma_f32_32x32x16_bf16 v[32:47], v[208:211], v[72:75], v[32:47]
    v_mul_f32 v148, v132, v153
    v_rcp_f32 v144, v144
    v_mul_f32 v132, v132, v140
    ds_read_b128 v[68:71], v2 offset:51200
    v_mfma_f32_32x32x16_bf16 v[32:47], v[212:215], v[76:79], v[32:47]
    s_add_u32 m0, s84, 90112
    s_nop 0
    buffer_load_dwordx4 v1, s[8:11], s83 offen offset:2048 sc1 lds
    ds_read_b128 v[72:75], v2 offset:52224
    s_waitcnt lgkmcnt(4)
    v_mfma_f32_32x32x16_bf16 v[32:47], v[216:219], v[80:83], v[32:47]
    v_add_f32 v145, 1.0, v145
    v_fma_f32 v134, -v152, v54, v22
    v_exp_f32 v148, v148
    ds_read_b128 v[76:79], v2 offset:53248
    v_mfma_f32_32x32x16_bf16 v[32:47], v[220:223], v[84:87], v[32:47]
    v_fma_f32 v142, -v152, v62, v30
    v_mul_f32 v149, v133, v153
    ds_read_b128 v[80:83], v2 offset:54272
    s_waitcnt lgkmcnt(4)
    v_mfma_f32_32x32x16_bf16 v[32:47], v[224:227], v[88:91], v[32:47]
    v_rcp_f32 v145, v145
    v_mul_f32 v133, v133, v141
    ds_read_b128 v[84:87], v2 offset:55296
    v_mfma_f32_32x32x16_bf16 v[32:47], v[228:231], v[64:67], v[32:47]
    s_barrier
    v_add_f32 v146, 1.0, v146
    v_fma_f32 v135, -v152, v55, v23
    ds_read_b128 v[88:91], v2 offset:56320
    s_waitcnt lgkmcnt(4)
    v_mfma_f32_32x32x16_bf16 v[32:47], v[232:235], v[68:71], v[32:47]
    v_exp_f32 v149, v149
    v_fma_f32 v143, -v152, v63, v31
    v_mul_f32 v150, v134, v153
    ds_read_b128 v[64:67], v7 offset:0
    v_mfma_f32_32x32x16_bf16 v[32:47], v[236:239], v[72:75], v[32:47]
    v_rcp_f32 v146, v146
    v_mul_f32 v134, v134, v142
    ds_read_b128 v[68:71], v7 offset:1024
    s_waitcnt lgkmcnt(4)
    v_mfma_f32_32x32x16_bf16 v[32:47], v[240:243], v[76:79], v[32:47]
    v_add_f32 v147, 1.0, v147
    v_mul_f32 v136, v128, v144
    v_exp_f32 v150, v150
    ds_read_b128 v[72:75], v7 offset:2048
    v_mfma_f32_32x32x16_bf16 v[32:47], v[244:247], v[80:83], v[32:47]
    v_mul_f32 v151, v135, v153
    v_rcp_f32 v147, v147
    ds_read_b128 v[76:79], v7 offset:3072
    s_waitcnt lgkmcnt(4)
    v_mfma_f32_32x32x16_bf16 v[32:47], v[248:251], v[84:87], v[32:47]
    v_mul_f32 v135, v135, v143
    v_add_f32 v148, 1.0, v148
    v_mul_f32 v137, v129, v145
    ds_read_b128 v[80:83], v7 offset:4096
    v_mfma_f32_32x32x16_bf16 v[32:47], v[252:255], v[88:91], v[32:47]
    v_exp_f32 v151, v151
    v_rcp_f32 v148, v148
    v_add_f32 v149, 1.0, v149
    v_mul_f32 v138, v130, v146
    v_cvt_pk_bf16_f32 v156, v136, v137
    v_rcp_f32 v149, v149
    v_add_f32 v150, 1.0, v150
    v_mul_f32 v139, v131, v147
    v_rcp_f32 v150, v150
    v_add_f32 v151, 1.0, v151
    v_mul_f32 v140, v132, v148
    v_cvt_pk_bf16_f32 v157, v138, v139
    v_rcp_f32 v151, v151
    v_mul_f32 v141, v133, v149
    v_mul_f32 v142, v134, v150
    v_cvt_pk_bf16_f32 v158, v140, v141
    v_mul_f32 v143, v135, v151
    v_cvt_pk_bf16_f32 v159, v142, v143
    s_add_u32 s82, s79, 0
    buffer_store_dwordx4 v[156:159], v1, s[8:11], s82 offen
    ds_read_b128 v[84:87], v7 offset:5120
    s_waitcnt lgkmcnt(4)
    v_mfma_f32_32x32x16_bf16 v[16:31], a[224:227], v[64:67], 0
    ds_read_b64 v[152:153], v5 offset:512
    ds_read_b128 v[88:91], v7 offset:6144
    v_mfma_f32_32x32x16_bf16 v[16:31], a[228:231], v[68:71], v[16:31]
    ds_read_b128 v[64:67], v7 offset:7168
    s_waitcnt lgkmcnt(5)
    v_mfma_f32_32x32x16_bf16 v[16:31], a[232:235], v[72:75], v[16:31]
    s_waitcnt lgkmcnt(2)
    v_fma_f32 v128, -v152, v48, v32
    v_fma_f32 v136, -v152, v56, v40
    v_fma_f32 v129, -v152, v49, v33
    ds_read_b128 v[68:71], v7 offset:8192
    v_mfma_f32_32x32x16_bf16 v[16:31], a[236:239], v[76:79], v[16:31]
    v_fma_f32 v137, -v152, v57, v41
    v_mul_f32 v144, v128, v153
    v_mul_f32 v128, v128, v136
    ds_read_b128 v[72:75], v7 offset:9216
    v_mfma_f32_32x32x16_bf16 v[16:31], a[240:243], v[80:83], v[16:31]
    v_fma_f32 v130, -v152, v50, v34
    v_exp_f32 v144, v144
    v_fma_f32 v138, -v152, v58, v42
    ds_read_b128 v[76:79], v7 offset:10240
    v_mfma_f32_32x32x16_bf16 v[16:31], a[244:247], v[84:87], v[16:31]
    v_mul_f32 v145, v129, v153
    v_mul_f32 v129, v129, v137
    v_fma_f32 v131, -v152, v51, v35
    ds_read_b128 v[80:83], v7 offset:11264
    s_waitcnt lgkmcnt(4)
    v_mfma_f32_32x32x16_bf16 v[16:31], a[248:251], v[88:91], v[16:31]
    buffer_load_dwordx4 v[92:95], v4, s[8:11], 0 offen offset:0 sc1
    ds_read_b128 v[84:87], v7 offset:12288
    v_mfma_f32_32x32x16_bf16 v[16:31], a[252:255], v[64:67], v[16:31]
    v_exp_f32 v145, v145
    v_fma_f32 v139, -v152, v59, v43
    ds_read_b128 v[88:91], v7 offset:13312
    s_waitcnt lgkmcnt(4)
    v_mfma_f32_32x32x16_bf16 v[16:31], v[176:179], v[68:71], v[16:31]
    buffer_load_dwordx4 v[96:99], v4, s[8:11], 0 offen offset:1024 sc1
    v_mul_f32 v146, v130, v153
    ds_read_b128 v[64:67], v7 offset:14336
    v_mfma_f32_32x32x16_bf16 v[16:31], v[180:183], v[72:75], v[16:31]
    v_mul_f32 v130, v130, v138
    v_fma_f32 v132, -v152, v52, v36
    ds_read_b128 v[68:71], v7 offset:15360
    s_waitcnt lgkmcnt(4)
    v_mfma_f32_32x32x16_bf16 v[16:31], v[184:187], v[76:79], v[16:31]
    buffer_load_dwordx4 v[100:103], v4, s[8:11], 0 offen offset:2048 sc1
    ds_read_b128 v[72:75], v7 offset:16384
    v_mfma_f32_32x32x16_bf16 v[16:31], v[188:191], v[80:83], v[16:31]
    v_exp_f32 v146, v146
    v_fma_f32 v140, -v152, v60, v44
    ds_read_b128 v[76:79], v7 offset:17408
    s_waitcnt lgkmcnt(4)
    v_mfma_f32_32x32x16_bf16 v[16:31], v[192:195], v[84:87], v[16:31]
    buffer_load_dwordx4 v[104:107], v4, s[8:11], 0 offen offset:3072 sc1
    v_mul_f32 v147, v131, v153
    ds_read_b128 v[80:83], v7 offset:18432
    v_mfma_f32_32x32x16_bf16 v[16:31], v[196:199], v[88:91], v[16:31]
    v_mul_f32 v131, v131, v139
    v_add_f32 v144, 1.0, v144
    v_fma_f32 v133, -v152, v53, v37
    ds_read_b128 v[84:87], v7 offset:19456
    s_waitcnt lgkmcnt(4)
    v_mfma_f32_32x32x16_bf16 v[16:31], v[200:203], v[64:67], v[16:31]
    buffer_load_dwordx4 v[108:111], v4, s[8:11], s78 offen offset:0 sc1
    ds_read_b128 v[88:91], v7 offset:20480
    v_mfma_f32_32x32x16_bf16 v[16:31], v[204:207], v[68:71], v[16:31]
    v_exp_f32 v147, v147
    v_fma_f32 v141, -v152, v61, v45
    ds_read_b128 v[64:67], v7 offset:21504
    s_waitcnt lgkmcnt(4)
    v_mfma_f32_32x32x16_bf16 v[16:31], v[208:211], v[72:75], v[16:31]
    buffer_load_dwordx4 v[168:171], v4, s[8:11], s78 offen offset:1024 sc1
    v_mul_f32 v148, v132, v153
    ds_read_b128 v[68:71], v7 offset:22528
    v_mfma_f32_32x32x16_bf16 v[16:31], v[212:215], v[76:79], v[16:31]
    v_rcp_f32 v144, v144
    v_mul_f32 v132, v132, v140
    ds_read_b128 v[72:75], v7 offset:23552
    s_waitcnt lgkmcnt(4)
    v_mfma_f32_32x32x16_bf16 v[16:31], v[216:219], v[80:83], v[16:31]
    buffer_load_dwordx4 v[172:175], v4, s[8:11], s78 offen offset:2048 sc1
    v_add_f32 v145, 1.0, v145
    ds_read_b128 v[76:79], v7 offset:24576
    v_mfma_f32_32x32x16_bf16 v[16:31], v[220:223], v[84:87], v[16:31]
    v_fma_f32 v134, -v152, v54, v38
    v_exp_f32 v148, v148
    ds_read_b128 v[80:83], v7 offset:25600
    s_waitcnt lgkmcnt(4)
    v_mfma_f32_32x32x16_bf16 v[16:31], v[224:227], v[88:91], v[16:31]
    s_waitcnt vmcnt(7)
    buffer_store_dwordx2 v[10:11], v8, s[8:11], 0 offen offset:0
    ds_read_b128 v[84:87], v7 offset:26624
    v_mfma_f32_32x32x16_bf16 v[16:31], v[228:231], v[64:67], v[16:31]
    s_barrier
    v_fma_f32 v142, -v152, v62, v46
    v_mul_f32 v149, v133, v153
    ds_read_b128 v[88:91], v7 offset:27648
    s_waitcnt lgkmcnt(4)
    v_mfma_f32_32x32x16_bf16 v[16:31], v[232:235], v[68:71], v[16:31]
    v_rcp_f32 v145, v145
    v_mul_f32 v133, v133, v141
    v_add_f32 v146, 1.0, v146
    ds_read_b128 v[64:67], v7 offset:28672
    v_mfma_f32_32x32x16_bf16 v[16:31], v[236:239], v[72:75], v[16:31]
    v_fma_f32 v135, -v152, v55, v39
    v_exp_f32 v149, v149
    ds_read_b128 v[68:71], v7 offset:29696
    s_waitcnt lgkmcnt(4)
    v_mfma_f32_32x32x16_bf16 v[16:31], v[240:243], v[76:79], v[16:31]
    v_fma_f32 v143, -v152, v63, v47
    v_mul_f32 v150, v134, v153
    v_rcp_f32 v146, v146
    ds_read_b128 v[72:75], v7 offset:30720
    v_mfma_f32_32x32x16_bf16 v[16:31], v[244:247], v[80:83], v[16:31]
    v_mul_f32 v134, v134, v142
    v_add_f32 v147, 1.0, v147
    v_mul_f32 v136, v128, v144
    ds_read_b128 v[76:79], v7 offset:31744
    s_waitcnt lgkmcnt(4)
    v_mfma_f32_32x32x16_bf16 v[16:31], v[248:251], v[84:87], v[16:31]
    v_exp_f32 v150, v150
    v_mul_f32 v151, v135, v153
    ds_read_b128 v[80:83], v7 offset:32768
    v_mfma_f32_32x32x16_bf16 v[16:31], v[252:255], v[88:91], v[16:31]
    s_waitcnt vmcnt(1)
    s_mov_b32 s80, 0
GC_1_37:
    v_cmpx_eq_u64 vcc, s[100:101], v[94:95]
    v_cmpx_eq_u64 vcc, s[100:101], v[98:99]
    v_cmpx_eq_u64 vcc, s[100:101], v[102:103]
    v_cmpx_eq_u64 vcc, s[100:101], v[106:107]
    v_cmpx_eq_u64 vcc, s[100:101], v[110:111]
    v_cmpx_eq_u64 vcc, s[100:101], v[170:171]
    v_cmpx_eq_u64 vcc, s[100:101], v[174:175]
    s_nop 4
    s_cmp_eq_u64 exec, -1
    s_mov_b64 exec, -1
    s_cbranch_scc1 GCD_1_38
    buffer_load_dwordx4 v[92:95], v4, s[8:11], 0 offen offset:0 sc1
    buffer_load_dwordx4 v[96:99], v4, s[8:11], 0 offen offset:1024 sc1
    buffer_load_dwordx4 v[100:103], v4, s[8:11], 0 offen offset:2048 sc1
    buffer_load_dwordx4 v[104:107], v4, s[8:11], 0 offen offset:3072 sc1
    buffer_load_dwordx4 v[108:111], v4, s[8:11], s78 offen offset:0 sc1
    buffer_load_dwordx4 v[168:171], v4, s[8:11], s78 offen offset:1024 sc1
    buffer_load_dwordx4 v[172:175], v4, s[8:11], s78 offen offset:2048 sc1
    s_waitcnt vmcnt(0)
    s_add_u32 s80, s80, 1
    s_cmp_lt_u32 s80, 20000
    s_cbranch_scc0 GCD_1_38_to
    s_sleep 1
    s_branch GC_1_37
GCD_1_38_to:
    s_or_b32 s39, s39, 64
GCD_1_38:
    v_rcp_f32 v147, v147
    v_mul_f32 v135, v135, v143
    v_add_f32 v148, 1.0, v148
    v_mul_f32 v137, v129, v145
    v_exp_f32 v151, v151
    v_rcp_f32 v148, v148
    v_add_f32 v149, 1.0, v149
    v_mul_f32 v138, v130, v146
    v_cvt_pk_bf16_f32 v156, v136, v137
    v_rcp_f32 v149, v149
    v_add_f32 v150, 1.0, v150
    v_mul_f32 v139, v131, v147
    v_rcp_f32 v150, v150
    v_add_f32 v151, 1.0, v151
    v_mul_f32 v140, v132, v148
    v_cvt_pk_bf16_f32 v157, v138, v139
    v_rcp_f32 v151, v151
    v_mul_f32 v141, v133, v149
    v_mul_f32 v142, v134, v150
    v_cvt_pk_bf16_f32 v158, v140, v141
    v_mul_f32 v143, v135, v151
    v_cvt_pk_bf16_f32 v159, v142, v143
    s_add_u32 s82, s79, 114688
    buffer_store_dwordx4 v[156:159], v1, s[8:11], s82 offen
    ds_read_b128 v[84:87], v7 offset:33792
    s_waitcnt lgkmcnt(4)
    v_mfma_f32_32x32x16_bf16 v[32:47], a[224:227], v[64:67], 0
    s_barrier
    ds_read_b64 v[152:153], v5 offset:1024
    ds_read_b128 v[88:91], v7 offset:34816
    v_mfma_f32_32x32x16_bf16 v[32:47], a[228:231], v[68:71], v[32:47]
    s_add_u32 s83, s85, 114688
    s_add_u32 m0, s84, 0
    s_nop 0
    buffer_load_dwordx4 v1, s[8:11], s83 offen offset:0 sc1 lds
    ds_read_b128 v[64:67], v7 offset:35840
    s_waitcnt lgkmcnt(5)
    v_mfma_f32_32x32x16_bf16 v[32:47], a[232:235], v[72:75], v[32:47]
    s_add_u32 m0, s84, 0
    s_nop 0
    buffer_load_dwordx4 v1, s[8:11], s83 offen offset:1024 sc1 lds
    v_add_f32 v94, v92, v96
    ds_read_b128 v[68:71], v7 offset:36864
    v_mfma_f32_32x32x16_bf16 v[32:47], a[236:239], v[76:79], v[32:47]
    v_add_f32 v95, v93, v97
    v_add_f32 v94, v94, v100
    v_add_f32 v95, v95, v101
    ds_read_b128 v[72:75], v7 offset:37888
    s_waitcnt lgkmcnt(5)
    v_mfma_f32_32x32x16_bf16 v[32:47], a[240:243], v[80:83], v[32:47]
    s_add_u32 m0, s84, 0
    s_nop 0
    buffer_load_dwordx4 v1, s[8:11], s83 offen offset:2048 sc1 lds
    v_add_f32 v94, v94, v104
    ds_read_b128 v[76:79], v7 offset:38912
    v_mfma_f32_32x32x16_bf16 v[32:47], a[244:247], v[84:87], v[32:47]
    v_add_f32 v95, v95, v105
    v_add_f32 v94, v94, v108
    v_add_f32 v95, v95, v109
    ds_read_b128 v[80:83], v7 offset:39936
    s_waitcnt lgkmcnt(4)
    v_mfma_f32_32x32x16_bf16 v[32:47], a[248:251], v[88:91], v[32:47]
    s_add_u32 m0, s84, 0
    s_nop 0
    buffer_load_dwordx4 v1, s[8:11], s83 offen offset:3072 sc1 lds
    v_add_f32 v94, v94, v168
    ds_read_b128 v[84:87], v7 offset:40960
    v_mfma_f32_32x32x16_bf16 v[32:47], a[252:255], v[64:67], v[32:47]
    s_add_u32 s83, s83, 4096
    s_add_u32 m0, s84, 4096
    s_nop 0
    buffer_load_dwordx4 v1, s[8:11], s83 offen offset:0 sc1 lds
    ds_read_b128 v[88:91], v7 offset:41984
    s_waitcnt lgkmcnt(4)
    v_mfma_f32_32x32x16_bf16 v[32:47], v[176:179], v[68:71], v[32:47]
    v_add_f32 v95, v95, v169
    v_add_f32 v94, v94, v172
    v_add_f32 v95, v95, v173
    v_mov_b32 v98, v94
    ds_read_b128 v[64:67], v7 offset:43008
    v_mfma_f32_32x32x16_bf16 v[32:47], v[180:183], v[72:75], v[32:47]
    s_add_u32 m0, s84, 4096
    s_nop 0
    buffer_load_dwordx4 v1, s[8:11], s83 offen offset:1024 sc1 lds
    ds_read_b128 v[68:71], v7 offset:44032
    s_waitcnt lgkmcnt(4)
    v_mfma_f32_32x32x16_bf16 v[32:47], v[184:187], v[76:79], v[32:47]
    v_mov_b32 v99, v95
    s_nop 0
    v_permlane32_swap_b32 v98, v94
    v_permlane32_swap_b32 v99, v95
    ds_read_b128 v[72:75], v7 offset:45056
    v_mfma_f32_32x32x16_bf16 v[32:47], v[188:191], v[80:83], v[32:47]
    s_add_u32 m0, s84, 4096
    s_nop 0
    buffer_load_dwordx4 v1, s[8:11], s83 offen offset:2048 sc1 lds
    ds_read_b128 v[76:79], v7 offset:46080
    s_waitcnt lgkmcnt(4)
    v_mfma_f32_32x32x16_bf16 v[32:47], v[192:195], v[84:87], v[32:47]
    v_add_f32 v94, v94, v98
    v_add_f32 v95, v95, v99
    v_mul_f32 v100, 0x3b124925, v94
    v_mul_f32 v105, 0x3b124925, v95
    ds_read_b128 v[80:83], v7 offset:47104
    v_mfma_f32_32x32x16_bf16 v[32:47], v[196:199], v[88:91], v[32:47]
    v_fma_f32 v105, -v100, v100, v105
    v_max_f32 v105, 0, v105
    v_add_f32 v105, 0x3727c5ac, v105
    ds_read_b128 v[84:87], v7 offset:48128
    s_waitcnt lgkmcnt(4)
    v_mfma_f32_32x32x16_bf16 v[32:47], v[200:203], v[64:67], v[32:47]
    s_add_u32 s83, s85, 143360
    s_add_u32 m0, s84, 28672
    s_nop 0
    buffer_load_dwordx4 v1, s[8:11], s83 offen offset:0 sc1 lds
    ds_read_b128 v[88:91], v7 offset:49152
    v_mfma_f32_32x32x16_bf16 v[32:47], v[204:207], v[68:71], v[32:47]
    v_rsq_f32 v104, v105
    v_mov_b32 v103, 0
    ds_read_b128 v[64:67], v7 offset:50176
    s_waitcnt lgkmcnt(4)
    v_mfma_f32_32x32x16_bf16 v[32:47], v[208:211], v[72:75], v[32:47]
    s_add_u32 m0, s84, 28672
    s_nop 0
    buffer_load_dwordx4 v1, s[8:11], s83 offen offset:1024 sc1 lds
    v_mul_f32 v101, 0xbfb8aa3b, v104
    ds_read_b128 v[68:71], v7 offset:51200
    v_mfma_f32_32x32x16_bf16 v[32:47], v[212:215], v[76:79], v[32:47]
    v_mul_f32 v102, v104, v104
    v_fma_f32 v128, -v152, v48, v16
    ds_read_b128 v[72:75], v7 offset:52224
    s_waitcnt lgkmcnt(4)
    v_mfma_f32_32x32x16_bf16 v[32:47], v[216:219], v[80:83], v[32:47]
    s_add_u32 m0, s84, 28672
    s_nop 0
    buffer_load_dwordx4 v1, s[8:11], s83 offen offset:2048 sc1 lds
    v_fma_f32 v136, -v152, v56, v24
    ds_read_b128 v[76:79], v7 offset:53248
    v_mfma_f32_32x32x16_bf16 v[32:47], v[220:223], v[84:87], v[32:47]
    s_lshl_b32 s80, s36, 9
    v_add_u32 v108, s80, v5
    ds_write_b128 v108, v[100:103] offset:2048
    ds_read_b128 v[80:83], v7 offset:54272
    s_waitcnt lgkmcnt(5)
    v_mfma_f32_32x32x16_bf16 v[32:47], v[224:227], v[88:91], v[32:47]
    s_add_u32 m0, s84, 28672
    s_nop 0
    buffer_load_dwordx4 v1, s[8:11], s83 offen offset:3072 sc1 lds
    s_waitcnt vmcnt(11)
    buffer_store_dwordx2 v[10:11], v8, s[8:11], 0 offen offset:896
    s_waitcnt vmcnt(5)
    ds_read_b128 v[84:87], v7 offset:55296
    v_mfma_f32_32x32x16_bf16 v[32:47], v[228:231], v[64:67], v[32:47]
    s_barrier
    v_fma_f32 v129, -v152, v49, v17
    v_fma_f32 v137, -v152, v57, v25
    ds_read_b128 v[88:91], v7 offset:56320
    s_waitcnt lgkmcnt(5)
    v_mfma_f32_32x32x16_bf16 v[32:47], v[232:235], v[68:71], v[32:47]
    s_add_u32 s83, s83, 4096
    s_add_u32 m0, s84, 32768
    s_nop 0
    buffer_load_dwordx4 v1, s[8:11], s83 offen offset:0 sc1 lds
    ds_read_b128 v[64:67], v2 offset:0
    v_mfma_f32_32x32x16_bf16 v[32:47], v[236:239], v[72:75], v[32:47]
    v_mul_f32 v144, v128, v153
    v_mul_f32 v128, v128, v136
    v_fma_f32 v130, -v152, v50, v18
    ds_read_b128 v[68:71], v2 offset:1024
    s_waitcnt lgkmcnt(4)
    v_mfma_f32_32x32x16_bf16 v[32:47], v[240:243], v[76:79], v[32:47]
    s_add_u32 m0, s84, 32768
    s_nop 0
    buffer_load_dwordx4 v1, s[8:11], s83 offen offset:1024 sc1 lds
    ds_read_b128 v[72:75], v2 offset:2048
    v_mfma_f32_32x32x16_bf16 v[32:47], v[244:247], v[80:83], v[32:47]
    v_exp_f32 v144, v144
    v_fma_f32 v138, -v152, v58, v26
    ds_read_b128 v[76:79], v2 offset:3072
    s_waitcnt lgkmcnt(4)
    v_mfma_f32_32x32x16_bf16 v[32:47], v[248:251], v[84:87], v[32:47]
    s_add_u32 m0, s84, 32768
    s_nop 0
    buffer_load_dwordx4 v1, s[8:11], s83 offen offset:2048 sc1 lds
    v_mul_f32 v145, v129, v153
    ds_read_b128 v[80:83], v2 offset:4096
    v_mfma_f32_32x32x16_bf16 v[32:47], v[252:255], v[88:91], v[32:47]
    v_mul_f32 v129, v129, v137
    v_fma_f32 v131, -v152, v51, v19
    v_exp_f32 v145, v145
    v_fma_f32 v139, -v152, v59, v27
    v_mul_f32 v146, v130, v153
    v_mul_f32 v130, v130, v138
    v_fma_f32 v132, -v152, v52, v20
    v_exp_f32 v146, v146
    v_fma_f32 v140, -v152, v60, v28
    v_mul_f32 v147, v131, v153
    v_mul_f32 v131, v131, v139
    v_add_f32 v144, 1.0, v144
    v_fma_f32 v133, -v152, v53, v21
    v_exp_f32 v147, v147
    v_fma_f32 v141, -v152, v61, v29
    v_mul_f32 v148, v132, v153
    v_rcp_f32 v144, v144
    v_mul_f32 v132, v132, v140
    v_add_f32 v145, 1.0, v145
    v_fma_f32 v134, -v152, v54, v22
    v_exp_f32 v148, v148
    v_fma_f32 v142, -v152, v62, v30
    v_mul_f32 v149, v133, v153
    v_rcp_f32 v145, v145
    v_mul_f32 v133, v133, v141
    v_add_f32 v146, 1.0, v146
    v_fma_f32 v135, -v152, v55, v23
    v_exp_f32 v149, v149
    v_fma_f32 v143, -v152, v63, v31
    v_mul_f32 v150, v134, v153
    v_rcp_f32 v146, v146
    v_mul_f32 v134, v134, v142
    v_add_f32 v147, 1.0, v147
    v_mul_f32 v136, v128, v144
    v_exp_f32 v150, v150
    v_mul_f32 v151, v135, v153
    v_rcp_f32 v147, v147
    v_mul_f32 v135, v135, v143
    v_add_f32 v148, 1.0, v148
    v_mul_f32 v137, v129, v145
    v_exp_f32 v151, v151
    v_rcp_f32 v148, v148
    v_add_f32 v149, 1.0, v149
    v_mul_f32 v138, v130, v146
    v_cvt_pk_bf16_f32 v156, v136, v137
    v_rcp_f32 v149, v149
    v_add_f32 v150, 1.0, v150
    v_mul_f32 v139, v131, v147
    v_rcp_f32 v150, v150
    v_add_f32 v151, 1.0, v151
    v_mul_f32 v140, v132, v148
    v_cvt_pk_bf16_f32 v157, v138, v139
    v_rcp_f32 v151, v151
    v_mul_f32 v141, v133, v149
    v_mul_f32 v142, v134, v150
    v_cvt_pk_bf16_f32 v158, v140, v141
    v_mul_f32 v143, v135, v151
    v_cvt_pk_bf16_f32 v159, v142, v143
    s_add_u32 s82, s79, 229376
    buffer_store_dwordx4 v[156:159], v1, s[8:11], s82 offen
    ds_read_b128 v[84:87], v2 offset:5120
    s_waitcnt lgkmcnt(4)
    v_mfma_f32_32x32x16_bf16 v[16:31], a[224:227], v[64:67], 0
    s_add_u32 s83, s85, 172032
    s_add_u32 m0, s84, 57344
    s_nop 0
    buffer_load_dwordx4 v1, s[8:11], s83 offen offset:0 sc1 lds
    ds_read_b64 v[152:153], v5 offset:1536
    ds_read_b128 v[88:91], v2 offset:6144
    v_mfma_f32_32x32x16_bf16 v[16:31], a[228:231], v[68:71], v[16:31]
    ds_read_b128 v[64:67], v2 offset:7168
    s_waitcnt lgkmcnt(5)
    v_mfma_f32_32x32x16_bf16 v[16:31], a[232:235], v[72:75], v[16:31]
    s_add_u32 m0, s84, 57344
    s_nop 0
    buffer_load_dwordx4 v1, s[8:11], s83 offen offset:1024 sc1 lds
    s_waitcnt lgkmcnt(2)
    ds_read_b128 v[68:71], v2 offset:8192
    v_mfma_f32_32x32x16_bf16 v[16:31], a[236:239], v[76:79], v[16:31]
    v_fma_f32 v128, -v152, v48, v32
    v_fma_f32 v136, -v152, v56, v40
    v_fma_f32 v129, -v152, v49, v33
    ds_read_b128 v[72:75], v2 offset:9216
    v_mfma_f32_32x32x16_bf16 v[16:31], a[240:243], v[80:83], v[16:31]
    v_fma_f32 v137, -v152, v57, v41
    v_mul_f32 v144, v128, v153
    v_mul_f32 v128, v128, v136
    v_fma_f32 v130, -v152, v50, v34
    ds_read_b128 v[76:79], v2 offset:10240
    v_mfma_f32_32x32x16_bf16 v[16:31], a[244:247], v[84:87], v[16:31]
    s_add_u32 m0, s84, 57344
    s_nop 0
    buffer_load_dwordx4 v1, s[8:11], s83 offen offset:2048 sc1 lds
    ds_read_b128 v[80:83], v2 offset:11264
    s_waitcnt lgkmcnt(4)
    v_mfma_f32_32x32x16_bf16 v[16:31], a[248:251], v[88:91], v[16:31]
    v_exp_f32 v144, v144
    v_fma_f32 v138, -v152, v58, v42
    v_mul_f32 v145, v129, v153
    ds_read_b128 v[84:87], v2 offset:12288
    v_mfma_f32_32x32x16_bf16 v[16:31], a[252:255], v[64:67], v[16:31]
    v_mul_f32 v129, v129, v137
    v_fma_f32 v131, -v152, v51, v35
    ds_read_b128 v[88:91], v2 offset:13312
    s_waitcnt lgkmcnt(4)
    v_mfma_f32_32x32x16_bf16 v[16:31], v[176:179], v[68:71], v[16:31]
    s_add_u32 m0, s84, 57344
    s_nop 0
    buffer_load_dwordx4 v1, s[8:11], s83 offen offset:3072 sc1 lds
    ds_read_b128 v[64:67], v2 offset:14336
    v_mfma_f32_32x32x16_bf16 v[16:31], v[180:183], v[72:75], v[16:31]
    v_exp_f32 v145, v145
    v_fma_f32 v139, -v152, v59, v43
    ds_read_b128 v[68:71], v2 offset:15360
    s_waitcnt lgkmcnt(4)
    v_mfma_f32_32x32x16_bf16 v[16:31], v[184:187], v[76:79], v[16:31]
    v_mul_f32 v146, v130, v153
    v_mul_f32 v130, v130, v138
    v_fma_f32 v132, -v152, v52, v36
    ds_read_b128 v[72:75], v2 offset:16384
    v_mfma_f32_32x32x16_bf16 v[16:31], v[188:191], v[80:83], v[16:31]
    s_add_u32 s83, s83, 4096
    s_add_u32 m0, s84, 61440
    s_nop 0
    buffer_load_dwordx4 v1, s[8:11], s83 offen offset:0 sc1 lds
    ds_read_b128 v[76:79], v2 offset:17408
    s_waitcnt lgkmcnt(4)
    v_mfma_f32_32x32x16_bf16 v[16:31], v[192:195], v[84:87], v[16:31]
    v_exp_f32 v146, v146
    v_fma_f32 v140, -v152, v60, v44
    v_mul_f32 v147, v131, v153
    ds_read_b128 v[80:83], v2 offset:18432
    v_mfma_f32_32x32x16_bf16 v[16:31], v[196:199], v[88:91], v[16:31]
    v_mul_f32 v131, v131, v139
    v_add_f32 v144, 1.0, v144
    v_fma_f32 v133, -v152, v53, v37
    ds_read_b128 v[84:87], v2 offset:19456
    s_waitcnt lgkmcnt(4)
    v_mfma_f32_32x32x16_bf16 v[16:31], v[200:203], v[64:67], v[16:31]
    s_add_u32 m0, s84, 61440
    s_nop 0
    buffer_load_dwordx4 v1, s[8:11], s83 offen offset:1024 sc1 lds
    ds_read_b128 v[88:91], v2 offset:20480
    v_mfma_f32_32x32x16_bf16 v[16:31], v[204:207], v[68:71], v[16:31]
    v_exp_f32 v147, v147
    v_fma_f32 v141, -v152, v61, v45
    ds_read_b128 v[64:67], v2 offset:21504
    s_waitcnt lgkmcnt(4)
    v_mfma_f32_32x32x16_bf16 v[16:31], v[208:211], v[72:75], v[16:31]
    v_mul_f32 v148, v132, v153
    v_rcp_f32 v144, v144
    v_mul_f32 v132, v132, v140
    ds_read_b128 v[68:71], v2 offset:22528
    v_mfma_f32_32x32x16_bf16 v[16:31], v[212:215], v[76:79], v[16:31]
    s_add_u32 m0, s84, 61440
    s_nop 0
    buffer_load_dwordx4 v1, s[8:11], s83 offen offset:2048 sc1 lds
    ds_read_b128 v[72:75], v2 offset:23552
    s_waitcnt lgkmcnt(4)
    v_mfma_f32_32x32x16_bf16 v[16:31], v[216:219], v[80:83], v[16:31]
    v_add_f32 v145, 1.0, v145
    v_fma_f32 v134, -v152, v54, v38
    v_exp_f32 v148, v148
    ds_read_b128 v[76:79], v2 offset:24576
    v_mfma_f32_32x32x16_bf16 v[16:31], v[220:223], v[84:87], v[16:31]
    v_fma_f32 v142, -v152, v62, v46
    v_mul_f32 v149, v133, v153
    ds_read_b128 v[80:83], v2 offset:25600
    s_waitcnt lgkmcnt(4)
    v_mfma_f32_32x32x16_bf16 v[16:31], v[224:227], v[88:91], v[16:31]
    s_waitcnt vmcnt(7)
    buffer_store_dwordx2 v[10:11], v8, s[8:11], 0 offen offset:1792
    ds_read_b128 v[84:87], v2 offset:26624
    v_mfma_f32_32x32x16_bf16 v[16:31], v[228:231], v[64:67], v[16:31]
    s_barrier
    v_rcp_f32 v145, v145
    ds_read_b128 v[88:91], v2 offset:27648
    s_waitcnt lgkmcnt(4)
    v_mfma_f32_32x32x16_bf16 v[16:31], v[232:235], v[68:71], v[16:31]
    v_mul_f32 v133, v133, v141
    v_add_f32 v146, 1.0, v146
    v_fma_f32 v135, -v152, v55, v39
    ds_read_b128 v[64:67], v2 offset:28672
    v_mfma_f32_32x32x16_bf16 v[16:31], v[236:239], v[72:75], v[16:31]
    v_exp_f32 v149, v149
    v_fma_f32 v143, -v152, v63, v47
    ds_read_b128 v[68:71], v2 offset:29696
    s_waitcnt lgkmcnt(4)
    v_mfma_f32_32x32x16_bf16 v[16:31], v[240:243], v[76:79], v[16:31]
    v_mul_f32 v150, v134, v153
    v_rcp_f32 v146, v146
    v_mul_f32 v134, v134, v142
    ds_read_b128 v[72:75], v2 offset:30720
    v_mfma_f32_32x32x16_bf16 v[16:31], v[244:247], v[80:83], v[16:31]
    v_add_f32 v147, 1.0, v147
    v_mul_f32 v136, v128, v144
    ds_read_b128 v[76:79], v2 offset:31744
    s_waitcnt lgkmcnt(4)
    v_mfma_f32_32x32x16_bf16 v[16:31], v[248:251], v[84:87], v[16:31]
    v_exp_f32 v150, v150
    v_mul_f32 v151, v135, v153
    ds_read_b128 v[80:83], v2 offset:32768
    v_mfma_f32_32x32x16_bf16 v[16:31], v[252:255], v[88:91], v[16:31]
    v_rcp_f32 v147, v147
    v_mul_f32 v135, v135, v143
    v_add_f32 v148, 1.0, v148
    v_mul_f32 v137, v129, v145
    v_exp_f32 v151, v151
    v_rcp_f32 v148, v148
    v_add_f32 v149, 1.0, v149
    v_mul_f32 v138, v130, v146
    v_cvt_pk_bf16_f32 v156, v136, v137
    v_rcp_f32 v149, v149
    v_add_f32 v150, 1.0, v150
    v_mul_f32 v139, v131, v147
    v_rcp_f32 v150, v150
    v_add_f32 v151, 1.0, v151
    v_mul_f32 v140, v132, v148
    v_cvt_pk_bf16_f32 v157, v138, v139
    v_rcp_f32 v151, v151
    v_mul_f32 v141, v133, v149
    v_mul_f32 v142, v134, v150
    v_cvt_pk_bf16_f32 v158, v140, v141
    v_mul_f32 v143, v135, v151
    v_cvt_pk_bf16_f32 v159, v142, v143
    s_add_u32 s82, s79, 344064
    buffer_store_dwordx4 v[156:159], v1, s[8:11], s82 offen
    ds_read_b128 v[84:87], v2 offset:33792
    s_waitcnt lgkmcnt(4)
    v_mfma_f32_32x32x16_bf16 v[32:47], a[224:227], v[64:67], 0
    s_add_u32 s83, s85, 200704
    s_add_u32 m0, s84, 86016
    s_nop 0
    buffer_load_dwordx4 v1, s[8:11], s83 offen offset:0 sc1 lds
    ds_read_b64 v[152:153], v5 offset:2048
    ds_read_b128 v[88:91], v2 offset:34816
    v_mfma_f32_32x32x16_bf16 v[32:47], a[228:231], v[68:71], v[32:47]
    ds_read_b128 v[64:67], v2 offset:35840
    s_waitcnt lgkmcnt(5)
    v_mfma_f32_32x32x16_bf16 v[32:47], a[232:235], v[72:75], v[32:47]
    s_add_u32 m0, s84, 86016
    s_nop 0
    buffer_load_dwordx4 v1, s[8:11], s83 offen offset:1024 sc1 lds
    s_waitcnt lgkmcnt(2)
    ds_read_b128 v[68:71], v2 offset:36864
    v_mfma_f32_32x32x16_bf16 v[32:47], a[236:239], v[76:79], v[32:47]
    v_fma_f32 v128, -v152, v48, v16
    v_fma_f32 v136, -v152, v56, v24
    v_fma_f32 v129, -v152, v49, v17
    ds_read_b128 v[72:75], v2 offset:37888
    v_mfma_f32_32x32x16_bf16 v[32:47], a[240:243], v[80:83], v[32:47]
    v_fma_f32 v137, -v152, v57, v25
    v_mul_f32 v144, v128, v153
    v_mul_f32 v128, v128, v136
    v_fma_f32 v130, -v152, v50, v18
    ds_read_b128 v[76:79], v2 offset:38912
    v_mfma_f32_32x32x16_bf16 v[32:47], a[244:247], v[84:87], v[32:47]
    s_add_u32 m0, s84, 86016
    s_nop 0
    buffer_load_dwordx4 v1, s[8:11], s83 offen offset:2048 sc1 lds
    ds_read_b128 v[80:83], v2 offset:39936
    s_waitcnt lgkmcnt(4)
    v_mfma_f32_32x32x16_bf16 v[32:47], a[248:251], v[88:91], v[32:47]
    v_exp_f32 v144, v144
    v_fma_f32 v138, -v152, v58, v26
    v_mul_f32 v145, v129, v153
    ds_read_b128 v[84:87], v2 offset:40960
    v_mfma_f32_32x32x16_bf16 v[32:47], a[252:255], v[64:67], v[32:47]
    v_mul_f32 v129, v129, v137
    v_fma_f32 v131, -v152, v51, v19
    ds_read_b128 v[88:91], v2 offset:41984
    s_waitcnt lgkmcnt(4)
    v_mfma_f32_32x32x16_bf16 v[32:47], v[176:179], v[68:71], v[32:47]
    s_add_u32 m0, s84, 86016
    s_nop 0
    buffer_load_dwordx4 v1, s[8:11], s83 offen offset:3072 sc1 lds
    ds_read_b128 v[64:67], v2 offset:43008
    v_mfma_f32_32x32x16_bf16 v[32:47], v[180:183], v[72:75], v[32:47]
    v_exp_f32 v145, v145
    v_fma_f32 v139, -v152, v59, v27
    ds_read_b128 v[68:71], v2 offset:44032
    s_waitcnt lgkmcnt(4)
    v_mfma_f32_32x32x16_bf16 v[32:47], v[184:187], v[76:79], v[32:47]
    v_mul_f32 v146, v130, v153
    v_mul_f32 v130, v130, v138
    v_fma_f32 v132, -v152, v52, v20
    ds_read_b128 v[72:75], v2 offset:45056
    v_mfma_f32_32x32x16_bf16 v[32:47], v[188:191], v[80:83], v[32:47]
    s_add_u32 s83, s83, 4096
    s_add_u32 m0, s84, 90112
    s_nop 0
    buffer_load_dwordx4 v1, s[8:11], s83 offen offset:0 sc1 lds
    ds_read_b128 v[76:79], v2 offset:46080
    s_waitcnt lgkmcnt(4)
    v_mfma_f32_32x32x16_bf16 v[32:47], v[192:195], v[84:87], v[32:47]
    v_exp_f32 v146, v146
    v_fma_f32 v140, -v152, v60, v28
    v_mul_f32 v147, v131, v153
    ds_read_b128 v[80:83], v2 offset:47104
    v_mfma_f32_32x32x16_bf16 v[32:47], v[196:199], v[88:91], v[32:47]
    v_mul_f32 v131, v131, v139
    v_add_f32 v144, 1.0, v144
    v_fma_f32 v133, -v152, v53, v21
    ds_read_b128 v[84:87], v2 offset:48128
    s_waitcnt lgkmcnt(4)
    v_mfma_f32_32x32x16_bf16 v[32:47], v[200:203], v[64:67], v[32:47]
    s_add_u32 m0, s84, 90112
    s_nop 0
    buffer_load_dwordx4 v1, s[8:11], s83 offen offset:1024 sc1 lds
    ds_read_b128 v[88:91], v2 offset:49152
    v_mfma_f32_32x32x16_bf16 v[32:47], v[204:207], v[68:71], v[32:47]
    v_exp_f32 v147, v147
    v_fma_f32 v141, -v152, v61, v29
    ds_read_b128 v[64:67], v2 offset:50176
    s_waitcnt lgkmcnt(4)
    v_mfma_f32_32x32x16_bf16 v[32:47], v[208:211], v[72:75], v[32:47]
    v_mul_f32 v148, v132, v153
    v_rcp_f32 v144, v144
    v_mul_f32 v132, v132, v140
    ds_read_b128 v[68:71], v2 offset:51200
    v_mfma_f32_32x32x16_bf16 v[32:47], v[212:215], v[76:79], v[32:47]
    s_add_u32 m0, s84, 90112
    s_nop 0
    buffer_load_dwordx4 v1, s[8:11], s83 offen offset:2048 sc1 lds
    ds_read_b128 v[72:75], v2 offset:52224
    s_waitcnt lgkmcnt(4)
    v_mfma_f32_32x32x16_bf16 v[32:47], v[216:219], v[80:83], v[32:47]
    v_add_f32 v145, 1.0, v145
    v_fma_f32 v134, -v152, v54, v22
    v_exp_f32 v148, v148
    ds_read_b128 v[76:79], v2 offset:53248
    v_mfma_f32_32x32x16_bf16 v[32:47], v[220:223], v[84:87], v[32:47]
    v_fma_f32 v142, -v152, v62, v30
    v_mul_f32 v149, v133, v153
    ds_read_b128 v[80:83], v2 offset:54272
    s_waitcnt lgkmcnt(4)
    v_mfma_f32_32x32x16_bf16 v[32:47], v[224:227], v[88:91], v[32:47]
    s_waitcnt vmcnt(7)
    buffer_store_dwordx2 v[10:11], v8, s[8:11], 0 offen offset:2688
    ds_read_b128 v[84:87], v2 offset:55296
    v_mfma_f32_32x32x16_bf16 v[32:47], v[228:231], v[64:67], v[32:47]
    s_barrier
    v_rcp_f32 v145, v145
    ds_read_b128 v[88:91], v2 offset:56320
    s_waitcnt lgkmcnt(4)
    v_mfma_f32_32x32x16_bf16 v[32:47], v[232:235], v[68:71], v[32:47]
    v_mul_f32 v133, v133, v141
    v_add_f32 v146, 1.0, v146
    v_fma_f32 v135, -v152, v55, v23
    ds_read_b128 v[64:67], v7 offset:0
    v_mfma_f32_32x32x16_bf16 v[32:47], v[236:239], v[72:75], v[32:47]
    v_exp_f32 v149, v149
    v_fma_f32 v143, -v152, v63, v31
    ds_read_b128 v[68:71], v7 offset:1024
    s_waitcnt lgkmcnt(4)
    v_mfma_f32_32x32x16_bf16 v[32:47], v[240:243], v[76:79], v[32:47]
    v_mul_f32 v150, v134, v153
    v_rcp_f32 v146, v146
    v_mul_f32 v134, v134, v142
    ds_read_b128 v[72:75], v7 offset:2048
    v_mfma_f32_32x32x16_bf16 v[32:47], v[244:247], v[80:83], v[32:47]
    v_add_f32 v147, 1.0, v147
    v_mul_f32 v136, v128, v144
    ds_read_b128 v[76:79], v7 offset:3072
    s_waitcnt lgkmcnt(4)
    v_mfma_f32_32x32x16_bf16 v[32:47], v[248:251], v[84:87], v[32:47]
    v_exp_f32 v150, v150
    v_mul_f32 v151, v135, v153
    ds_read_b128 v[80:83], v7 offset:4096
    v_mfma_f32_32x32x16_bf16 v[32:47], v[252:255], v[88:91], v[32:47]
    v_rcp_f32 v147, v147
    v_mul_f32 v135, v135, v143
    v_add_f32 v148, 1.0, v148
    v_mul_f32 v137, v129, v145
    v_exp_f32 v151, v151
    v_rcp_f32 v148, v148
    v_add_f32 v149, 1.0, v149
    v_mul_f32 v138, v130, v146
    v_cvt_pk_bf16_f32 v156, v136, v137
    v_rcp_f32 v149, v149
    v_add_f32 v150, 1.0, v150
    v_mul_f32 v139, v131, v147
    v_rcp_f32 v150, v150
    v_add_f32 v151, 1.0, v151
    v_mul_f32 v140, v132, v148
    v_cvt_pk_bf16_f32 v157, v138, v139
    v_rcp_f32 v151, v151
    v_mul_f32 v141, v133, v149
    v_mul_f32 v142, v134, v150
    v_cvt_pk_bf16_f32 v158, v140, v141
    v_mul_f32 v143, v135, v151
    v_cvt_pk_bf16_f32 v159, v142, v143
    s_add_u32 s82, s79, 458752
    buffer_store_dwordx4 v[156:159], v1, s[8:11], s82 offen
    ds_read_b128 v[84:87], v7 offset:5120
    s_waitcnt lgkmcnt(4)
    v_mfma_f32_32x32x16_bf16 v[16:31], a[224:227], v[64:67], 0
    ds_read_b64 v[152:153], v5 offset:2560
    ds_read_b128 v[88:91], v7 offset:6144
    v_mfma_f32_32x32x16_bf16 v[16:31], a[228:231], v[68:71], v[16:31]
    ds_read_b128 v[64:67], v7 offset:7168
    s_waitcnt lgkmcnt(5)
    v_mfma_f32_32x32x16_bf16 v[16:31], a[232:235], v[72:75], v[16:31]
    s_waitcnt lgkmcnt(2)
    v_fma_f32 v128, -v152, v48, v32
    v_fma_f32 v136, -v152, v56, v40
    v_fma_f32 v129, -v152, v49, v33
    ds_read_b128 v[68:71], v7 offset:8192
    v_mfma_f32_32x32x16_bf16 v[16:31], a[236:239], v[76:79], v[16:31]
    v_fma_f32 v137, -v152, v57, v41
    v_mul_f32 v144, v128, v153
    v_mul_f32 v128, v128, v136
    ds_read_b128 v[72:75], v7 offset:9216
    v_mfma_f32_32x32x16_bf16 v[16:31], a[240:243], v[80:83], v[16:31]
    v_fma_f32 v130, -v152, v50, v34
    v_exp_f32 v144, v144
    v_fma_f32 v138, -v152, v58, v42
    ds_read_b128 v[76:79], v7 offset:10240
    v_mfma_f32_32x32x16_bf16 v[16:31], a[244:247], v[84:87], v[16:31]
    v_mul_f32 v145, v129, v153
    v_mul_f32 v129, v129, v137
    v_fma_f32 v131, -v152, v51, v35
    ds_read_b128 v[80:83], v7 offset:11264
    s_waitcnt lgkmcnt(4)
    v_mfma_f32_32x32x16_bf16 v[16:31], a[248:251], v[88:91], v[16:31]
    v_exp_f32 v145, v145
    v_fma_f32 v139, -v152, v59, v43
    v_mul_f32 v146, v130, v153
    ds_read_b128 v[84:87], v7 offset:12288
    v_mfma_f32_32x32x16_bf16 v[16:31], a[252:255], v[64:67], v[16:31]
    v_mul_f32 v130, v130, v138
    v_fma_f32 v132, -v152, v52, v36
    ds_read_b128 v[88:91], v7 offset:13312
    s_waitcnt lgkmcnt(4)
    v_mfma_f32_32x32x16_bf16 v[16:31], v[176:179], v[68:71], v[16:31]
    v_exp_f32 v146, v146
    v_fma_f32 v140, -v152, v60, v44
    v_mul_f32 v147, v131, v153
    ds_read_b128 v[64:67], v7 offset:14336
    v_mfma_f32_32x32x16_bf16 v[16:31], v[180:183], v[72:75], v[16:31]
    v_mul_f32 v131, v131, v139
    v_add_f32 v144, 1.0, v144
    v_fma_f32 v133, -v152, v53, v37
    ds_read_b128 v[68:71], v7 offset:15360
    s_waitcnt lgkmcnt(4)
    v_mfma_f32_32x32x16_bf16 v[16:31], v[184:187], v[76:79], v[16:31]
    v_exp_f32 v147, v147
    v_fma_f32 v141, -v152, v61, v45
    v_mul_f32 v148, v132, v153
    ds_read_b128 v[72:75], v7 offset:16384
    v_mfma_f32_32x32x16_bf16 v[16:31], v[188:191], v[80:83], v[16:31]
    v_rcp_f32 v144, v144
    v_mul_f32 v132, v132, v140
    ds_read_b128 v[76:79], v7 offset:17408
    s_waitcnt lgkmcnt(4)
    v_mfma_f32_32x32x16_bf16 v[16:31], v[192:195], v[84:87], v[16:31]
    v_add_f32 v145, 1.0, v145
    v_fma_f32 v134, -v152, v54, v38
    v_exp_f32 v148, v148
    ds_read_b128 v[80:83], v7 offset:18432
    v_mfma_f32_32x32x16_bf16 v[16:31], v[196:199], v[88:91], v[16:31]
    v_fma_f32 v142, -v152, v62, v46
    v_mul_f32 v149, v133, v153
    ds_read_b128 v[84:87], v7 offset:19456
    s_waitcnt lgkmcnt(4)
    v_mfma_f32_32x32x16_bf16 v[16:31], v[200:203], v[64:67], v[16:31]
    v_rcp_f32 v145, v145
    v_mul_f32 v133, v133, v141
    v_add_f32 v146, 1.0, v146
    ds_read_b128 v[88:91], v7 offset:20480
    v_mfma_f32_32x32x16_bf16 v[16:31], v[204:207], v[68:71], v[16:31]
    v_fma_f32 v135, -v152, v55, v39
    v_exp_f32 v149, v149
    ds_read_b128 v[64:67], v7 offset:21504
    s_waitcnt lgkmcnt(4)
    v_mfma_f32_32x32x16_bf16 v[16:31], v[208:211], v[72:75], v[16:31]
    v_fma_f32 v143, -v152, v63, v47
    v_mul_f32 v150, v134, v153
    v_rcp_f32 v146, v146
    ds_read_b128 v[68:71], v7 offset:22528
    v_mfma_f32_32x32x16_bf16 v[16:31], v[212:215], v[76:79], v[16:31]
    v_mul_f32 v134, v134, v142
    v_add_f32 v147, 1.0, v147
    v_mul_f32 v136, v128, v144
    ds_read_b128 v[72:75], v7 offset:23552
    s_waitcnt lgkmcnt(4)
    v_mfma_f32_32x32x16_bf16 v[16:31], v[216:219], v[80:83], v[16:31]
    v_exp_f32 v150, v150
    v_mul_f32 v151, v135, v153
    ds_read_b128 v[76:79], v7 offset:24576
    v_mfma_f32_32x32x16_bf16 v[16:31], v[220:223], v[84:87], v[16:31]
    v_rcp_f32 v147, v147
    v_mul_f32 v135, v135, v143
    ds_read_b128 v[80:83], v7 offset:25600
    s_waitcnt lgkmcnt(4)
    v_mfma_f32_32x32x16_bf16 v[16:31], v[224:227], v[88:91], v[16:31]
    s_waitcnt vmcnt(0)
    buffer_store_dwordx2 v[10:11], v9, s[8:11], 0 offen offset:0
    ds_read_b128 v[84:87], v7 offset:26624
    v_mfma_f32_32x32x16_bf16 v[16:31], v[228:231], v[64:67], v[16:31]
    s_barrier
    v_add_f32 v148, 1.0, v148
    v_mul_f32 v137, v129, v145
    ds_read_b128 v[88:91], v7 offset:27648
    s_waitcnt lgkmcnt(4)
    v_mfma_f32_32x32x16_bf16 v[16:31], v[232:235], v[68:71], v[16:31]
    v_exp_f32 v151, v151
    v_rcp_f32 v148, v148
    ds_read_b128 v[64:67], v7 offset:28672
    v_mfma_f32_32x32x16_bf16 v[16:31], v[236:239], v[72:75], v[16:31]
    v_add_f32 v149, 1.0, v149
    v_mul_f32 v138, v130, v146
    v_cvt_pk_bf16_f32 v156, v136, v137
    ds_read_b128 v[68:71], v7 offset:29696
    s_waitcnt lgkmcnt(4)
    v_mfma_f32_32x32x16_bf16 v[16:31], v[240:243], v[76:79], v[16:31]
    v_rcp_f32 v149, v149
    v_add_f32 v150, 1.0, v150
    v_mul_f32 v139, v131, v147
    ds_read_b128 v[72:75], v7 offset:30720
    v_mfma_f32_32x32x16_bf16 v[16:31], v[244:247], v[80:83], v[16:31]
    v_rcp_f32 v150, v150
    v_add_f32 v151, 1.0, v151
    ds_read_b128 v[76:79], v7 offset:31744
    s_waitcnt lgkmcnt(4)
    v_mfma_f32_32x32x16_bf16 v[16:31], v[248:251], v[84:87], v[16:31]
    v_mul_f32 v140, v132, v148
    v_cvt_pk_bf16_f32 v157, v138, v139
    v_rcp_f32 v151, v151
    ds_read_b128 v[80:83], v7 offset:32768
    v_mfma_f32_32x32x16_bf16 v[16:31], v[252:255], v[88:91], v[16:31]
    v_mul_f32 v141, v133, v149
    v_mul_f32 v142, v134, v150
    v_cvt_pk_bf16_f32 v158, v140, v141
    v_mul_f32 v143, v135, v151
    v_cvt_pk_bf16_f32 v159, v142, v143
    s_add_u32 s82, s79, 573440
    buffer_store_dwordx4 v[156:159], v1, s[8:11], s82 offen
    ds_read_b128 v[84:87], v7 offset:33792
    s_waitcnt lgkmcnt(4)
    v_mfma_f32_32x32x16_bf16 v[32:47], a[224:227], v[64:67], 0
    ds_read_b64 v[152:153], v5 offset:3072
    ds_read_b128 v[88:91], v7 offset:34816
    v_mfma_f32_32x32x16_bf16 v[32:47], a[228:231], v[68:71], v[32:47]
    s_add_u32 s82, s76, s67
    s_mul_i32 s82, s82, 112
    s_mul_i32 s83, s36, 28
    s_add_u32 s82, s82, s83
    s_lshl_b32 s83, s82, 3
    s_add_u32 s83, s83, s74
    v_min_u32 v3, 27, v0
    v_lshlrev_b32 v3, 3, v3
    v_add_u32 v3, s83, v3
    s_lshl_b32 s94, s82, 10
    s_add_u32 s94, s94, s72
    buffer_load_dwordx2 v[168:169], v3, s[8:11], 0 offen sc1
    ds_read_b128 v[64:67], v7 offset:35840
    s_waitcnt lgkmcnt(5)
    v_mfma_f32_32x32x16_bf16 v[32:47], a[232:235], v[72:75], v[32:47]
    s_waitcnt lgkmcnt(2)
    v_fma_f32 v128, -v152, v48, v16
    v_fma_f32 v136, -v152, v56, v24
    v_fma_f32 v129, -v152, v49, v17
    ds_read_b128 v[68:71], v7 offset:36864
    v_mfma_f32_32x32x16_bf16 v[32:47], a[236:239], v[76:79], v[32:47]
    v_fma_f32 v137, -v152, v57, v25
    v_mul_f32 v144, v128, v153
    v_mul_f32 v128, v128, v136
    ds_read_b128 v[72:75], v7 offset:37888
    v_mfma_f32_32x32x16_bf16 v[32:47], a[240:243], v[80:83], v[32:47]
    v_fma_f32 v130, -v152, v50, v18
    v_exp_f32 v144, v144
    v_fma_f32 v138, -v152, v58, v26
    ds_read_b128 v[76:79], v7 offset:38912
    v_mfma_f32_32x32x16_bf16 v[32:47], a[244:247], v[84:87], v[32:47]
    v_mul_f32 v145, v129, v153
    v_mul_f32 v129, v129, v137
    v_fma_f32 v131, -v152, v51, v19
    s_add_u32 s82, s76, s67
    s_add_u32 s82, s82, 4
    s_mul_i32 s82, s82, 112
    s_mul_i32 s83, s36, 28
    s_add_u32 s82, s82, s83
    s_lshl_b32 s83, s82, 3
    s_add_u32 s83, s83, s74
    v_min_u32 v4, 27, v0
    v_lshlrev_b32 v4, 3, v4
    v_add_u32 v4, s83, v4
    s_lshl_b32 s95, s82, 10
    s_add_u32 s95, s95, s72
    ds_read_b128 v[80:83], v7 offset:39936
    s_waitcnt lgkmcnt(4)
    v_mfma_f32_32x32x16_bf16 v[32:47], a[248:251], v[88:91], v[32:47]
    v_exp_f32 v145, v145
    v_fma_f32 v139, -v152, v59, v27
    v_mul_f32 v146, v130, v153
    ds_read_b128 v[84:87], v7 offset:40960
    v_mfma_f32_32x32x16_bf16 v[32:47], a[252:255], v[64:67], v[32:47]
    v_mul_f32 v130, v130, v138
    v_fma_f32 v132, -v152, v52, v20
    ds_read_b128 v[88:91], v7 offset:41984
    s_waitcnt lgkmcnt(4)
    v_mfma_f32_32x32x16_bf16 v[32:47], v[176:179], v[68:71], v[32:47]
    v_exp_f32 v146, v146
    v_fma_f32 v140, -v152, v60, v28
    v_mul_f32 v147, v131, v153
    s_waitcnt vmcnt(0)
    v_cmp_ne_u64 vcc, s[100:101], v[168:169]
    s_cbranch_vccz FSD_1_40
    s_mov_b32 s80, 0
FS_1_39:
    buffer_load_dwordx2 v[168:169], v3, s[8:11], 0 offen sc1
    s_waitcnt vmcnt(0)
    v_cmp_ne_u64 vcc, s[100:101], v[168:169]
    s_cbranch_vccz FSD_1_40
    s_add_u32 s80, s80, 1
    s_cmp_lt_u32 s80, 20000
    s_cbranch_scc0 FSD_1_40_to
    s_sleep 1
    s_branch FS_1_39
FSD_1_40_to:
    s_or_b32 s39, s39, 8
FSD_1_40:
    ds_read_b128 v[64:67], v7 offset:43008
    v_mfma_f32_32x32x16_bf16 v[32:47], v[180:183], v[72:75], v[32:47]
    v_mul_f32 v131, v131, v139
    v_add_f32 v144, 1.0, v144
    v_fma_f32 v133, -v152, v53, v21
    s_lshl_b32 s80, s67, 9
    s_add_u32 s80, s80, 8
    v_add_u32 v6, s80, v5
    s_lshl_b32 s80, s36, 11
    s_add_u32 s80, s80, 118784
    v_add_u32 v12, s80, v1
    s_lshl_b32 s80, s36, 13
    s_add_u32 s80, s80, 118784
    v_add_u32 v13, s80, v1
    s_add_u32 s83, s94, 0
    buffer_load_dwordx4 v[92:95], v1, s[8:11], s83 offen offset:0 sc1
    ds_read_b128 v[68:71], v7 offset:44032
    s_waitcnt lgkmcnt(4)
    v_mfma_f32_32x32x16_bf16 v[32:47], v[184:187], v[76:79], v[32:47]
    v_exp_f32 v147, v147
    v_fma_f32 v141, -v152, v61, v29
    v_mul_f32 v148, v132, v153
    ds_read_b128 v[72:75], v7 offset:45056
    v_mfma_f32_32x32x16_bf16 v[32:47], v[188:191], v[80:83], v[32:47]
    v_rcp_f32 v144, v144
    v_mul_f32 v132, v132, v140
    s_add_u32 s83, s94, 0
    buffer_load_dwordx4 v[96:99], v1, s[8:11], s83 offen offset:1024 sc1
    ds_read_b128 v[76:79], v7 offset:46080
    s_waitcnt lgkmcnt(4)
    v_mfma_f32_32x32x16_bf16 v[32:47], v[192:195], v[84:87], v[32:47]
    v_add_f32 v145, 1.0, v145
    v_fma_f32 v134, -v152, v54, v22
    v_exp_f32 v148, v148
    ds_read_b128 v[80:83], v7 offset:47104
    v_mfma_f32_32x32x16_bf16 v[32:47], v[196:199], v[88:91], v[32:47]
    v_fma_f32 v142, -v152, v62, v30
    v_mul_f32 v149, v133, v153
    ds_read_b128 v[84:87], v7 offset:48128
    s_waitcnt lgkmcnt(4)
    v_mfma_f32_32x32x16_bf16 v[32:47], v[200:203], v[64:67], v[32:47]
    v_rcp_f32 v145, v145
    v_mul_f32 v133, v133, v141
    v_add_f32 v146, 1.0, v146
    s_add_u32 s83, s94, 0
    buffer_load_dwordx4 v[100:103], v1, s[8:11], s83 offen offset:2048 sc1
    ds_read_b128 v[88:91], v7 offset:49152
    v_mfma_f32_32x32x16_bf16 v[32:47], v[204:207], v[68:71], v[32:47]
    v_fma_f32 v135, -v152, v55, v23
    v_exp_f32 v149, v149
    ds_read_b128 v[64:67], v7 offset:50176
    s_waitcnt lgkmcnt(4)
    v_mfma_f32_32x32x16_bf16 v[32:47], v[208:211], v[72:75], v[32:47]
    v_fma_f32 v143, -v152, v63, v31
    v_mul_f32 v150, v134, v153
    v_rcp_f32 v146, v146
    s_add_u32 s83, s94, 0
    buffer_load_dwordx4 v[104:107], v1, s[8:11], s83 offen offset:3072 sc1
    ds_read_b128 v[68:71], v7 offset:51200
    v_mfma_f32_32x32x16_bf16 v[32:47], v[212:215], v[76:79], v[32:47]
    v_mul_f32 v134, v134, v142
    v_add_f32 v147, 1.0, v147
    v_mul_f32 v136, v128, v144
    ds_read_b128 v[72:75], v7 offset:52224
    s_waitcnt lgkmcnt(4)
    v_mfma_f32_32x32x16_bf16 v[32:47], v[216:219], v[80:83], v[32:47]
    v_exp_f32 v150, v150
    v_mul_f32 v151, v135, v153
    s_add_u32 s83, s94, 4096
    buffer_load_dwordx4 v[108:111], v1, s[8:11], s83 offen offset:0 sc1
    ds_read_b128 v[76:79], v7 offset:53248
    v_mfma_f32_32x32x16_bf16 v[32:47], v[220:223], v[84:87], v[32:47]
    v_rcp_f32 v147, v147
    v_mul_f32 v135, v135, v143
    ds_read_b128 v[80:83], v7 offset:54272
    s_waitcnt lgkmcnt(4)
    v_mfma_f32_32x32x16_bf16 v[32:47], v[224:227], v[88:91], v[32:47]
    buffer_store_dwordx2 v[10:11], v9, s[8:11], 0 offen offset:896
    v_add_f32 v148, 1.0, v148
    ds_read_b128 v[84:87], v7 offset:55296
    v_mfma_f32_32x32x16_bf16 v[32:47], v[228:231], v[64:67], v[32:47]
    s_barrier
    v_mul_f32 v137, v129, v145
    s_add_u32 s83, s94, 4096
    buffer_load_dwordx4 v[64:67], v1, s[8:11], s83 offen offset:1024 sc1
    ds_read_b128 v[88:91], v7 offset:56320
    s_waitcnt lgkmcnt(4)
    v_mfma_f32_32x32x16_bf16 v[32:47], v[232:235], v[68:71], v[32:47]
    v_exp_f32 v151, v151
    v_rcp_f32 v148, v148
    v_add_f32 v149, 1.0, v149
    v_mfma_f32_32x32x16_bf16 v[32:47], v[236:239], v[72:75], v[32:47]
    v_mul_f32 v138, v130, v146
    v_cvt_pk_bf16_f32 v156, v136, v137
    v_rcp_f32 v149, v149
    s_add_u32 s83, s94, 4096
    buffer_load_dwordx4 v[68:71], v1, s[8:11], s83 offen offset:2048 sc1
    s_waitcnt lgkmcnt(2)
    v_mfma_f32_32x32x16_bf16 v[32:47], v[240:243], v[76:79], v[32:47]
    v_add_f32 v150, 1.0, v150
    v_mul_f32 v139, v131, v147
    v_rcp_f32 v150, v150
    v_add_f32 v151, 1.0, v151
    v_mfma_f32_32x32x16_bf16 v[32:47], v[244:247], v[80:83], v[32:47]
    v_mul_f32 v140, v132, v148
    v_cvt_pk_bf16_f32 v157, v138, v139
    v_rcp_f32 v151, v151
    s_add_u32 s83, s94, 4096
    buffer_load_dwordx4 v[72:75], v1, s[8:11], s83 offen offset:3072 sc1
    s_waitcnt lgkmcnt(0)
    v_mfma_f32_32x32x16_bf16 v[32:47], v[248:251], v[84:87], v[32:47]
    v_mul_f32 v141, v133, v149
    v_mul_f32 v142, v134, v150
    v_cvt_pk_bf16_f32 v158, v140, v141
    v_mul_f32 v143, v135, v151
    v_cvt_pk_bf16_f32 v159, v142, v143
    v_mfma_f32_32x32x16_bf16 v[32:47], v[252:255], v[88:91], v[32:47]
    s_add_u32 s82, s79, 688128
    buffer_store_dwordx4 v[156:159], v1, s[8:11], s82 offen
    s_add_u32 s83, s94, 8192
    buffer_load_dwordx4 v[76:79], v1, s[8:11], s83 offen offset:0 sc1
    s_waitcnt vmcnt(10)
    v_mfma_f32_32x32x16_bf16 v[16:31], a[0:3], v[92:95], 0
    ds_read_b64 v[152:153], v5 offset:3584
    s_waitcnt lgkmcnt(0)
    s_nop 3
    v_fma_f32 v128, -v152, v48, v32
    v_fma_f32 v136, -v152, v56, v40
    v_fma_f32 v129, -v152, v49, v33
    v_fma_f32 v137, -v152, v57, v41
    v_mfma_f32_32x32x16_bf16 v[160:175], a[4:7], v[92:95], 0
    s_add_u32 s83, s94, 8192
    buffer_load_dwordx4 v[80:83], v1, s[8:11], s83 offen offset:1024 sc1
    s_add_u32 s83, s94, 8192
    buffer_load_dwordx4 v[84:87], v1, s[8:11], s83 offen offset:2048 sc1
    s_add_u32 s83, s94, 12288
    buffer_load_dwordx4 v[92:95], v1, s[8:11], s83 offen offset:0 sc1
    s_waitcnt vmcnt(12)
    v_mfma_f32_32x32x16_bf16 v[16:31], a[8:11], v[96:99], v[16:31]
    v_mul_f32 v144, v128, v153
    v_mul_f32 v128, v128, v136
    v_fma_f32 v130, -v152, v50, v34
    v_exp_f32 v144, v144
    v_fma_f32 v138, -v152, v58, v42
    v_mfma_f32_32x32x16_bf16 v[160:175], a[12:15], v[96:99], v[160:175]
    s_add_u32 s83, s94, 8192
    buffer_load_dwordx4 v[88:91], v1, s[8:11], s83 offen offset:3072 sc1
    s_add_u32 s83, s94, 12288
    buffer_load_dwordx4 v[96:99], v1, s[8:11], s83 offen offset:1024 sc1
    s_waitcnt vmcnt(13)
    v_mfma_f32_32x32x16_bf16 v[16:31], a[16:19], v[100:103], v[16:31]
    v_mul_f32 v145, v129, v153
    v_mul_f32 v129, v129, v137
    v_fma_f32 v131, -v152, v51, v35
    v_exp_f32 v145, v145
    v_fma_f32 v139, -v152, v59, v43
    v_mfma_f32_32x32x16_bf16 v[160:175], a[20:23], v[100:103], v[160:175]
    s_add_u32 s83, s94, 12288
    buffer_load_dwordx4 v[100:103], v1, s[8:11], s83 offen offset:2048 sc1
    v_mul_f32 v146, v130, v153
    v_mul_f32 v130, v130, v138
    s_waitcnt vmcnt(13)
    v_mfma_f32_32x32x16_bf16 v[16:31], a[24:27], v[104:107], v[16:31]
    v_fma_f32 v132, -v152, v52, v36
    v_exp_f32 v146, v146
    v_fma_f32 v140, -v152, v60, v44
    v_mul_f32 v147, v131, v153
    v_mul_f32 v131, v131, v139
    v_mfma_f32_32x32x16_bf16 v[160:175], a[28:31], v[104:107], v[160:175]
    s_add_u32 s83, s94, 12288
    buffer_load_dwordx4 v[104:107], v1, s[8:11], s83 offen offset:3072 sc1
    v_add_f32 v144, 1.0, v144
    v_fma_f32 v133, -v152, v53, v37
    s_waitcnt vmcnt(13)
    v_mfma_f32_32x32x16_bf16 v[16:31], a[32:35], v[108:111], v[16:31]
    v_exp_f32 v147, v147
    v_fma_f32 v141, -v152, v61, v45
    v_mul_f32 v148, v132, v153
    v_rcp_f32 v144, v144
    v_mfma_f32_32x32x16_bf16 v[160:175], a[36:39], v[108:111], v[160:175]
    s_add_u32 s83, s94, 16384
    buffer_load_dwordx4 v[108:111], v1, s[8:11], s83 offen offset:0 sc1
    v_mul_f32 v132, v132, v140
    v_add_f32 v145, 1.0, v145
    s_waitcnt vmcnt(12)
    v_mfma_f32_32x32x16_bf16 v[16:31], a[40:43], v[64:67], v[16:31]
    v_fma_f32 v134, -v152, v54, v38
    v_exp_f32 v148, v148
    v_fma_f32 v142, -v152, v62, v46
    v_mul_f32 v149, v133, v153
    v_mfma_f32_32x32x16_bf16 v[160:175], a[44:47], v[64:67], v[160:175]
    s_add_u32 s83, s94, 16384
    buffer_load_dwordx4 v[64:67], v1, s[8:11], s83 offen offset:1024 sc1
    v_rcp_f32 v145, v145
    s_waitcnt vmcnt(12)
    v_mfma_f32_32x32x16_bf16 v[16:31], a[48:51], v[68:71], v[16:31]
    s_waitcnt vmcnt(10)
    buffer_store_dwordx2 v[10:11], v9, s[8:11], 0 offen offset:1792
    v_mul_f32 v133, v133, v141
    v_add_f32 v146, 1.0, v146
    v_fma_f32 v135, -v152, v55, v39
    v_mfma_f32_32x32x16_bf16 v[160:175], a[52:55], v[68:71], v[160:175]
    s_add_u32 s83, s94, 16384
    buffer_load_dwordx4 v[68:71], v1, s[8:11], s83 offen offset:2048 sc1
    v_exp_f32 v149, v149
    v_mfma_f32_32x32x16_bf16 v[16:31], a[56:59], v[72:75], v[16:31]
    v_fma_f32 v143, -v152, v63, v47
    v_mul_f32 v150, v134, v153
    v_rcp_f32 v146, v146
    v_mul_f32 v134, v134, v142
    v_add_f32 v147, 1.0, v147
    v_mfma_f32_32x32x16_bf16 v[160:175], a[60:63], v[72:75], v[160:175]
    s_add_u32 s83, s94, 16384
    buffer_load_dwordx4 v[72:75], v1, s[8:11], s83 offen offset:3072 sc1
    v_mul_f32 v136, v128, v144
    s_waitcnt vmcnt(12)
    v_mfma_f32_32x32x16_bf16 v[16:31], a[64:67], v[76:79], v[16:31]
    v_exp_f32 v150, v150
    v_mul_f32 v151, v135, v153
    v_rcp_f32 v147, v147
    v_mul_f32 v135, v135, v143
    v_mfma_f32_32x32x16_bf16 v[160:175], a[68:71], v[76:79], v[160:175]
    s_add_u32 s83, s94, 20480
    buffer_load_dwordx4 v[76:79], v1, s[8:11], s83 offen offset:0 sc1
    v_add_f32 v148, 1.0, v148
    v_mul_f32 v137, v129, v145
    s_waitcnt vmcnt(12)
    v_mfma_f32_32x32x16_bf16 v[16:31], a[72:75], v[80:83], v[16:31]
    v_exp_f32 v151, v151
    v_rcp_f32 v148, v148
    v_add_f32 v149, 1.0, v149
    v_mul_f32 v138, v130, v146
    buffer_load_dwordx2 v[154:155], v4, s[8:11], 0 offen sc1
    v_mfma_f32_32x32x16_bf16 v[160:175], a[76:79], v[80:83], v[160:175]
    s_add_u32 s83, s94, 20480
    buffer_load_dwordx4 v[80:83], v1, s[8:11], s83 offen offset:1024 sc1
    v_cvt_pk_bf16_f32 v156, v136, v137
    s_waitcnt vmcnt(13)
    v_mfma_f32_32x32x16_bf16 v[16:31], a[80:83], v[84:87], v[16:31]
    v_rcp_f32 v149, v149
    v_add_f32 v150, 1.0, v150
    v_mul_f32 v139, v131, v147
    v_rcp_f32 v150, v150
    v_mfma_f32_32x32x16_bf16 v[160:175], a[84:87], v[84:87], v[160:175]
    s_add_u32 s83, s94, 20480
    buffer_load_dwordx4 v[84:87], v1, s[8:11], s83 offen offset:2048 sc1
    v_add_f32 v151, 1.0, v151
    v_mul_f32 v140, v132, v148
    s_waitcnt vmcnt(12)
    v_mfma_f32_32x32x16_bf16 v[16:31], a[88:91], v[88:91], v[16:31]
    v_cvt_pk_bf16_f32 v157, v138, v139
    v_rcp_f32 v151, v151
    v_mul_f32 v141, v133, v149
    v_mul_f32 v142, v134, v150
    v_cvt_pk_bf16_f32 v158, v140, v141
    v_mfma_f32_32x32x16_bf16 v[160:175], a[92:95], v[88:91], v[160:175]
    s_add_u32 s83, s94, 20480
    buffer_load_dwordx4 v[88:91], v1, s[8:11], s83 offen offset:3072 sc1
    v_mul_f32 v143, v135, v151
    v_cvt_pk_bf16_f32 v159, v142, v143
    v_mfma_f32_32x32x16_bf16 v[16:31], a[96:99], v[92:95], v[16:31]
    s_add_u32 s82, s79, 802816
    buffer_store_dwordx4 v[156:159], v1, s[8:11], s82 offen
    v_mfma_f32_32x32x16_bf16 v[160:175], a[100:103], v[92:95], v[160:175]
    s_add_u32 s83, s94, 24576
    buffer_load_dwordx4 v[92:95], v1, s[8:11], s83 offen offset:0 sc1
    s_waitcnt vmcnt(14)
    v_mfma_f32_32x32x16_bf16 v[16:31], a[104:107], v[96:99], v[16:31]
    v_mfma_f32_32x32x16_bf16 v[160:175], a[108:111], v[96:99], v[160:175]
    s_add_u32 s83, s94, 24576
    buffer_load_dwordx4 v[96:99], v1, s[8:11], s83 offen offset:1024 sc1
    s_waitcnt vmcnt(14)
    v_mfma_f32_32x32x16_bf16 v[16:31], a[112:115], v[100:103], v[16:31]
    v_mfma_f32_32x32x16_bf16 v[160:175], a[116:119], v[100:103], v[160:175]
    s_add_u32 s83, s94, 24576
    buffer_load_dwordx4 v[100:103], v1, s[8:11], s83 offen offset:2048 sc1
    s_waitcnt vmcnt(14)
    v_mfma_f32_32x32x16_bf16 v[16:31], a[120:123], v[104:107], v[16:31]
    v_mfma_f32_32x32x16_bf16 v[160:175], a[124:127], v[104:107], v[160:175]
    s_add_u32 s83, s94, 24576
    buffer_load_dwordx4 v[104:107], v1, s[8:11], s83 offen offset:3072 sc1
    s_waitcnt vmcnt(14)
    v_mfma_f32_32x32x16_bf16 v[16:31], a[128:131], v[108:111], v[16:31]
    s_waitcnt vmcnt(4)
    buffer_store_dwordx2 v[10:11], v9, s[8:11], 0 offen offset:2688
    v_mfma_f32_32x32x16_bf16 v[160:175], a[132:135], v[108:111], v[160:175]
    v_mfma_f32_32x32x16_bf16 v[16:31], a[136:139], v[64:67], v[16:31]
    v_mfma_f32_32x32x16_bf16 v[160:175], a[140:143], v[64:67], v[160:175]
    v_cmp_ne_u64 vcc, s[100:101], v[154:155]
    s_cbranch_vccz FSD_1_42
    s_mov_b32 s80, 0
FS_1_41:
    buffer_load_dwordx2 v[154:155], v4, s[8:11], 0 offen sc1
    s_waitcnt vmcnt(0)
    v_cmp_ne_u64 vcc, s[100:101], v[154:155]
    s_cbranch_vccz FSD_1_42
    s_add_u32 s80, s80, 1
    s_cmp_lt_u32 s80, 20000
    s_cbranch_scc0 FSD_1_42_to
    s_sleep 1
    s_branch FS_1_41
FSD_1_42_to:
    s_or_b32 s39, s39, 128
FSD_1_42:
    v_mfma_f32_32x32x16_bf16 v[16:31], a[144:147], v[68:71], v[16:31]
    v_mfma_f32_32x32x16_bf16 v[160:175], a[148:151], v[68:71], v[160:175]
    s_add_u32 s83, s95, 0
    buffer_load_dwordx4 v[108:111], v1, s[8:11], s83 offen offset:0 sc1
    s_add_u32 s83, s95, 0
    buffer_load_dwordx4 v[64:67], v1, s[8:11], s83 offen offset:1024 sc1
    v_mfma_f32_32x32x16_bf16 v[16:31], a[152:155], v[72:75], v[16:31]
    v_mfma_f32_32x32x16_bf16 v[160:175], a[156:159], v[72:75], v[160:175]
    s_add_u32 s83, s95, 0
    buffer_load_dwordx4 v[68:71], v1, s[8:11], s83 offen offset:2048 sc1
    s_add_u32 s83, s95, 0
    buffer_load_dwordx4 v[72:75], v1, s[8:11], s83 offen offset:3072 sc1
    v_mfma_f32_32x32x16_bf16 v[16:31], a[160:163], v[76:79], v[16:31]
    v_mfma_f32_32x32x16_bf16 v[160:175], a[164:167], v[76:79], v[160:175]
    s_add_u32 s83, s95, 4096
    buffer_load_dwordx4 v[76:79], v1, s[8:11], s83 offen offset:0 sc1
    v_mfma_f32_32x32x16_bf16 v[16:31], a[168:171], v[80:83], v[16:31]
    v_mfma_f32_32x32x16_bf16 v[160:175], a[172:175], v[80:83], v[160:175]
    s_add_u32 s83, s95, 4096
    buffer_load_dwordx4 v[80:83], v1, s[8:11], s83 offen offset:1024 sc1
    v_mfma_f32_32x32x16_bf16 v[16:31], a[176:179], v[84:87], v[16:31]
    v_mfma_f32_32x32x16_bf16 v[160:175], a[180:183], v[84:87], v[160:175]
    s_add_u32 s83, s95, 4096
    buffer_load_dwordx4 v[84:87], v1, s[8:11], s83 offen offset:2048 sc1
    v_mfma_f32_32x32x16_bf16 v[16:31], a[184:187], v[88:91], v[16:31]
    v_mfma_f32_32x32x16_bf16 v[160:175], a[188:191], v[88:91], v[160:175]
    s_add_u32 s83, s95, 4096
    buffer_load_dwordx4 v[88:91], v1, s[8:11], s83 offen offset:3072 sc1
    s_waitcnt vmcnt(12)
    v_mfma_f32_32x32x16_bf16 v[16:31], a[192:195], v[92:95], v[16:31]
    v_mfma_f32_32x32x16_bf16 v[160:175], a[196:199], v[92:95], v[160:175]
    s_add_u32 s83, s95, 8192
    buffer_load_dwordx4 v[92:95], v1, s[8:11], s83 offen offset:0 sc1
    s_waitcnt vmcnt(12)
    v_mfma_f32_32x32x16_bf16 v[16:31], a[200:203], v[96:99], v[16:31]
    v_mfma_f32_32x32x16_bf16 v[160:175], a[204:207], v[96:99], v[160:175]
    s_add_u32 s83, s95, 8192
    buffer_load_dwordx4 v[96:99], v1, s[8:11], s83 offen offset:1024 sc1
    s_waitcnt vmcnt(12)
    v_mfma_f32_32x32x16_bf16 v[16:31], a[208:211], v[100:103], v[16:31]
    v_mfma_f32_32x32x16_bf16 v[160:175], a[212:215], v[100:103], v[160:175]
    s_add_u32 s83, s95, 8192
    buffer_load_dwordx4 v[100:103], v1, s[8:11], s83 offen offset:2048 sc1
    s_waitcnt vmcnt(12)
    v_mfma_f32_32x32x16_bf16 v[16:31], a[216:219], v[104:107], v[16:31]
    v_mfma_f32_32x32x16_bf16 v[160:175], a[220:223], v[104:107], v[160:175]
    s_add_u32 s83, s95, 8192
    buffer_load_dwordx4 v[104:107], v1, s[8:11], s83 offen offset:3072 sc1
    s_waitcnt vmcnt(11)
    v_mfma_f32_32x32x16_bf16 v[32:47], a[0:3], v[108:111], 0
    v_mfma_f32_32x32x16_bf16 v[128:143], a[4:7], v[108:111], 0
    s_add_u32 s83, s95, 12288
    buffer_load_dwordx4 v[108:111], v1, s[8:11], s83 offen offset:0 sc1
    s_waitcnt vmcnt(11)
    v_mfma_f32_32x32x16_bf16 v[32:47], a[8:11], v[64:67], v[32:47]
    s_nop 1
    ds_write_b128 v12, v[16:19] offset:0
    ds_write_b128 v12, v[20:23] offset:1024
    ds_write_b128 v12, v[24:27] offset:16384
    v_mfma_f32_32x32x16_bf16 v[128:143], a[12:15], v[64:67], v[128:143]
    s_add_u32 s83, s95, 12288
    buffer_load_dwordx4 v[64:67], v1, s[8:11], s83 offen offset:1024 sc1
    ds_write_b128 v12, v[28:31] offset:17408
    s_waitcnt vmcnt(11)
    v_mfma_f32_32x32x16_bf16 v[32:47], a[16:19], v[68:71], v[32:47]
    ds_write_b128 v12, v[160:163] offset:8192
    ds_write_b128 v12, v[164:167] offset:9216
    ds_write_b128 v12, v[168:171] offset:24576
    v_mfma_f32_32x32x16_bf16 v[128:143], a[20:23], v[68:71], v[128:143]
    s_add_u32 s83, s95, 12288
    buffer_load_dwordx4 v[68:71], v1, s[8:11], s83 offen offset:2048 sc1
    ds_write_b128 v12, v[172:175] offset:25600
    s_waitcnt vmcnt(11)
    v_mfma_f32_32x32x16_bf16 v[32:47], a[24:27], v[72:75], v[32:47]
    v_mfma_f32_32x32x16_bf16 v[128:143], a[28:31], v[72:75], v[128:143]
    s_add_u32 s83, s95, 12288
    buffer_load_dwordx4 v[72:75], v1, s[8:11], s83 offen offset:3072 sc1
    s_waitcnt vmcnt(11)
    v_mfma_f32_32x32x16_bf16 v[32:47], a[32:35], v[76:79], v[32:47]
    v_mfma_f32_32x32x16_bf16 v[128:143], a[36:39], v[76:79], v[128:143]
    s_add_u32 s83, s95, 16384
    buffer_load_dwordx4 v[76:79], v1, s[8:11], s83 offen offset:0 sc1
    s_waitcnt lgkmcnt(0)
    s_barrier
    s_waitcnt vmcnt(11)
    v_mfma_f32_32x32x16_bf16 v[32:47], a[40:43], v[80:83], v[32:47]
    ds_read_b128 v[16:19], v13 offset:0
    ds_read_b128 v[20:23], v13 offset:1024
    ds_read_b128 v[24:27], v13 offset:2048
    ds_read_b128 v[28:31], v13 offset:3072
    ds_read_b128 v[160:163], v13 offset:4096
    ds_read_b128 v[164:167], v13 offset:5120
    v_mfma_f32_32x32x16_bf16 v[128:143], a[44:47], v[80:83], v[128:143]
    s_add_u32 s83, s95, 16384
    buffer_load_dwordx4 v[80:83], v1, s[8:11], s83 offen offset:1024 sc1
    ds_read_b128 v[168:171], v13 offset:6144
    ds_read_b128 v[172:175], v13 offset:7168
    s_waitcnt vmcnt(11)
    v_mfma_f32_32x32x16_bf16 v[32:47], a[48:51], v[84:87], v[32:47]
    ds_read_b32 v152, v6 offset:0
    v_mfma_f32_32x32x16_bf16 v[128:143], a[52:55], v[84:87], v[128:143]
    s_add_u32 s83, s95, 16384
    buffer_load_dwordx4 v[84:87], v1, s[8:11], s83 offen offset:2048 sc1
    s_waitcnt vmcnt(11)
    v_mfma_f32_32x32x16_bf16 v[32:47], a[56:59], v[88:91], v[32:47]
    v_mfma_f32_32x32x16_bf16 v[128:143], a[60:63], v[88:91], v[128:143]
    s_add_u32 s83, s95, 16384
    buffer_load_dwordx4 v[88:91], v1, s[8:11], s83 offen offset:3072 sc1
    s_waitcnt vmcnt(11)
    v_mfma_f32_32x32x16_bf16 v[32:47], a[64:67], v[92:95], v[32:47]
    s_waitcnt lgkmcnt(0)
    v_add_f32 v144, v16, v24
    v_add_f32 v145, v17, v25
    v_add_f32 v146, v18, v26
    v_add_f32 v147, v19, v27
    v_add_f32 v148, v20, v28
    v_mfma_f32_32x32x16_bf16 v[128:143], a[68:71], v[92:95], v[128:143]
    s_add_u32 s83, s95, 20480
    buffer_load_dwordx4 v[92:95], v1, s[8:11], s83 offen offset:0 sc1
    v_add_f32 v149, v21, v29
    v_add_f32 v150, v22, v30
    s_waitcnt vmcnt(11)
    v_mfma_f32_32x32x16_bf16 v[32:47], a[72:75], v[96:99], v[32:47]
    v_add_f32 v151, v23, v31
    v_add_f32 v160, v160, v168
    v_add_f32 v161, v161, v169
    v_add_f32 v162, v162, v170
    v_add_f32 v163, v163, v171
    v_add_f32 v164, v164, v172
    v_mfma_f32_32x32x16_bf16 v[128:143], a[76:79], v[96:99], v[128:143]
    s_add_u32 s83, s95, 20480
    buffer_load_dwordx4 v[96:99], v1, s[8:11], s83 offen offset:1024 sc1
    v_add_f32 v165, v165, v173
    v_add_f32 v166, v166, v174
    s_waitcnt vmcnt(11)
    v_mfma_f32_32x32x16_bf16 v[32:47], a[80:83], v[100:103], v[32:47]
    v_add_f32 v167, v167, v175
    v_add_f32 v144, v144, v160
    v_add_f32 v145, v145, v161
    v_add_f32 v146, v146, v162
    v_add_f32 v147, v147, v163
    v_add_f32 v148, v148, v164
    v_mfma_f32_32x32x16_bf16 v[128:143], a[84:87], v[100:103], v[128:143]
    s_add_u32 s83, s95, 20480
    buffer_load_dwordx4 v[100:103], v1, s[8:11], s83 offen offset:2048 sc1
    v_add_f32 v149, v149, v165
    v_add_f32 v150, v150, v166
    s_waitcnt vmcnt(11)
    v_mfma_f32_32x32x16_bf16 v[32:47], a[88:91], v[104:107], v[32:47]
    v_add_f32 v151, v151, v167
    v_lshlrev_b32 v153, 16, v112
    v_and_b32 v154, s77, v112
    v_fma_f32 v144, v144, v152, v153
    v_fma_f32 v145, v145, v152, v154
    v_lshlrev_b32 v153, 16, v113
    v_mfma_f32_32x32x16_bf16 v[128:143], a[92:95], v[104:107], v[128:143]
    s_add_u32 s83, s95, 20480
    buffer_load_dwordx4 v[104:107], v1, s[8:11], s83 offen offset:3072 sc1
    v_and_b32 v154, s77, v113
    v_fma_f32 v146, v146, v152, v153
    s_waitcnt vmcnt(11)
    v_mfma_f32_32x32x16_bf16 v[32:47], a[96:99], v[108:111], v[32:47]
    v_fma_f32 v147, v147, v152, v154
    v_lshlrev_b32 v153, 16, v114
    v_and_b32 v154, s77, v114
    v_fma_f32 v148, v148, v152, v153
    v_fma_f32 v149, v149, v152, v154
    v_lshlrev_b32 v153, 16, v115
    v_mfma_f32_32x32x16_bf16 v[128:143], a[100:103], v[108:111], v[128:143]
    s_add_u32 s83, s95, 24576
    buffer_load_dwordx4 v[108:111], v1, s[8:11], s83 offen offset:0 sc1
    v_and_b32 v154, s77, v115
    v_fma_f32 v150, v150, v152, v153
    s_waitcnt vmcnt(11)
    v_mfma_f32_32x32x16_bf16 v[32:47], a[104:107], v[64:67], v[32:47]
    v_fma_f32 v151, v151, v152, v154
    v_mfma_f32_32x32x16_bf16 v[128:143], a[108:111], v[64:67], v[128:143]
    s_add_u32 s83, s95, 24576
    buffer_load_dwordx4 v[64:67], v1, s[8:11], s83 offen offset:1024 sc1
    s_waitcnt vmcnt(11)
    v_mfma_f32_32x32x16_bf16 v[32:47], a[112:115], v[68:71], v[32:47]
    v_mfma_f32_32x32x16_bf16 v[128:143], a[116:119], v[68:71], v[128:143]
    s_add_u32 s83, s95, 24576
    buffer_load_dwordx4 v[68:71], v1, s[8:11], s83 offen offset:2048 sc1
    s_waitcnt vmcnt(11)
    v_mfma_f32_32x32x16_bf16 v[32:47], a[120:123], v[72:75], v[32:47]
    v_mfma_f32_32x32x16_bf16 v[128:143], a[124:127], v[72:75], v[128:143]
    s_add_u32 s83, s95, 24576
    buffer_load_dwordx4 v[72:75], v1, s[8:11], s83 offen offset:3072 sc1
    s_waitcnt vmcnt(11)
    v_mfma_f32_32x32x16_bf16 v[32:47], a[128:131], v[76:79], v[32:47]
    v_mfma_f32_32x32x16_bf16 v[128:143], a[132:135], v[76:79], v[128:143]
    s_waitcnt vmcnt(10)
    v_mfma_f32_32x32x16_bf16 v[32:47], a[136:139], v[80:83], v[32:47]
    v_mfma_f32_32x32x16_bf16 v[128:143], a[140:143], v[80:83], v[128:143]
    s_waitcnt vmcnt(9)
    v_mfma_f32_32x32x16_bf16 v[32:47], a[144:147], v[84:87], v[32:47]
    v_mfma_f32_32x32x16_bf16 v[128:143], a[148:151], v[84:87], v[128:143]
    s_waitcnt vmcnt(8)
    v_mfma_f32_32x32x16_bf16 v[32:47], a[152:155], v[88:91], v[32:47]
    v_mfma_f32_32x32x16_bf16 v[128:143], a[156:159], v[88:91], v[128:143]
    s_waitcnt vmcnt(7)
    v_mfma_f32_32x32x16_bf16 v[32:47], a[160:163], v[92:95], v[32:47]
    v_mfma_f32_32x32x16_bf16 v[128:143], a[164:167], v[92:95], v[128:143]
    s_waitcnt vmcnt(6)
    v_mfma_f32_32x32x16_bf16 v[32:47], a[168:171], v[96:99], v[32:47]
    v_mfma_f32_32x32x16_bf16 v[128:143], a[172:175], v[96:99], v[128:143]
    s_waitcnt vmcnt(5)
    v_mfma_f32_32x32x16_bf16 v[32:47], a[176:179], v[100:103], v[32:47]
    v_mfma_f32_32x32x16_bf16 v[128:143], a[180:183], v[100:103], v[128:143]
    s_waitcnt vmcnt(4)
    v_mfma_f32_32x32x16_bf16 v[32:47], a[184:187], v[104:107], v[32:47]
    v_mfma_f32_32x32x16_bf16 v[128:143], a[188:191], v[104:107], v[128:143]
    s_waitcnt vmcnt(3)
    v_mfma_f32_32x32x16_bf16 v[32:47], a[192:195], v[108:111], v[32:47]
    v_mfma_f32_32x32x16_bf16 v[128:143], a[196:199], v[108:111], v[128:143]
    s_waitcnt vmcnt(2)
    v_mfma_f32_32x32x16_bf16 v[32:47], a[200:203], v[64:67], v[32:47]
    v_mfma_f32_32x32x16_bf16 v[128:143], a[204:207], v[64:67], v[128:143]
    s_waitcnt vmcnt(1)
    v_mfma_f32_32x32x16_bf16 v[32:47], a[208:211], v[68:71], v[32:47]
    v_mfma_f32_32x32x16_bf16 v[128:143], a[212:215], v[68:71], v[128:143]
    s_waitcnt vmcnt(0)
    v_mfma_f32_32x32x16_bf16 v[32:47], a[216:219], v[72:75], v[32:47]
    v_mfma_f32_32x32x16_bf16 v[128:143], a[220:223], v[72:75], v[128:143]
    v_and_b32 v4, 31, v0
    s_lshl_b32 s80, s68, 5
    v_add_u32 v4, s80, v4
    v_mul_u32_u24 v4, 896, v4
    v_lshrrev_b32 v158, 5, v0
    v_lshl_add_u32 v4, v158, 3, v4
    v_cvt_pk_bf16_f32 v154, v144, v145
    v_cvt_pk_bf16_f32 v155, v146, v147
    v_cvt_pk_bf16_f32 v156, v148, v149
    v_cvt_pk_bf16_f32 v157, v150, v151
    s_lshl_b32 s80, s69, 6
    s_lshl_b32 s81, s5, 5
    s_add_u32 s80, s80, s81
    buffer_store_dwordx2 v[154:155], v4, s[32:35], s80 offen offset:0
    buffer_store_dwordx2 v[156:157], v4, s[32:35], s80 offen offset:16
    s_barrier
    ds_write_b128 v12, v[32:35] offset:0
    ds_write_b128 v12, v[36:39] offset:1024
    ds_write_b128 v12, v[40:43] offset:16384
    ds_write_b128 v12, v[44:47] offset:17408
    ds_write_b128 v12, v[128:131] offset:8192
    ds_write_b128 v12, v[132:135] offset:9216
    ds_write_b128 v12, v[136:139] offset:24576
    ds_write_b128 v12, v[140:143] offset:25600
    s_waitcnt lgkmcnt(0)
    s_barrier
    ds_read_b128 v[128:131], v13 offset:0
    ds_read_b128 v[132:135], v13 offset:1024
    ds_read_b128 v[136:139], v13 offset:2048
    ds_read_b128 v[140:143], v13 offset:3072
    ds_read_b128 v[144:147], v13 offset:4096
    ds_read_b128 v[148:151], v13 offset:5120
    ds_read_b128 v[152:155], v13 offset:6144
    ds_read_b128 v[156:159], v13 offset:7168
    ds_read_b32 v168, v6 offset:2048
    s_waitcnt lgkmcnt(0)
    v_add_f32 v160, v128, v136
    v_add_f32 v161, v129, v137
    v_add_f32 v162, v130, v138
    v_add_f32 v163, v131, v139
    v_add_f32 v164, v132, v140
    v_add_f32 v165, v133, v141
    v_add_f32 v166, v134, v142
    v_add_f32 v167, v135, v143
    v_add_f32 v144, v144, v152
    v_add_f32 v145, v145, v153
    v_add_f32 v146, v146, v154
    v_add_f32 v147, v147, v155
    v_add_f32 v148, v148, v156
    v_add_f32 v149, v149, v157
    v_add_f32 v150, v150, v158
    v_add_f32 v151, v151, v159
    v_add_f32 v160, v160, v144
    v_add_f32 v161, v161, v145
    v_add_f32 v162, v162, v146
    v_add_f32 v163, v163, v147
    v_add_f32 v164, v164, v148
    v_add_f32 v165, v165, v149
    v_add_f32 v166, v166, v150
    v_add_f32 v167, v167, v151
    v_lshlrev_b32 v169, 16, v116
    v_and_b32 v170, s77, v116
    v_fma_f32 v160, v160, v168, v169
    v_fma_f32 v161, v161, v168, v170
    v_lshlrev_b32 v169, 16, v117
    v_and_b32 v170, s77, v117
    v_fma_f32 v162, v162, v168, v169
    v_fma_f32 v163, v163, v168, v170
    v_lshlrev_b32 v169, 16, v118
    v_and_b32 v170, s77, v118
    v_fma_f32 v164, v164, v168, v169
    v_fma_f32 v165, v165, v168, v170
    v_lshlrev_b32 v169, 16, v119
    v_and_b32 v170, s77, v119
    v_fma_f32 v166, v166, v168, v169
    v_fma_f32 v167, v167, v168, v170
    v_cvt_pk_bf16_f32 v170, v160, v161
    v_cvt_pk_bf16_f32 v171, v162, v163
    v_cvt_pk_bf16_f32 v172, v164, v165
    v_cvt_pk_bf16_f32 v173, v166, v167
    s_lshl_b32 s80, s69, 6
    s_lshl_b32 s81, s5, 5
    s_add_u32 s80, s80, s81
    s_add_u32 s80, s80, 114688
    buffer_store_dwordx2 v[170:171], v4, s[32:35], s80 offen offset:0
    buffer_store_dwordx2 v[172:173], v4, s[32:35], s80 offen offset:16
    s_branch KB_end
KB_slow:
    v_and_b32 v14, 31, v0
    v_lshlrev_b32 v14, 3, v14
    s_lshl_b32 s80, s36, 8
    s_add_u32 s80, s80, 151552
    v_add_u32 v14, s80, v14
    v_lshlrev_b32 v160, 16, v152
    v_and_b32 v161, s77, v152
    v_lshlrev_b32 v162, 16, v153
    v_and_b32 v163, s77, v153
    v_lshlrev_b32 v164, 16, v154
    v_and_b32 v165, s77, v154
    v_lshlrev_b32 v166, 16, v155
    v_and_b32 v167, s77, v155
    v_mul_f32 v136, v144, v145
    v_lshlrev_b32 v137, 16, v120
    v_and_b32 v138, s77, v120
    v_fma_f32 v139, v160, v145, -v136
    v_fma_f32 v140, v161, v145, -v136
    v_fmac_f32 v160, v137, v139
    v_fmac_f32 v161, v138, v140
    v_lshlrev_b32 v137, 16, v121
    v_and_b32 v138, s77, v121
    v_fma_f32 v139, v162, v145, -v136
    v_fma_f32 v140, v163, v145, -v136
    v_fmac_f32 v162, v137, v139
    v_fmac_f32 v163, v138, v140
    v_lshlrev_b32 v137, 16, v122
    v_and_b32 v138, s77, v122
    v_fma_f32 v139, v164, v145, -v136
    v_fma_f32 v140, v165, v145, -v136
    v_fmac_f32 v164, v137, v139
    v_fmac_f32 v165, v138, v140
    v_lshlrev_b32 v137, 16, v123
    v_and_b32 v138, s77, v123
    v_fma_f32 v139, v166, v145, -v136
    v_fma_f32 v140, v167, v145, -v136
    v_fmac_f32 v166, v137, v139
    v_fmac_f32 v167, v138, v140
    v_cvt_pk_bf16_f32 v112, v160, v161
    v_cvt_pk_bf16_f32 v113, v162, v163
    v_cvt_pk_bf16_f32 v114, v164, v165
    v_cvt_pk_bf16_f32 v115, v166, v167
    s_add_u32 s80, s3, 5505024
    buffer_store_dwordx4 v[112:115], v1, s[8:11], s80 offen sc0 sc1
    v_add_f32 v128, v160, v161
    v_mul_f32 v129, v160, v160
    v_fmac_f32 v129, v161, v161
    v_add_f32 v128, v128, v162
    v_fmac_f32 v129, v162, v162
    v_add_f32 v128, v128, v163
    v_fmac_f32 v129, v163, v163
    v_add_f32 v128, v128, v164
    v_fmac_f32 v129, v164, v164
    v_add_f32 v128, v128, v165
    v_fmac_f32 v129, v165, v165
    v_add_f32 v128, v128, v166
    v_fmac_f32 v129, v166, v166
    v_add_f32 v128, v128, v167
    v_fmac_f32 v129, v167, v167
    v_mov_b32 v130, v128
    v_mov_b32 v131, v129
    s_nop 0
    v_permlane32_swap_b32 v130, v128
    v_permlane32_swap_b32 v131, v129
    v_add_f32 v128, v128, v130
    v_add_f32 v129, v129, v131
    ds_write_b64 v14, v[128:129] offset:2048
    v_lshlrev_b32 v160, 16, v156
    v_and_b32 v161, s77, v156
    v_lshlrev_b32 v162, 16, v157
    v_and_b32 v163, s77, v157
    v_lshlrev_b32 v164, 16, v158
    v_and_b32 v165, s77, v158
    v_lshlrev_b32 v166, 16, v159
    v_and_b32 v167, s77, v159
    v_mul_f32 v136, v146, v147
    v_lshlrev_b32 v137, 16, v124
    v_and_b32 v138, s77, v124
    v_fma_f32 v139, v160, v147, -v136
    v_fma_f32 v140, v161, v147, -v136
    v_fmac_f32 v160, v137, v139
    v_fmac_f32 v161, v138, v140
    v_lshlrev_b32 v137, 16, v125
    v_and_b32 v138, s77, v125
    v_fma_f32 v139, v162, v147, -v136
    v_fma_f32 v140, v163, v147, -v136
    v_fmac_f32 v162, v137, v139
    v_fmac_f32 v163, v138, v140
    v_lshlrev_b32 v137, 16, v126
    v_and_b32 v138, s77, v126
    v_fma_f32 v139, v164, v147, -v136
    v_fma_f32 v140, v165, v147, -v136
    v_fmac_f32 v164, v137, v139
    v_fmac_f32 v165, v138, v140
    v_lshlrev_b32 v137, 16, v127
    v_and_b32 v138, s77, v127
    v_fma_f32 v139, v166, v147, -v136
    v_fma_f32 v140, v167, v147, -v136
    v_fmac_f32 v166, v137, v139
    v_fmac_f32 v167, v138, v140
    v_cvt_pk_bf16_f32 v116, v160, v161
    v_cvt_pk_bf16_f32 v117, v162, v163
    v_cvt_pk_bf16_f32 v118, v164, v165
    v_cvt_pk_bf16_f32 v119, v166, v167
    s_add_u32 s80, s3, 5619712
    buffer_store_dwordx4 v[116:119], v1, s[8:11], s80 offen sc0 sc1
    v_add_f32 v144, v160, v161
    v_mul_f32 v145, v160, v160
    v_fmac_f32 v145, v161, v161
    v_add_f32 v144, v144, v162
    v_fmac_f32 v145, v162, v162
    v_add_f32 v144, v144, v163
    v_fmac_f32 v145, v163, v163
    v_add_f32 v144, v144, v164
    v_fmac_f32 v145, v164, v164
    v_add_f32 v144, v144, v165
    v_fmac_f32 v145, v165, v165
    v_add_f32 v144, v144, v166
    v_fmac_f32 v145, v166, v166
    v_add_f32 v144, v144, v167
    v_fmac_f32 v145, v167, v167
    v_mov_b32 v146, v144
    v_mov_b32 v147, v145
    s_nop 0
    v_permlane32_swap_b32 v146, v144
    v_permlane32_swap_b32 v147, v145
    v_add_f32 v144, v144, v146
    v_add_f32 v145, v145, v147
    ds_write_b64 v14, v[144:145] offset:3072
    s_waitcnt vmcnt(0) lgkmcnt(0)
    s_barrier
    ds_read_b64 v[132:133], v14 offset:2560
    s_waitcnt lgkmcnt(0)
    s_cmp_eq_u32 s5, 0
    s_cbranch_scc0 GP_1_43
    v_add_f32 v128, v128, v132
    v_add_f32 v129, v129, v133
    v_mov_b32 v130, s96
    v_mov_b32 v131, s97
    s_add_u32 s80, s4, 23920640
    s_mov_b32 exec_hi, 0
    buffer_store_dwordx4 v[128:131], v1, s[8:11], s80 offen sc0 sc1
    s_mov_b32 exec_hi, -1
GP_1_43:
    ds_read_b64 v[148:149], v14 offset:3584
    s_waitcnt lgkmcnt(0)
    s_cmp_eq_u32 s5, 0
    s_cbranch_scc0 GP_1_44
    v_add_f32 v144, v144, v148
    v_add_f32 v145, v145, v149
    v_mov_b32 v146, s96
    v_mov_b32 v147, s97
    s_add_u32 s80, s4, 23920640
    s_add_u32 s80, s80, 28672
    s_mov_b32 exec_hi, 0
    buffer_store_dwordx4 v[144:147], v1, s[8:11], s80 offen sc0 sc1
    s_mov_b32 exec_hi, -1
GP_1_44:
    s_xor_b32 s100, s96, 1
    s_mov_b32 s101, s97
    s_mov_b32 s70, 0
    s_mov_b32 s72, 9175040
    s_mov_b32 s74, 25296896
    s_mov_b32 s71, 5505024
    v_and_b32 v5, 31, v0
    v_lshlrev_b32 v5, 4, v5
    v_add_u32 v5, 114688, v5
    v_add_u32 v2, 0, v1
    v_add_u32 v7, 57344, v1
    s_mul_i32 s80, s76, 112
    s_add_u32 s80, s80, s63
    s_lshl_b32 s79, s80, 10
    s_add_u32 s79, s79, s72
    s_lshl_b32 s80, s80, 3
    s_add_u32 s80, s80, s74
    v_mov_b32 v8, s80
    v_add_u32 v9, 3584, v8
    s_mul_i32 s84, s36, 7168
    s_mul_i32 s85, s76, 28672
    s_add_u32 s85, s85, s71
    s_add_u32 s85, s85, s84
    s_add_u32 s82, s76, s36
    s_mul_i32 s83, s82, 7168
    s_add_u32 s83, s83, 23920640
    v_and_b32 v4, 31, v0
    v_lshlrev_b32 v4, 4, v4
    v_lshrrev_b32 v6, 5, v0
    v_lshl_add_u32 v4, v6, 9, v4
    v_add_u32 v4, s83, v4
    buffer_load_dwordx4 v[64:67], v4, s[8:11], 0 offen offset:0 sc1
    buffer_load_dwordx4 v[68:71], v4, s[8:11], 0 offen offset:1024 sc1
    buffer_load_dwordx4 v[72:75], v4, s[8:11], 0 offen offset:2048 sc1
    buffer_load_dwordx4 v[76:79], v4, s[8:11], 0 offen offset:3072 sc1
    buffer_load_dwordx4 v[80:83], v4, s[8:11], s78 offen offset:0 sc1
    buffer_load_dwordx4 v[84:87], v4, s[8:11], s78 offen offset:1024 sc1
    buffer_load_dwordx4 v[88:91], v4, s[8:11], s78 offen offset:2048 sc1
    v_add_u32 v6, 28672, v4
    buffer_load_dwordx4 v[92:95], v6, s[8:11], 0 offen offset:0 sc1
    buffer_load_dwordx4 v[96:99], v6, s[8:11], 0 offen offset:1024 sc1
    buffer_load_dwordx4 v[100:103], v6, s[8:11], 0 offen offset:2048 sc1
    buffer_load_dwordx4 v[104:107], v6, s[8:11], 0 offen offset:3072 sc1
    buffer_load_dwordx4 v[108:111], v6, s[8:11], s78 offen offset:0 sc1
    buffer_load_dwordx4 v[168:171], v6, s[8:11], s78 offen offset:1024 sc1
    buffer_load_dwordx4 v[172:175], v6, s[8:11], s78 offen offset:2048 sc1
    s_waitcnt vmcnt(7)
    s_mov_b32 s80, 0
GC_1_45:
    v_cmpx_eq_u64 vcc, s[96:97], v[66:67]
    v_cmpx_eq_u64 vcc, s[96:97], v[70:71]
    v_cmpx_eq_u64 vcc, s[96:97], v[74:75]
    v_cmpx_eq_u64 vcc, s[96:97], v[78:79]
    v_cmpx_eq_u64 vcc, s[96:97], v[82:83]
    v_cmpx_eq_u64 vcc, s[96:97], v[86:87]
    v_cmpx_eq_u64 vcc, s[96:97], v[90:91]
    s_nop 4
    s_cmp_eq_u64 exec, -1
    s_mov_b64 exec, -1
    s_cbranch_scc1 GCD_1_46
    buffer_load_dwordx4 v[64:67], v4, s[8:11], 0 offen offset:0 sc1
    buffer_load_dwordx4 v[68:71], v4, s[8:11], 0 offen offset:1024 sc1
    buffer_load_dwordx4 v[72:75], v4, s[8:11], 0 offen offset:2048 sc1
    buffer_load_dwordx4 v[76:79], v4, s[8:11], 0 offen offset:3072 sc1
    buffer_load_dwordx4 v[80:83], v4, s[8:11], s78 offen offset:0 sc1
    buffer_load_dwordx4 v[84:87], v4, s[8:11], s78 offen offset:1024 sc1
    buffer_load_dwordx4 v[88:91], v4, s[8:11], s78 offen offset:2048 sc1
    s_waitcnt vmcnt(0)
    s_add_u32 s80, s80, 1
    s_cmp_lt_u32 s80, 20000
    s_cbranch_scc0 GCD_1_46_to
    s_sleep 1
    s_branch GC_1_45
GCD_1_46_to:
    s_or_b32 s39, s39, 4
GCD_1_46:
    s_waitcnt vmcnt(0)
    s_mov_b32 s80, 0
GC_1_47:
    v_cmpx_eq_u64 vcc, s[96:97], v[94:95]
    v_cmpx_eq_u64 vcc, s[96:97], v[98:99]
    v_cmpx_eq_u64 vcc, s[96:97], v[102:103]
    v_cmpx_eq_u64 vcc, s[96:97], v[106:107]
    v_cmpx_eq_u64 vcc, s[96:97], v[110:111]
    v_cmpx_eq_u64 vcc, s[96:97], v[170:171]
    v_cmpx_eq_u64 vcc, s[96:97], v[174:175]
    s_nop 4
    s_cmp_eq_u64 exec, -1
    s_mov_b64 exec, -1
    s_cbranch_scc1 GCD_1_48
    buffer_load_dwordx4 v[92:95], v6, s[8:11], 0 offen offset:0 sc1
    buffer_load_dwordx4 v[96:99], v6, s[8:11], 0 offen offset:1024 sc1
    buffer_load_dwordx4 v[100:103], v6, s[8:11], 0 offen offset:2048 sc1
    buffer_load_dwordx4 v[104:107], v6, s[8:11], 0 offen offset:3072 sc1
    buffer_load_dwordx4 v[108:111], v6, s[8:11], s78 offen offset:0 sc1
    buffer_load_dwordx4 v[168:171], v6, s[8:11], s78 offen offset:1024 sc1
    buffer_load_dwordx4 v[172:175], v6, s[8:11], s78 offen offset:2048 sc1
    s_waitcnt vmcnt(0)
    s_add_u32 s80, s80, 1
    s_cmp_lt_u32 s80, 20000
    s_cbranch_scc0 GCD_1_48_to
    s_sleep 1
    s_branch GC_1_47
GCD_1_48_to:
    s_or_b32 s39, s39, 64
GCD_1_48:
    v_add_u32 v4, 28672, v4
    s_barrier
    s_add_u32 s83, s85, 0
    s_add_u32 m0, s84, 0
    s_nop 0
    buffer_load_dwordx4 v1, s[8:11], s83 offen offset:0 lds
    buffer_load_dwordx4 v1, s[8:11], s83 offen offset:1024 lds
    buffer_load_dwordx4 v1, s[8:11], s83 offen offset:2048 lds
    buffer_load_dwordx4 v1, s[8:11], s83 offen offset:3072 lds
    s_add_u32 s83, s83, 4096
    s_add_u32 m0, s84, 4096
    s_nop 0
    buffer_load_dwordx4 v1, s[8:11], s83 offen offset:0 lds
    buffer_load_dwordx4 v1, s[8:11], s83 offen offset:1024 lds
    buffer_load_dwordx4 v1, s[8:11], s83 offen offset:2048 lds
    s_add_u32 s83, s85, 28672
    s_add_u32 m0, s84, 28672
    s_nop 0
    buffer_load_dwordx4 v1, s[8:11], s83 offen offset:0 lds
    buffer_load_dwordx4 v1, s[8:11], s83 offen offset:1024 lds
    buffer_load_dwordx4 v1, s[8:11], s83 offen offset:2048 lds
    buffer_load_dwordx4 v1, s[8:11], s83 offen offset:3072 lds
    s_add_u32 s83, s83, 4096
    s_add_u32 m0, s84, 32768
    s_nop 0
    buffer_load_dwordx4 v1, s[8:11], s83 offen offset:0 lds
    buffer_load_dwordx4 v1, s[8:11], s83 offen offset:1024 lds
    buffer_load_dwordx4 v1, s[8:11], s83 offen offset:2048 lds
    v_add_f32 v66, v64, v68
    v_add_f32 v67, v65, v69
    v_add_f32 v66, v66, v72
    v_add_f32 v67, v67, v73
    v_add_f32 v66, v66, v76
    v_add_f32 v67, v67, v77
    v_add_f32 v66, v66, v80
    v_add_f32 v67, v67, v81
    v_add_f32 v66, v66, v84
    v_add_f32 v67, v67, v85
    v_add_f32 v66, v66, v88
    v_add_f32 v67, v67, v89
    v_mov_b32 v70, v66
    v_mov_b32 v71, v67
    s_nop 0
    v_permlane32_swap_b32 v70, v66
    v_permlane32_swap_b32 v71, v67
    v_add_f32 v66, v66, v70
    v_add_f32 v67, v67, v71
    v_mul_f32 v72, 0x3b124925, v66
    v_mul_f32 v77, 0x3b124925, v67
    v_fma_f32 v77, -v72, v72, v77
    v_max_f32 v77, 0, v77
    v_add_f32 v77, 0x3727c5ac, v77
    v_rsq_f32 v76, v77
    v_mov_b32 v75, 0
    v_mul_f32 v73, 0xbfb8aa3b, v76
    v_mul_f32 v74, v76, v76
    s_lshl_b32 s80, s36, 9
    v_add_u32 v80, s80, v5
    ds_write_b128 v80, v[72:75] offset:0
    s_lshl_b32 s94, s66, 2
    s_add_u32 s94, s94, s36
    s_lshl_b32 s80, s94, 3
    s_add_u32 s80, s80, 25419776
    v_mov_b32 v3, s80
    buffer_load_dwordx2 v[160:161], v3, s[8:11], 0 offen sc1
    s_mul_i32 s94, s94, 57344
    s_add_u32 s94, s94, 25420800
    s_waitcnt vmcnt(0)
    v_cmp_ne_u64 vcc, s[96:97], v[160:161]
    s_cbranch_vccz FSD_1_50
    s_mov_b32 s80, 0
FS_1_49:
    buffer_load_dwordx2 v[160:161], v3, s[8:11], 0 offen sc1
    s_waitcnt vmcnt(0)
    v_cmp_ne_u64 vcc, s[96:97], v[160:161]
    s_cbranch_vccz FSD_1_50
    s_add_u32 s80, s80, 1
    s_cmp_lt_u32 s80, 20000
    s_cbranch_scc0 FSD_1_50_to
    s_sleep 1
    s_branch FS_1_49
FSD_1_50_to:
    s_or_b32 s39, s39, 4096
FSD_1_50:
    s_waitcnt lgkmcnt(0)
    s_barrier
    ds_read_b128 v[64:67], v2 offset:0
    ds_read_b128 v[68:71], v2 offset:1024
    ds_read_b128 v[72:75], v2 offset:2048
    ds_read_b128 v[76:79], v2 offset:3072
    ds_read_b128 v[80:83], v2 offset:4096
    ds_read_b128 v[84:87], v2 offset:5120
    s_waitcnt lgkmcnt(4)
    v_mfma_f32_32x32x16_bf16 v[16:31], a[224:227], v[64:67], 0
    ds_read_b128 v[88:91], v2 offset:6144
    v_mfma_f32_32x32x16_bf16 v[16:31], a[228:231], v[68:71], v[16:31]
    ds_read_b128 v[64:67], v2 offset:7168
    s_waitcnt lgkmcnt(4)
    v_mfma_f32_32x32x16_bf16 v[16:31], a[232:235], v[72:75], v[16:31]
    v_add_f32 v94, v92, v96
    v_add_f32 v95, v93, v97
    v_add_f32 v94, v94, v100
    v_add_f32 v95, v95, v101
    ds_read_b128 v[68:71], v2 offset:8192
    v_mfma_f32_32x32x16_bf16 v[16:31], a[236:239], v[76:79], v[16:31]
    v_add_f32 v94, v94, v104
    v_add_f32 v95, v95, v105
    v_add_f32 v94, v94, v108
    ds_read_b128 v[72:75], v2 offset:9216
    s_waitcnt lgkmcnt(4)
    v_mfma_f32_32x32x16_bf16 v[16:31], a[240:243], v[80:83], v[16:31]
    v_add_f32 v95, v95, v109
    v_add_f32 v94, v94, v168
    v_add_f32 v95, v95, v169
    v_add_f32 v94, v94, v172
    ds_read_b128 v[76:79], v2 offset:10240
    v_mfma_f32_32x32x16_bf16 v[16:31], a[244:247], v[84:87], v[16:31]
    v_add_f32 v95, v95, v173
    v_mov_b32 v98, v94
    v_mov_b32 v99, v95
    ds_read_b128 v[80:83], v2 offset:11264
    s_waitcnt lgkmcnt(4)
    v_mfma_f32_32x32x16_bf16 v[16:31], a[248:251], v[88:91], v[16:31]
    s_nop 0
    v_permlane32_swap_b32 v98, v94
    v_permlane32_swap_b32 v99, v95
    v_add_f32 v94, v94, v98
    ds_read_b128 v[84:87], v2 offset:12288
    v_mfma_f32_32x32x16_bf16 v[16:31], a[252:255], v[64:67], v[16:31]
    v_add_f32 v95, v95, v99
    v_mul_f32 v100, 0x3b124925, v94
    v_mul_f32 v105, 0x3b124925, v95
    ds_read_b128 v[88:91], v2 offset:13312
    s_waitcnt lgkmcnt(4)
    v_mfma_f32_32x32x16_bf16 v[16:31], v[176:179], v[68:71], v[16:31]
    v_fma_f32 v105, -v100, v100, v105
    v_max_f32 v105, 0, v105
    v_add_f32 v105, 0x3727c5ac, v105
    ds_read_b128 v[64:67], v2 offset:14336
    v_mfma_f32_32x32x16_bf16 v[16:31], v[180:183], v[72:75], v[16:31]
    v_rsq_f32 v104, v105
    v_mov_b32 v103, 0
    ds_read_b128 v[68:71], v2 offset:15360
    s_waitcnt lgkmcnt(4)
    v_mfma_f32_32x32x16_bf16 v[16:31], v[184:187], v[76:79], v[16:31]
    v_mul_f32 v101, 0xbfb8aa3b, v104
    v_mul_f32 v102, v104, v104
    ds_read_b128 v[72:75], v2 offset:16384
    v_mfma_f32_32x32x16_bf16 v[16:31], v[188:191], v[80:83], v[16:31]
    s_lshl_b32 s80, s36, 9
    v_add_u32 v108, s80, v5
    ds_write_b128 v108, v[100:103] offset:2048
    ds_read_b128 v[76:79], v2 offset:17408
    s_waitcnt lgkmcnt(5)
    v_mfma_f32_32x32x16_bf16 v[16:31], v[192:195], v[84:87], v[16:31]
    ds_read_b128 v[80:83], v2 offset:18432
    v_mfma_f32_32x32x16_bf16 v[16:31], v[196:199], v[88:91], v[16:31]
    ds_read_b128 v[84:87], v2 offset:19456
    s_waitcnt lgkmcnt(5)
    v_mfma_f32_32x32x16_bf16 v[16:31], v[200:203], v[64:67], v[16:31]
    s_add_u32 s83, s85, 57344
    s_add_u32 m0, s84, 57344
    s_nop 0
    buffer_load_dwordx4 v1, s[8:11], s83 offen offset:0 lds
    ds_read_b128 v[88:91], v2 offset:20480
    v_mfma_f32_32x32x16_bf16 v[16:31], v[204:207], v[68:71], v[16:31]
    ds_read_b128 v[64:67], v2 offset:21504
    s_waitcnt lgkmcnt(4)
    v_mfma_f32_32x32x16_bf16 v[16:31], v[208:211], v[72:75], v[16:31]
    s_add_u32 m0, s84, 57344
    s_nop 0
    buffer_load_dwordx4 v1, s[8:11], s83 offen offset:1024 lds
    ds_read_b128 v[68:71], v2 offset:22528
    v_mfma_f32_32x32x16_bf16 v[16:31], v[212:215], v[76:79], v[16:31]
    ds_read_b128 v[72:75], v2 offset:23552
    s_waitcnt lgkmcnt(4)
    v_mfma_f32_32x32x16_bf16 v[16:31], v[216:219], v[80:83], v[16:31]
    s_add_u32 m0, s84, 57344
    s_nop 0
    buffer_load_dwordx4 v1, s[8:11], s83 offen offset:2048 lds
    ds_read_b128 v[76:79], v2 offset:24576
    v_mfma_f32_32x32x16_bf16 v[16:31], v[220:223], v[84:87], v[16:31]
    ds_read_b128 v[80:83], v2 offset:25600
    s_waitcnt lgkmcnt(4)
    v_mfma_f32_32x32x16_bf16 v[16:31], v[224:227], v[88:91], v[16:31]
    s_add_u32 m0, s84, 57344
    s_nop 0
    buffer_load_dwordx4 v1, s[8:11], s83 offen offset:3072 lds
    ds_read_b128 v[84:87], v2 offset:26624
    v_mfma_f32_32x32x16_bf16 v[16:31], v[228:231], v[64:67], v[16:31]
    s_barrier
    ds_read_b128 v[88:91], v2 offset:27648
    s_waitcnt lgkmcnt(4)
    v_mfma_f32_32x32x16_bf16 v[16:31], v[232:235], v[68:71], v[16:31]
    s_add_u32 s83, s83, 4096
    s_add_u32 m0, s84, 61440
    s_nop 0
    buffer_load_dwordx4 v1, s[8:11], s83 offen offset:0 lds
    ds_read_b128 v[64:67], v2 offset:28672
    v_mfma_f32_32x32x16_bf16 v[16:31], v[236:239], v[72:75], v[16:31]
    ds_read_b128 v[68:71], v2 offset:29696
    s_waitcnt lgkmcnt(4)
    v_mfma_f32_32x32x16_bf16 v[16:31], v[240:243], v[76:79], v[16:31]
    s_add_u32 m0, s84, 61440
    s_nop 0
    buffer_load_dwordx4 v1, s[8:11], s83 offen offset:1024 lds
    ds_read_b128 v[72:75], v2 offset:30720
    v_mfma_f32_32x32x16_bf16 v[16:31], v[244:247], v[80:83], v[16:31]
    ds_read_b128 v[76:79], v2 offset:31744
    s_waitcnt lgkmcnt(4)
    v_mfma_f32_32x32x16_bf16 v[16:31], v[248:251], v[84:87], v[16:31]
    s_add_u32 m0, s84, 61440
    s_nop 0
    buffer_load_dwordx4 v1, s[8:11], s83 offen offset:2048 lds
    ds_read_b128 v[80:83], v2 offset:32768
    v_mfma_f32_32x32x16_bf16 v[16:31], v[252:255], v[88:91], v[16:31]
    ds_read_b128 v[84:87], v2 offset:33792
    s_waitcnt lgkmcnt(4)
    v_mfma_f32_32x32x16_bf16 v[32:47], a[224:227], v[64:67], 0
    s_add_u32 s95, s94, 0
    buffer_load_dwordx4 a[0:3], v1, s[8:11], s95 offen offset:0
    ds_read_b64 v[152:153], v5 offset:0
    ds_read_b128 v[88:91], v2 offset:34816
    v_mfma_f32_32x32x16_bf16 v[32:47], a[228:231], v[68:71], v[32:47]
    buffer_load_dwordx4 a[4:7], v1, s[8:11], s95 offen offset:1024
    ds_read_b128 v[64:67], v2 offset:35840
    s_waitcnt lgkmcnt(5)
    v_mfma_f32_32x32x16_bf16 v[32:47], a[232:235], v[72:75], v[32:47]
    s_waitcnt lgkmcnt(2)
    v_fma_f32 v128, -v152, v48, v16
    v_fma_f32 v136, -v152, v56, v24
    v_fma_f32 v129, -v152, v49, v17
    ds_read_b128 v[68:71], v2 offset:36864
    v_mfma_f32_32x32x16_bf16 v[32:47], a[236:239], v[76:79], v[32:47]
    buffer_load_dwordx4 a[8:11], v1, s[8:11], s95 offen offset:2048
    ds_read_b128 v[72:75], v2 offset:37888
    v_mfma_f32_32x32x16_bf16 v[32:47], a[240:243], v[80:83], v[32:47]
    buffer_load_dwordx4 a[12:15], v1, s[8:11], s95 offen offset:3072
    ds_read_b128 v[76:79], v2 offset:38912
    v_mfma_f32_32x32x16_bf16 v[32:47], a[244:247], v[84:87], v[32:47]
    v_fma_f32 v137, -v152, v57, v25
    v_mul_f32 v144, v128, v153
    v_mul_f32 v128, v128, v136
    ds_read_b128 v[80:83], v2 offset:39936
    s_waitcnt lgkmcnt(4)
    v_mfma_f32_32x32x16_bf16 v[32:47], a[248:251], v[88:91], v[32:47]
    s_add_u32 s95, s94, 4096
    buffer_load_dwordx4 a[16:19], v1, s[8:11], s95 offen offset:0
    ds_read_b128 v[84:87], v2 offset:40960
    v_mfma_f32_32x32x16_bf16 v[32:47], a[252:255], v[64:67], v[32:47]
    buffer_load_dwordx4 a[20:23], v1, s[8:11], s95 offen offset:1024
    ds_read_b128 v[88:91], v2 offset:41984
    s_waitcnt lgkmcnt(4)
    v_mfma_f32_32x32x16_bf16 v[32:47], v[176:179], v[68:71], v[32:47]
    v_fma_f32 v130, -v152, v50, v18
    v_exp_f32 v144, v144
    v_fma_f32 v138, -v152, v58, v26
    ds_read_b128 v[64:67], v2 offset:43008
    v_mfma_f32_32x32x16_bf16 v[32:47], v[180:183], v[72:75], v[32:47]
    buffer_load_dwordx4 a[24:27], v1, s[8:11], s95 offen offset:2048
    ds_read_b128 v[68:71], v2 offset:44032
    s_waitcnt lgkmcnt(4)
    v_mfma_f32_32x32x16_bf16 v[32:47], v[184:187], v[76:79], v[32:47]
    buffer_load_dwordx4 a[28:31], v1, s[8:11], s95 offen offset:3072
    ds_read_b128 v[72:75], v2 offset:45056
    v_mfma_f32_32x32x16_bf16 v[32:47], v[188:191], v[80:83], v[32:47]
    v_mul_f32 v145, v129, v153
    v_mul_f32 v129, v129, v137
    v_fma_f32 v131, -v152, v51, v19
    ds_read_b128 v[76:79], v2 offset:46080
    s_waitcnt lgkmcnt(4)
    v_mfma_f32_32x32x16_bf16 v[32:47], v[192:195], v[84:87], v[32:47]
    s_add_u32 s95, s94, 8192
    buffer_load_dwordx4 a[32:35], v1, s[8:11], s95 offen offset:0
    ds_read_b128 v[80:83], v2 offset:47104
    v_mfma_f32_32x32x16_bf16 v[32:47], v[196:199], v[88:91], v[32:47]
    v_exp_f32 v145, v145
    v_fma_f32 v139, -v152, v59, v27
    ds_read_b128 v[84:87], v2 offset:48128
    s_waitcnt lgkmcnt(4)
    v_mfma_f32_32x32x16_bf16 v[32:47], v[200:203], v[64:67], v[32:47]
    s_add_u32 s83, s85, 86016
    s_add_u32 m0, s84, 86016
    s_nop 0
    buffer_load_dwordx4 v1, s[8:11], s83 offen offset:0 lds
    ds_read_b128 v[88:91], v2 offset:49152
    v_mfma_f32_32x32x16_bf16 v[32:47], v[204:207], v[68:71], v[32:47]
    v_mul_f32 v146, v130, v153
    v_mul_f32 v130, v130, v138
    v_fma_f32 v132, -v152, v52, v20
    ds_read_b128 v[64:67], v2 offset:50176
    s_waitcnt lgkmcnt(4)
    v_mfma_f32_32x32x16_bf16 v[32:47], v[208:211], v[72:75], v[32:47]
    s_add_u32 m0, s84, 86016
    s_nop 0
    buffer_load_dwordx4 v1, s[8:11], s83 offen offset:1024 lds
    ds_read_b128 v[68:71], v2 offset:51200
    v_mfma_f32_32x32x16_bf16 v[32:47], v[212:215], v[76:79], v[32:47]
    v_exp_f32 v146, v146
    v_fma_f32 v140, -v152, v60, v28
    ds_read_b128 v[72:75], v2 offset:52224
    s_waitcnt lgkmcnt(4)
    v_mfma_f32_32x32x16_bf16 v[32:47], v[216:219], v[80:83], v[32:47]
    s_add_u32 m0, s84, 86016
    s_nop 0
    buffer_load_dwordx4 v1, s[8:11], s83 offen offset:2048 lds
    v_mul_f32 v147, v131, v153
    ds_read_b128 v[76:79], v2 offset:53248
    v_mfma_f32_32x32x16_bf16 v[32:47], v[220:223], v[84:87], v[32:47]
    v_mul_f32 v131, v131, v139
    v_add_f32 v144, 1.0, v144
    v_fma_f32 v133, -v152, v53, v21
    ds_read_b128 v[80:83], v2 offset:54272
    s_waitcnt lgkmcnt(4)
    v_mfma_f32_32x32x16_bf16 v[32:47], v[224:227], v[88:91], v[32:47]
    s_add_u32 m0, s84, 86016
    s_nop 0
    buffer_load_dwordx4 v1, s[8:11], s83 offen offset:3072 lds
    s_waitcnt vmcnt(13)
    ds_read_b128 v[84:87], v2 offset:55296
    v_mfma_f32_32x32x16_bf16 v[32:47], v[228:231], v[64:67], v[32:47]
    s_barrier
    v_exp_f32 v147, v147
    ds_read_b128 v[88:91], v2 offset:56320
    s_waitcnt lgkmcnt(4)
    v_mfma_f32_32x32x16_bf16 v[32:47], v[232:235], v[68:71], v[32:47]
    s_add_u32 s83, s83, 4096
    s_add_u32 m0, s84, 90112
    s_nop 0
    buffer_load_dwordx4 v1, s[8:11], s83 offen offset:0 lds
    ds_read_b128 v[64:67], v7 offset:0
    v_mfma_f32_32x32x16_bf16 v[32:47], v[236:239], v[72:75], v[32:47]
    v_fma_f32 v141, -v152, v61, v29
    v_mul_f32 v148, v132, v153
    ds_read_b128 v[68:71], v7 offset:1024
    s_waitcnt lgkmcnt(4)
    v_mfma_f32_32x32x16_bf16 v[32:47], v[240:243], v[76:79], v[32:47]
    s_add_u32 m0, s84, 90112
    s_nop 0
    buffer_load_dwordx4 v1, s[8:11], s83 offen offset:1024 lds
    ds_read_b128 v[72:75], v7 offset:2048
    v_mfma_f32_32x32x16_bf16 v[32:47], v[244:247], v[80:83], v[32:47]
    v_rcp_f32 v144, v144
    v_mul_f32 v132, v132, v140
    ds_read_b128 v[76:79], v7 offset:3072
    s_waitcnt lgkmcnt(4)
    v_mfma_f32_32x32x16_bf16 v[32:47], v[248:251], v[84:87], v[32:47]
    s_add_u32 m0, s84, 90112
    s_nop 0
    buffer_load_dwordx4 v1, s[8:11], s83 offen offset:2048 lds
    v_add_f32 v145, 1.0, v145
    ds_read_b128 v[80:83], v7 offset:4096
    v_mfma_f32_32x32x16_bf16 v[32:47], v[252:255], v[88:91], v[32:47]
    v_fma_f32 v134, -v152, v54, v22
    v_exp_f32 v148, v148
    v_fma_f32 v142, -v152, v62, v30
    v_mul_f32 v149, v133, v153
    v_rcp_f32 v145, v145
    v_mul_f32 v133, v133, v141
    v_add_f32 v146, 1.0, v146
    v_fma_f32 v135, -v152, v55, v23
    v_exp_f32 v149, v149
    v_fma_f32 v143, -v152, v63, v31
    v_mul_f32 v150, v134, v153
    v_rcp_f32 v146, v146
    v_mul_f32 v134, v134, v142
    v_add_f32 v147, 1.0, v147
    v_mul_f32 v136, v128, v144
    v_exp_f32 v150, v150
    v_mul_f32 v151, v135, v153
    v_rcp_f32 v147, v147
    v_mul_f32 v135, v135, v143
    v_add_f32 v148, 1.0, v148
    v_mul_f32 v137, v129, v145
    v_exp_f32 v151, v151
    v_rcp_f32 v148, v148
    v_add_f32 v149, 1.0, v149
    v_mul_f32 v138, v130, v146
    v_cvt_pk_bf16_f32 v156, v136, v137
    v_rcp_f32 v149, v149
    v_add_f32 v150, 1.0, v150
    v_mul_f32 v139, v131, v147
    v_rcp_f32 v150, v150
    v_add_f32 v151, 1.0, v151
    v_mul_f32 v140, v132, v148
    v_cvt_pk_bf16_f32 v157, v138, v139
    v_rcp_f32 v151, v151
    v_mul_f32 v141, v133, v149
    v_mul_f32 v142, v134, v150
    v_cvt_pk_bf16_f32 v158, v140, v141
    v_mul_f32 v143, v135, v151
    v_cvt_pk_bf16_f32 v159, v142, v143
    s_add_u32 s82, s79, 0
    buffer_store_dwordx4 v[156:159], v1, s[8:11], s82 offen sc0 sc1
    ds_read_b128 v[84:87], v7 offset:5120
    s_waitcnt lgkmcnt(4)
    v_mfma_f32_32x32x16_bf16 v[16:31], a[224:227], v[64:67], 0
    s_add_u32 s95, s94, 8192
    buffer_load_dwordx4 a[36:39], v1, s[8:11], s95 offen offset:1024
    ds_read_b64 v[152:153], v5 offset:512
    ds_read_b128 v[88:91], v7 offset:6144
    v_mfma_f32_32x32x16_bf16 v[16:31], a[228:231], v[68:71], v[16:31]
    buffer_load_dwordx4 a[40:43], v1, s[8:11], s95 offen offset:2048
    ds_read_b128 v[64:67], v7 offset:7168
    s_waitcnt lgkmcnt(5)
    v_mfma_f32_32x32x16_bf16 v[16:31], a[232:235], v[72:75], v[16:31]
    s_waitcnt lgkmcnt(2)
    v_fma_f32 v128, -v152, v48, v32
    v_fma_f32 v136, -v152, v56, v40
    v_fma_f32 v129, -v152, v49, v33
    ds_read_b128 v[68:71], v7 offset:8192
    v_mfma_f32_32x32x16_bf16 v[16:31], a[236:239], v[76:79], v[16:31]
    buffer_load_dwordx4 a[44:47], v1, s[8:11], s95 offen offset:3072
    ds_read_b128 v[72:75], v7 offset:9216
    v_mfma_f32_32x32x16_bf16 v[16:31], a[240:243], v[80:83], v[16:31]
    s_add_u32 s95, s94, 12288
    buffer_load_dwordx4 a[48:51], v1, s[8:11], s95 offen offset:0
    ds_read_b128 v[76:79], v7 offset:10240
    v_mfma_f32_32x32x16_bf16 v[16:31], a[244:247], v[84:87], v[16:31]
    v_fma_f32 v137, -v152, v57, v41
    v_mul_f32 v144, v128, v153
    v_mul_f32 v128, v128, v136
    ds_read_b128 v[80:83], v7 offset:11264
    s_waitcnt lgkmcnt(4)
    v_mfma_f32_32x32x16_bf16 v[16:31], a[248:251], v[88:91], v[16:31]
    buffer_load_dwordx4 a[52:55], v1, s[8:11], s95 offen offset:1024
    ds_read_b128 v[84:87], v7 offset:12288
    v_mfma_f32_32x32x16_bf16 v[16:31], a[252:255], v[64:67], v[16:31]
    buffer_load_dwordx4 a[56:59], v1, s[8:11], s95 offen offset:2048
    ds_read_b128 v[88:91], v7 offset:13312
    s_waitcnt lgkmcnt(4)
    v_mfma_f32_32x32x16_bf16 v[16:31], v[176:179], v[68:71], v[16:31]
    v_fma_f32 v130, -v152, v50, v34
    v_exp_f32 v144, v144
    v_fma_f32 v138, -v152, v58, v42
    ds_read_b128 v[64:67], v7 offset:14336
    v_mfma_f32_32x32x16_bf16 v[16:31], v[180:183], v[72:75], v[16:31]
    buffer_load_dwordx4 a[60:63], v1, s[8:11], s95 offen offset:3072
    ds_read_b128 v[68:71], v7 offset:15360
    s_waitcnt lgkmcnt(4)
    v_mfma_f32_32x32x16_bf16 v[16:31], v[184:187], v[76:79], v[16:31]
    s_add_u32 s95, s94, 16384
    buffer_load_dwordx4 a[64:67], v1, s[8:11], s95 offen offset:0
    ds_read_b128 v[72:75], v7 offset:16384
    v_mfma_f32_32x32x16_bf16 v[16:31], v[188:191], v[80:83], v[16:31]
    v_mul_f32 v145, v129, v153
    v_mul_f32 v129, v129, v137
    v_fma_f32 v131, -v152, v51, v35
    ds_read_b128 v[76:79], v7 offset:17408
    s_waitcnt lgkmcnt(4)
    v_mfma_f32_32x32x16_bf16 v[16:31], v[192:195], v[84:87], v[16:31]
    buffer_load_dwordx4 a[68:71], v1, s[8:11], s95 offen offset:1024
    ds_read_b128 v[80:83], v7 offset:18432
    v_mfma_f32_32x32x16_bf16 v[16:31], v[196:199], v[88:91], v[16:31]
    v_exp_f32 v145, v145
    v_fma_f32 v139, -v152, v59, v43
    ds_read_b128 v[84:87], v7 offset:19456
    s_waitcnt lgkmcnt(4)
    v_mfma_f32_32x32x16_bf16 v[16:31], v[200:203], v[64:67], v[16:31]
    s_add_u32 s83, s85, 114688
    s_add_u32 m0, s84, 0
    s_nop 0
    buffer_load_dwordx4 v1, s[8:11], s83 offen offset:0 lds
    ds_read_b128 v[88:91], v7 offset:20480
    v_mfma_f32_32x32x16_bf16 v[16:31], v[204:207], v[68:71], v[16:31]
    v_mul_f32 v146, v130, v153
    v_mul_f32 v130, v130, v138
    v_fma_f32 v132, -v152, v52, v36
    ds_read_b128 v[64:67], v7 offset:21504
    s_waitcnt lgkmcnt(4)
    v_mfma_f32_32x32x16_bf16 v[16:31], v[208:211], v[72:75], v[16:31]
    s_add_u32 m0, s84, 0
    s_nop 0
    buffer_load_dwordx4 v1, s[8:11], s83 offen offset:1024 lds
    ds_read_b128 v[68:71], v7 offset:22528
    v_mfma_f32_32x32x16_bf16 v[16:31], v[212:215], v[76:79], v[16:31]
    v_exp_f32 v146, v146
    v_fma_f32 v140, -v152, v60, v44
    ds_read_b128 v[72:75], v7 offset:23552
    s_waitcnt lgkmcnt(4)
    v_mfma_f32_32x32x16_bf16 v[16:31], v[216:219], v[80:83], v[16:31]
    s_add_u32 m0, s84, 0
    s_nop 0
    buffer_load_dwordx4 v1, s[8:11], s83 offen offset:2048 lds
    v_mul_f32 v147, v131, v153
    ds_read_b128 v[76:79], v7 offset:24576
    v_mfma_f32_32x32x16_bf16 v[16:31], v[220:223], v[84:87], v[16:31]
    v_mul_f32 v131, v131, v139
    v_add_f32 v144, 1.0, v144
    v_fma_f32 v133, -v152, v53, v37
    ds_read_b128 v[80:83], v7 offset:25600
    s_waitcnt lgkmcnt(4)
    v_mfma_f32_32x32x16_bf16 v[16:31], v[224:227], v[88:91], v[16:31]
    s_add_u32 m0, s84, 0
    s_nop 0
    buffer_load_dwordx4 v1, s[8:11], s83 offen offset:3072 lds
    s_waitcnt vmcnt(13)
    buffer_store_dwordx2 v[10:11], v8, s[8:11], 0 offen offset:0 sc0 sc1
    ds_read_b128 v[84:87], v7 offset:26624
    v_mfma_f32_32x32x16_bf16 v[16:31], v[228:231], v[64:67], v[16:31]
    s_barrier
    v_exp_f32 v147, v147
    ds_read_b128 v[88:91], v7 offset:27648
    s_waitcnt lgkmcnt(4)
    v_mfma_f32_32x32x16_bf16 v[16:31], v[232:235], v[68:71], v[16:31]
    s_add_u32 s83, s83, 4096
    s_add_u32 m0, s84, 4096
    s_nop 0
    buffer_load_dwordx4 v1, s[8:11], s83 offen offset:0 lds
    ds_read_b128 v[64:67], v7 offset:28672
    v_mfma_f32_32x32x16_bf16 v[16:31], v[236:239], v[72:75], v[16:31]
    v_fma_f32 v141, -v152, v61, v45
    v_mul_f32 v148, v132, v153
    ds_read_b128 v[68:71], v7 offset:29696
    s_waitcnt lgkmcnt(4)
    v_mfma_f32_32x32x16_bf16 v[16:31], v[240:243], v[76:79], v[16:31]
    s_add_u32 m0, s84, 4096
    s_nop 0
    buffer_load_dwordx4 v1, s[8:11], s83 offen offset:1024 lds
    ds_read_b128 v[72:75], v7 offset:30720
    v_mfma_f32_32x32x16_bf16 v[16:31], v[244:247], v[80:83], v[16:31]
    v_rcp_f32 v144, v144
    v_mul_f32 v132, v132, v140
    ds_read_b128 v[76:79], v7 offset:31744
    s_waitcnt lgkmcnt(4)
    v_mfma_f32_32x32x16_bf16 v[16:31], v[248:251], v[84:87], v[16:31]
    s_add_u32 m0, s84, 4096
    s_nop 0
    buffer_load_dwordx4 v1, s[8:11], s83 offen offset:2048 lds
    v_add_f32 v145, 1.0, v145
    ds_read_b128 v[80:83], v7 offset:32768
    v_mfma_f32_32x32x16_bf16 v[16:31], v[252:255], v[88:91], v[16:31]
    v_fma_f32 v134, -v152, v54, v38
    v_exp_f32 v148, v148
    v_fma_f32 v142, -v152, v62, v46
    v_mul_f32 v149, v133, v153
    v_rcp_f32 v145, v145
    v_mul_f32 v133, v133, v141
    v_add_f32 v146, 1.0, v146
    v_fma_f32 v135, -v152, v55, v39
    v_exp_f32 v149, v149
    v_fma_f32 v143, -v152, v63, v47
    v_mul_f32 v150, v134, v153
    v_rcp_f32 v146, v146
    v_mul_f32 v134, v134, v142
    v_add_f32 v147, 1.0, v147
    v_mul_f32 v136, v128, v144
    v_exp_f32 v150, v150
    v_mul_f32 v151, v135, v153
    v_rcp_f32 v147, v147
    v_mul_f32 v135, v135, v143
    v_add_f32 v148, 1.0, v148
    v_mul_f32 v137, v129, v145
    v_exp_f32 v151, v151
    v_rcp_f32 v148, v148
    v_add_f32 v149, 1.0, v149
    v_mul_f32 v138, v130, v146
    v_cvt_pk_bf16_f32 v156, v136, v137
    v_rcp_f32 v149, v149
    v_add_f32 v150, 1.0, v150
    v_mul_f32 v139, v131, v147
    v_rcp_f32 v150, v150
    v_add_f32 v151, 1.0, v151
    v_mul_f32 v140, v132, v148
    v_cvt_pk_bf16_f32 v157, v138, v139
    v_rcp_f32 v151, v151
    v_mul_f32 v141, v133, v149
    v_mul_f32 v142, v134, v150
    v_cvt_pk_bf16_f32 v158, v140, v141
    v_mul_f32 v143, v135, v151
    v_cvt_pk_bf16_f32 v159, v142, v143
    s_add_u32 s82, s79, 114688
    buffer_store_dwordx4 v[156:159], v1, s[8:11], s82 offen sc0 sc1
    ds_read_b128 v[84:87], v7 offset:33792
    s_waitcnt lgkmcnt(4)
    v_mfma_f32_32x32x16_bf16 v[32:47], a[224:227], v[64:67], 0
    s_add_u32 s95, s94, 16384
    buffer_load_dwordx4 a[72:75], v1, s[8:11], s95 offen offset:2048
    ds_read_b64 v[152:153], v5 offset:1024
    ds_read_b128 v[88:91], v7 offset:34816
    v_mfma_f32_32x32x16_bf16 v[32:47], a[228:231], v[68:71], v[32:47]
    buffer_load_dwordx4 a[76:79], v1, s[8:11], s95 offen offset:3072
    ds_read_b128 v[64:67], v7 offset:35840
    s_waitcnt lgkmcnt(5)
    v_mfma_f32_32x32x16_bf16 v[32:47], a[232:235], v[72:75], v[32:47]
    s_waitcnt lgkmcnt(2)
    v_fma_f32 v128, -v152, v48, v16
    v_fma_f32 v136, -v152, v56, v24
    v_fma_f32 v129, -v152, v49, v17
    ds_read_b128 v[68:71], v7 offset:36864
    v_mfma_f32_32x32x16_bf16 v[32:47], a[236:239], v[76:79], v[32:47]
    s_add_u32 s95, s94, 20480
    buffer_load_dwordx4 a[80:83], v1, s[8:11], s95 offen offset:0
    ds_read_b128 v[72:75], v7 offset:37888
    v_mfma_f32_32x32x16_bf16 v[32:47], a[240:243], v[80:83], v[32:47]
    buffer_load_dwordx4 a[84:87], v1, s[8:11], s95 offen offset:1024
    ds_read_b128 v[76:79], v7 offset:38912
    v_mfma_f32_32x32x16_bf16 v[32:47], a[244:247], v[84:87], v[32:47]
    v_fma_f32 v137, -v152, v57, v25
    v_mul_f32 v144, v128, v153
    v_mul_f32 v128, v128, v136
    ds_read_b128 v[80:83], v7 offset:39936
    s_waitcnt lgkmcnt(4)
    v_mfma_f32_32x32x16_bf16 v[32:47], a[248:251], v[88:91], v[32:47]
    buffer_load_dwordx4 a[88:91], v1, s[8:11], s95 offen offset:2048
    ds_read_b128 v[84:87], v7 offset:40960
    v_mfma_f32_32x32x16_bf16 v[32:47], a[252:255], v[64:67], v[32:47]
    buffer_load_dwordx4 a[92:95], v1, s[8:11], s95 offen offset:3072
    ds_read_b128 v[88:91], v7 offset:41984
    s_waitcnt lgkmcnt(4)
    v_mfma_f32_32x32x16_bf16 v[32:47], v[176:179], v[68:71], v[32:47]
    v_fma_f32 v130, -v152, v50, v18
    v_exp_f32 v144, v144
    v_fma_f32 v138, -v152, v58, v26
    ds_read_b128 v[64:67], v7 offset:43008
    v_mfma_f32_32x32x16_bf16 v[32:47], v[180:183], v[72:75], v[32:47]
    s_add_u32 s95, s94, 24576
    buffer_load_dwordx4 a[96:99], v1, s[8:11], s95 offen offset:0
    ds_read_b128 v[68:71], v7 offset:44032
    s_waitcnt lgkmcnt(4)
    v_mfma_f32_32x32x16_bf16 v[32:47], v[184:187], v[76:79], v[32:47]
    buffer_load_dwordx4 a[100:103], v1, s[8:11], s95 offen offset:1024
    ds_read_b128 v[72:75], v7 offset:45056
    v_mfma_f32_32x32x16_bf16 v[32:47], v[188:191], v[80:83], v[32:47]
    v_mul_f32 v145, v129, v153
    v_mul_f32 v129, v129, v137
    v_fma_f32 v131, -v152, v51, v19
    ds_read_b128 v[76:79], v7 offset:46080
    s_waitcnt lgkmcnt(4)
    v_mfma_f32_32x32x16_bf16 v[32:47], v[192:195], v[84:87], v[32:47]
    buffer_load_dwordx4 a[104:107], v1, s[8:11], s95 offen offset:2048
    ds_read_b128 v[80:83], v7 offset:47104
    v_mfma_f32_32x32x16_bf16 v[32:47], v[196:199], v[88:91], v[32:47]
    v_exp_f32 v145, v145
    v_fma_f32 v139, -v152, v59, v27
    ds_read_b128 v[84:87], v7 offset:48128
    s_waitcnt lgkmcnt(4)
    v_mfma_f32_32x32x16_bf16 v[32:47], v[200:203], v[64:67], v[32:47]
    s_add_u32 s83, s85, 143360
    s_add_u32 m0, s84, 28672
    s_nop 0
    buffer_load_dwordx4 v1, s[8:11], s83 offen offset:0 lds
    ds_read_b128 v[88:91], v7 offset:49152
    v_mfma_f32_32x32x16_bf16 v[32:47], v[204:207], v[68:71], v[32:47]
    v_mul_f32 v146, v130, v153
    v_mul_f32 v130, v130, v138
    v_fma_f32 v132, -v152, v52, v20
    ds_read_b128 v[64:67], v7 offset:50176
    s_waitcnt lgkmcnt(4)
    v_mfma_f32_32x32x16_bf16 v[32:47], v[208:211], v[72:75], v[32:47]
    s_add_u32 m0, s84, 28672
    s_nop 0
    buffer_load_dwordx4 v1, s[8:11], s83 offen offset:1024 lds
    ds_read_b128 v[68:71], v7 offset:51200
    v_mfma_f32_32x32x16_bf16 v[32:47], v[212:215], v[76:79], v[32:47]
    v_exp_f32 v146, v146
    v_fma_f32 v140, -v152, v60, v28
    ds_read_b128 v[72:75], v7 offset:52224
    s_waitcnt lgkmcnt(4)
    v_mfma_f32_32x32x16_bf16 v[32:47], v[216:219], v[80:83], v[32:47]
    s_add_u32 m0, s84, 28672
    s_nop 0
    buffer_load_dwordx4 v1, s[8:11], s83 offen offset:2048 lds
    v_mul_f32 v147, v131, v153
    ds_read_b128 v[76:79], v7 offset:53248
    v_mfma_f32_32x32x16_bf16 v[32:47], v[220:223], v[84:87], v[32:47]
    v_mul_f32 v131, v131, v139
    v_add_f32 v144, 1.0, v144
    v_fma_f32 v133, -v152, v53, v21
    ds_read_b128 v[80:83], v7 offset:54272
    s_waitcnt lgkmcnt(4)
    v_mfma_f32_32x32x16_bf16 v[32:47], v[224:227], v[88:91], v[32:47]
    s_add_u32 m0, s84, 28672
    s_nop 0
    buffer_load_dwordx4 v1, s[8:11], s83 offen offset:3072 lds
    s_waitcnt vmcnt(13)
    buffer_store_dwordx2 v[10:11], v8, s[8:11], 0 offen offset:896 sc0 sc1
    ds_read_b128 v[84:87], v7 offset:55296
    v_mfma_f32_32x32x16_bf16 v[32:47], v[228:231], v[64:67], v[32:47]
    s_barrier
    v_exp_f32 v147, v147
    ds_read_b128 v[88:91], v7 offset:56320
    s_waitcnt lgkmcnt(4)
    v_mfma_f32_32x32x16_bf16 v[32:47], v[232:235], v[68:71], v[32:47]
    s_add_u32 s83, s83, 4096
    s_add_u32 m0, s84, 32768
    s_nop 0
    buffer_load_dwordx4 v1, s[8:11], s83 offen offset:0 lds
    ds_read_b128 v[64:67], v2 offset:0
    v_mfma_f32_32x32x16_bf16 v[32:47], v[236:239], v[72:75], v[32:47]
    v_fma_f32 v141, -v152, v61, v29
    v_mul_f32 v148, v132, v153
    ds_read_b128 v[68:71], v2 offset:1024
    s_waitcnt lgkmcnt(4)
    v_mfma_f32_32x32x16_bf16 v[32:47], v[240:243], v[76:79], v[32:47]
    s_add_u32 m0, s84, 32768
    s_nop 0
    buffer_load_dwordx4 v1, s[8:11], s83 offen offset:1024 lds
    ds_read_b128 v[72:75], v2 offset:2048
    v_mfma_f32_32x32x16_bf16 v[32:47], v[244:247], v[80:83], v[32:47]
    v_rcp_f32 v144, v144
    v_mul_f32 v132, v132, v140
    ds_read_b128 v[76:79], v2 offset:3072
    s_waitcnt lgkmcnt(4)
    v_mfma_f32_32x32x16_bf16 v[32:47], v[248:251], v[84:87], v[32:47]
    s_add_u32 m0, s84, 32768
    s_nop 0
    buffer_load_dwordx4 v1, s[8:11], s83 offen offset:2048 lds
    v_add_f32 v145, 1.0, v145
    ds_read_b128 v[80:83], v2 offset:4096
    v_mfma_f32_32x32x16_bf16 v[32:47], v[252:255], v[88:91], v[32:47]
    v_fma_f32 v134, -v152, v54, v22
    v_exp_f32 v148, v148
    v_fma_f32 v142, -v152, v62, v30
    v_mul_f32 v149, v133, v153
    v_rcp_f32 v145, v145
    v_mul_f32 v133, v133, v141
    v_add_f32 v146, 1.0, v146
    v_fma_f32 v135, -v152, v55, v23
    v_exp_f32 v149, v149
    v_fma_f32 v143, -v152, v63, v31
    v_mul_f32 v150, v134, v153
    v_rcp_f32 v146, v146
    v_mul_f32 v134, v134, v142
    v_add_f32 v147, 1.0, v147
    v_mul_f32 v136, v128, v144
    v_exp_f32 v150, v150
    v_mul_f32 v151, v135, v153
    v_rcp_f32 v147, v147
    v_mul_f32 v135, v135, v143
    v_add_f32 v148, 1.0, v148
    v_mul_f32 v137, v129, v145
    v_exp_f32 v151, v151
    v_rcp_f32 v148, v148
    v_add_f32 v149, 1.0, v149
    v_mul_f32 v138, v130, v146
    v_cvt_pk_bf16_f32 v156, v136, v137
    v_rcp_f32 v149, v149
    v_add_f32 v150, 1.0, v150
    v_mul_f32 v139, v131, v147
    v_rcp_f32 v150, v150
    v_add_f32 v151, 1.0, v151
    v_mul_f32 v140, v132, v148
    v_cvt_pk_bf16_f32 v157, v138, v139
    v_rcp_f32 v151, v151
    v_mul_f32 v141, v133, v149
    v_mul_f32 v142, v134, v150
    v_cvt_pk_bf16_f32 v158, v140, v141
    v_mul_f32 v143, v135, v151
    v_cvt_pk_bf16_f32 v159, v142, v143
    s_add_u32 s82, s79, 229376
    buffer_store_dwordx4 v[156:159], v1, s[8:11], s82 offen sc0 sc1
    ds_read_b128 v[84:87], v2 offset:5120
    s_waitcnt lgkmcnt(4)
    v_mfma_f32_32x32x16_bf16 v[16:31], a[224:227], v[64:67], 0
    s_add_u32 s95, s94, 24576
    buffer_load_dwordx4 a[108:111], v1, s[8:11], s95 offen offset:3072
    ds_read_b64 v[152:153], v5 offset:1536
    ds_read_b128 v[88:91], v2 offset:6144
    v_mfma_f32_32x32x16_bf16 v[16:31], a[228:231], v[68:71], v[16:31]
    s_add_u32 s95, s94, 28672
    buffer_load_dwordx4 a[112:115], v1, s[8:11], s95 offen offset:0
    ds_read_b128 v[64:67], v2 offset:7168
    s_waitcnt lgkmcnt(5)
    v_mfma_f32_32x32x16_bf16 v[16:31], a[232:235], v[72:75], v[16:31]
    s_waitcnt lgkmcnt(2)
    v_fma_f32 v128, -v152, v48, v32
    v_fma_f32 v136, -v152, v56, v40
    v_fma_f32 v129, -v152, v49, v33
    ds_read_b128 v[68:71], v2 offset:8192
    v_mfma_f32_32x32x16_bf16 v[16:31], a[236:239], v[76:79], v[16:31]
    buffer_load_dwordx4 a[116:119], v1, s[8:11], s95 offen offset:1024
    ds_read_b128 v[72:75], v2 offset:9216
    v_mfma_f32_32x32x16_bf16 v[16:31], a[240:243], v[80:83], v[16:31]
    buffer_load_dwordx4 a[120:123], v1, s[8:11], s95 offen offset:2048
    ds_read_b128 v[76:79], v2 offset:10240
    v_mfma_f32_32x32x16_bf16 v[16:31], a[244:247], v[84:87], v[16:31]
    v_fma_f32 v137, -v152, v57, v41
    v_mul_f32 v144, v128, v153
    v_mul_f32 v128, v128, v136
    ds_read_b128 v[80:83], v2 offset:11264
    s_waitcnt lgkmcnt(4)
    v_mfma_f32_32x32x16_bf16 v[16:31], a[248:251], v[88:91], v[16:31]
    buffer_load_dwordx4 a[124:127], v1, s[8:11], s95 offen offset:3072
    ds_read_b128 v[84:87], v2 offset:12288
    v_mfma_f32_32x32x16_bf16 v[16:31], a[252:255], v[64:67], v[16:31]
    s_add_u32 s95, s94, 32768
    buffer_load_dwordx4 a[128:131], v1, s[8:11], s95 offen offset:0
    ds_read_b128 v[88:91], v2 offset:13312
    s_waitcnt lgkmcnt(4)
    v_mfma_f32_32x32x16_bf16 v[16:31], v[176:179], v[68:71], v[16:31]
    v_fma_f32 v130, -v152, v50, v34
    v_exp_f32 v144, v144
    v_fma_f32 v138, -v152, v58, v42
    ds_read_b128 v[64:67], v2 offset:14336
    v_mfma_f32_32x32x16_bf16 v[16:31], v[180:183], v[72:75], v[16:31]
    buffer_load_dwordx4 a[132:135], v1, s[8:11], s95 offen offset:1024
    ds_read_b128 v[68:71], v2 offset:15360
    s_waitcnt lgkmcnt(4)
    v_mfma_f32_32x32x16_bf16 v[16:31], v[184:187], v[76:79], v[16:31]
    buffer_load_dwordx4 a[136:139], v1, s[8:11], s95 offen offset:2048
    ds_read_b128 v[72:75], v2 offset:16384
    v_mfma_f32_32x32x16_bf16 v[16:31], v[188:191], v[80:83], v[16:31]
    v_mul_f32 v145, v129, v153
    v_mul_f32 v129, v129, v137
    v_fma_f32 v131, -v152, v51, v35
    ds_read_b128 v[76:79], v2 offset:17408
    s_waitcnt lgkmcnt(4)
    v_mfma_f32_32x32x16_bf16 v[16:31], v[192:195], v[84:87], v[16:31]
    buffer_load_dwordx4 a[140:143], v1, s[8:11], s95 offen offset:3072
    ds_read_b128 v[80:83], v2 offset:18432
    v_mfma_f32_32x32x16_bf16 v[16:31], v[196:199], v[88:91], v[16:31]
    v_exp_f32 v145, v145
    v_fma_f32 v139, -v152, v59, v43
    ds_read_b128 v[84:87], v2 offset:19456
    s_waitcnt lgkmcnt(4)
    v_mfma_f32_32x32x16_bf16 v[16:31], v[200:203], v[64:67], v[16:31]
    s_add_u32 s83, s85, 172032
    s_add_u32 m0, s84, 57344
    s_nop 0
    buffer_load_dwordx4 v1, s[8:11], s83 offen offset:0 lds
    ds_read_b128 v[88:91], v2 offset:20480
    v_mfma_f32_32x32x16_bf16 v[16:31], v[204:207], v[68:71], v[16:31]
    v_mul_f32 v146, v130, v153
    v_mul_f32 v130, v130, v138
    v_fma_f32 v132, -v152, v52, v36
    ds_read_b128 v[64:67], v2 offset:21504
    s_waitcnt lgkmcnt(4)
    v_mfma_f32_32x32x16_bf16 v[16:31], v[208:211], v[72:75], v[16:31]
    s_add_u32 m0, s84, 57344
    s_nop 0
    buffer_load_dwordx4 v1, s[8:11], s83 offen offset:1024 lds
    ds_read_b128 v[68:71], v2 offset:22528
    v_mfma_f32_32x32x16_bf16 v[16:31], v[212:215], v[76:79], v[16:31]
    v_exp_f32 v146, v146
    v_fma_f32 v140, -v152, v60, v44
    ds_read_b128 v[72:75], v2 offset:23552
    s_waitcnt lgkmcnt(4)
    v_mfma_f32_32x32x16_bf16 v[16:31], v[216:219], v[80:83], v[16:31]
    s_add_u32 m0, s84, 57344
    s_nop 0
    buffer_load_dwordx4 v1, s[8:11], s83 offen offset:2048 lds
    v_mul_f32 v147, v131, v153
    ds_read_b128 v[76:79], v2 offset:24576
    v_mfma_f32_32x32x16_bf16 v[16:31], v[220:223], v[84:87], v[16:31]
    v_mul_f32 v131, v131, v139
    v_add_f32 v144, 1.0, v144
    v_fma_f32 v133, -v152, v53, v37
    ds_read_b128 v[80:83], v2 offset:25600
    s_waitcnt lgkmcnt(4)
    v_mfma_f32_32x32x16_bf16 v[16:31], v[224:227], v[88:91], v[16:31]
    s_add_u32 m0, s84, 57344
    s_nop 0
    buffer_load_dwordx4 v1, s[8:11], s83 offen offset:3072 lds
    s_waitcnt vmcnt(13)
    buffer_store_dwordx2 v[10:11], v8, s[8:11], 0 offen offset:1792 sc0 sc1
    ds_read_b128 v[84:87], v2 offset:26624
    v_mfma_f32_32x32x16_bf16 v[16:31], v[228:231], v[64:67], v[16:31]
    s_barrier
    v_exp_f32 v147, v147
    ds_read_b128 v[88:91], v2 offset:27648
    s_waitcnt lgkmcnt(4)
    v_mfma_f32_32x32x16_bf16 v[16:31], v[232:235], v[68:71], v[16:31]
    s_add_u32 s83, s83, 4096
    s_add_u32 m0, s84, 61440
    s_nop 0
    buffer_load_dwordx4 v1, s[8:11], s83 offen offset:0 lds
    ds_read_b128 v[64:67], v2 offset:28672
    v_mfma_f32_32x32x16_bf16 v[16:31], v[236:239], v[72:75], v[16:31]
    v_fma_f32 v141, -v152, v61, v45
    v_mul_f32 v148, v132, v153
    ds_read_b128 v[68:71], v2 offset:29696
    s_waitcnt lgkmcnt(4)
    v_mfma_f32_32x32x16_bf16 v[16:31], v[240:243], v[76:79], v[16:31]
    s_add_u32 m0, s84, 61440
    s_nop 0
    buffer_load_dwordx4 v1, s[8:11], s83 offen offset:1024 lds
    ds_read_b128 v[72:75], v2 offset:30720
    v_mfma_f32_32x32x16_bf16 v[16:31], v[244:247], v[80:83], v[16:31]
    v_rcp_f32 v144, v144
    v_mul_f32 v132, v132, v140
    ds_read_b128 v[76:79], v2 offset:31744
    s_waitcnt lgkmcnt(4)
    v_mfma_f32_32x32x16_bf16 v[16:31], v[248:251], v[84:87], v[16:31]
    s_add_u32 m0, s84, 61440
    s_nop 0
    buffer_load_dwordx4 v1, s[8:11], s83 offen offset:2048 lds
    v_add_f32 v145, 1.0, v145
    ds_read_b128 v[80:83], v2 offset:32768
    v_mfma_f32_32x32x16_bf16 v[16:31], v[252:255], v[88:91], v[16:31]
    v_fma_f32 v134, -v152, v54, v38
    v_exp_f32 v148, v148
    v_fma_f32 v142, -v152, v62, v46
    v_mul_f32 v149, v133, v153
    v_rcp_f32 v145, v145
    v_mul_f32 v133, v133, v141
    v_add_f32 v146, 1.0, v146
    v_fma_f32 v135, -v152, v55, v39
    v_exp_f32 v149, v149
    v_fma_f32 v143, -v152, v63, v47
    v_mul_f32 v150, v134, v153
    v_rcp_f32 v146, v146
    v_mul_f32 v134, v134, v142
    v_add_f32 v147, 1.0, v147
    v_mul_f32 v136, v128, v144
    v_exp_f32 v150, v150
    v_mul_f32 v151, v135, v153
    v_rcp_f32 v147, v147
    v_mul_f32 v135, v135, v143
    v_add_f32 v148, 1.0, v148
    v_mul_f32 v137, v129, v145
    v_exp_f32 v151, v151
    v_rcp_f32 v148, v148
    v_add_f32 v149, 1.0, v149
    v_mul_f32 v138, v130, v146
    v_cvt_pk_bf16_f32 v156, v136, v137
    v_rcp_f32 v149, v149
    v_add_f32 v150, 1.0, v150
    v_mul_f32 v139, v131, v147
    v_rcp_f32 v150, v150
    v_add_f32 v151, 1.0, v151
    v_mul_f32 v140, v132, v148
    v_cvt_pk_bf16_f32 v157, v138, v139
    v_rcp_f32 v151, v151
    v_mul_f32 v141, v133, v149
    v_mul_f32 v142, v134, v150
    v_cvt_pk_bf16_f32 v158, v140, v141
    v_mul_f32 v143, v135, v151
    v_cvt_pk_bf16_f32 v159, v142, v143
    s_add_u32 s82, s79, 344064
    buffer_store_dwordx4 v[156:159], v1, s[8:11], s82 offen sc0 sc1
    ds_read_b128 v[84:87], v2 offset:33792
    s_waitcnt lgkmcnt(4)
    v_mfma_f32_32x32x16_bf16 v[32:47], a[224:227], v[64:67], 0
    s_add_u32 s95, s94, 36864
    buffer_load_dwordx4 a[144:147], v1, s[8:11], s95 offen offset:0
    ds_read_b64 v[152:153], v5 offset:2048
    ds_read_b128 v[88:91], v2 offset:34816
    v_mfma_f32_32x32x16_bf16 v[32:47], a[228:231], v[68:71], v[32:47]
    buffer_load_dwordx4 a[148:151], v1, s[8:11], s95 offen offset:1024
    ds_read_b128 v[64:67], v2 offset:35840
    s_waitcnt lgkmcnt(5)
    v_mfma_f32_32x32x16_bf16 v[32:47], a[232:235], v[72:75], v[32:47]
    buffer_load_dwordx4 a[152:155], v1, s[8:11], s95 offen offset:2048
    ds_read_b128 v[68:71], v2 offset:36864
    v_mfma_f32_32x32x16_bf16 v[32:47], a[236:239], v[76:79], v[32:47]
    s_waitcnt lgkmcnt(3)
    v_fma_f32 v128, -v152, v48, v16
    v_fma_f32 v136, -v152, v56, v24
    ds_read_b128 v[72:75], v2 offset:37888
    v_mfma_f32_32x32x16_bf16 v[32:47], a[240:243], v[80:83], v[32:47]
    buffer_load_dwordx4 a[156:159], v1, s[8:11], s95 offen offset:3072
    ds_read_b128 v[76:79], v2 offset:38912
    v_mfma_f32_32x32x16_bf16 v[32:47], a[244:247], v[84:87], v[32:47]
    s_add_u32 s95, s94, 40960
    buffer_load_dwordx4 a[160:163], v1, s[8:11], s95 offen offset:0
    ds_read_b128 v[80:83], v2 offset:39936
    s_waitcnt lgkmcnt(4)
    v_mfma_f32_32x32x16_bf16 v[32:47], a[248:251], v[88:91], v[32:47]
    v_fma_f32 v129, -v152, v49, v17
    v_fma_f32 v137, -v152, v57, v25
    v_mul_f32 v144, v128, v153
    v_mul_f32 v128, v128, v136
    ds_read_b128 v[84:87], v2 offset:40960
    v_mfma_f32_32x32x16_bf16 v[32:47], a[252:255], v[64:67], v[32:47]
    buffer_load_dwordx4 a[164:167], v1, s[8:11], s95 offen offset:1024
    ds_read_b128 v[88:91], v2 offset:41984
    s_waitcnt lgkmcnt(4)
    v_mfma_f32_32x32x16_bf16 v[32:47], v[176:179], v[68:71], v[32:47]
    buffer_load_dwordx4 a[168:171], v1, s[8:11], s95 offen offset:2048
    ds_read_b128 v[64:67], v2 offset:43008
    v_mfma_f32_32x32x16_bf16 v[32:47], v[180:183], v[72:75], v[32:47]
    buffer_load_dwordx4 a[172:175], v1, s[8:11], s95 offen offset:3072
    ds_read_b128 v[68:71], v2 offset:44032
    s_waitcnt lgkmcnt(4)
    v_mfma_f32_32x32x16_bf16 v[32:47], v[184:187], v[76:79], v[32:47]
    v_fma_f32 v130, -v152, v50, v18
    v_exp_f32 v144, v144
    v_fma_f32 v138, -v152, v58, v26
    ds_read_b128 v[72:75], v2 offset:45056
    v_mfma_f32_32x32x16_bf16 v[32:47], v[188:191], v[80:83], v[32:47]
    s_add_u32 s95, s94, 45056
    buffer_load_dwordx4 a[176:179], v1, s[8:11], s95 offen offset:0
    ds_read_b128 v[76:79], v2 offset:46080
    s_waitcnt lgkmcnt(4)
    v_mfma_f32_32x32x16_bf16 v[32:47], v[192:195], v[84:87], v[32:47]
    buffer_load_dwordx4 a[180:183], v1, s[8:11], s95 offen offset:1024
    ds_read_b128 v[80:83], v2 offset:47104
    v_mfma_f32_32x32x16_bf16 v[32:47], v[196:199], v[88:91], v[32:47]
    v_mul_f32 v145, v129, v153
    v_mul_f32 v129, v129, v137
    v_fma_f32 v131, -v152, v51, v19
    ds_read_b128 v[84:87], v2 offset:48128
    s_waitcnt lgkmcnt(4)
    v_mfma_f32_32x32x16_bf16 v[32:47], v[200:203], v[64:67], v[32:47]
    s_add_u32 s83, s85, 200704
    s_add_u32 m0, s84, 86016
    s_nop 0
    buffer_load_dwordx4 v1, s[8:11], s83 offen offset:0 lds
    ds_read_b128 v[88:91], v2 offset:49152
    v_mfma_f32_32x32x16_bf16 v[32:47], v[204:207], v[68:71], v[32:47]
    v_exp_f32 v145, v145
    v_fma_f32 v139, -v152, v59, v27
    ds_read_b128 v[64:67], v2 offset:50176
    s_waitcnt lgkmcnt(4)
    v_mfma_f32_32x32x16_bf16 v[32:47], v[208:211], v[72:75], v[32:47]
    s_add_u32 m0, s84, 86016
    s_nop 0
    buffer_load_dwordx4 v1, s[8:11], s83 offen offset:1024 lds
    v_mul_f32 v146, v130, v153
    ds_read_b128 v[68:71], v2 offset:51200
    v_mfma_f32_32x32x16_bf16 v[32:47], v[212:215], v[76:79], v[32:47]
    v_mul_f32 v130, v130, v138
    v_fma_f32 v132, -v152, v52, v20
    ds_read_b128 v[72:75], v2 offset:52224
    s_waitcnt lgkmcnt(4)
    v_mfma_f32_32x32x16_bf16 v[32:47], v[216:219], v[80:83], v[32:47]
    s_add_u32 m0, s84, 86016
    s_nop 0
    buffer_load_dwordx4 v1, s[8:11], s83 offen offset:2048 lds
    ds_read_b128 v[76:79], v2 offset:53248
    v_mfma_f32_32x32x16_bf16 v[32:47], v[220:223], v[84:87], v[32:47]
    v_exp_f32 v146, v146
    v_fma_f32 v140, -v152, v60, v28
    ds_read_b128 v[80:83], v2 offset:54272
    s_waitcnt lgkmcnt(4)
    v_mfma_f32_32x32x16_bf16 v[32:47], v[224:227], v[88:91], v[32:47]
    s_add_u32 m0, s84, 86016
    s_nop 0
    buffer_load_dwordx4 v1, s[8:11], s83 offen offset:3072 lds
    s_waitcnt vmcnt(14)
    buffer_store_dwordx2 v[10:11], v8, s[8:11], 0 offen offset:2688 sc0 sc1
    ds_read_b128 v[84:87], v2 offset:55296
    v_mfma_f32_32x32x16_bf16 v[32:47], v[228:231], v[64:67], v[32:47]
    s_barrier
    v_mul_f32 v147, v131, v153
    v_mul_f32 v131, v131, v139
    ds_read_b128 v[88:91], v2 offset:56320
    s_waitcnt lgkmcnt(4)
    v_mfma_f32_32x32x16_bf16 v[32:47], v[232:235], v[68:71], v[32:47]
    s_add_u32 s83, s83, 4096
    s_add_u32 m0, s84, 90112
    s_nop 0
    buffer_load_dwordx4 v1, s[8:11], s83 offen offset:0 lds
    ds_read_b128 v[64:67], v7 offset:0
    v_mfma_f32_32x32x16_bf16 v[32:47], v[236:239], v[72:75], v[32:47]
    v_add_f32 v144, 1.0, v144
    v_fma_f32 v133, -v152, v53, v21
    ds_read_b128 v[68:71], v7 offset:1024
    s_waitcnt lgkmcnt(4)
    v_mfma_f32_32x32x16_bf16 v[32:47], v[240:243], v[76:79], v[32:47]
    s_add_u32 m0, s84, 90112
    s_nop 0
    buffer_load_dwordx4 v1, s[8:11], s83 offen offset:1024 lds
    ds_read_b128 v[72:75], v7 offset:2048
    v_mfma_f32_32x32x16_bf16 v[32:47], v[244:247], v[80:83], v[32:47]
    v_exp_f32 v147, v147
    v_fma_f32 v141, -v152, v61, v29
    ds_read_b128 v[76:79], v7 offset:3072
    s_waitcnt lgkmcnt(4)
    v_mfma_f32_32x32x16_bf16 v[32:47], v[248:251], v[84:87], v[32:47]
    s_add_u32 m0, s84, 90112
    s_nop 0
    buffer_load_dwordx4 v1, s[8:11], s83 offen offset:2048 lds
    v_mul_f32 v148, v132, v153
    ds_read_b128 v[80:83], v7 offset:4096
    v_mfma_f32_32x32x16_bf16 v[32:47], v[252:255], v[88:91], v[32:47]
    v_rcp_f32 v144, v144
    v_mul_f32 v132, v132, v140
    v_add_f32 v145, 1.0, v145
    v_fma_f32 v134, -v152, v54, v22
    v_exp_f32 v148, v148
    v_fma_f32 v142, -v152, v62, v30
    v_mul_f32 v149, v133, v153
    v_rcp_f32 v145, v145
    v_mul_f32 v133, v133, v141
    v_add_f32 v146, 1.0, v146
    v_fma_f32 v135, -v152, v55, v23
    v_exp_f32 v149, v149
    v_fma_f32 v143, -v152, v63, v31
    v_mul_f32 v150, v134, v153
    v_rcp_f32 v146, v146
    v_mul_f32 v134, v134, v142
    v_add_f32 v147, 1.0, v147
    v_mul_f32 v136, v128, v144
    v_exp_f32 v150, v150
    v_mul_f32 v151, v135, v153
    v_rcp_f32 v147, v147
    v_mul_f32 v135, v135, v143
    v_add_f32 v148, 1.0, v148
    v_mul_f32 v137, v129, v145
    v_exp_f32 v151, v151
    v_rcp_f32 v148, v148
    v_add_f32 v149, 1.0, v149
    v_mul_f32 v138, v130, v146
    v_cvt_pk_bf16_f32 v156, v136, v137
    v_rcp_f32 v149, v149
    v_add_f32 v150, 1.0, v150
    v_mul_f32 v139, v131, v147
    v_rcp_f32 v150, v150
    v_add_f32 v151, 1.0, v151
    v_mul_f32 v140, v132, v148
    v_cvt_pk_bf16_f32 v157, v138, v139
    v_rcp_f32 v151, v151
    v_mul_f32 v141, v133, v149
    v_mul_f32 v142, v134, v150
    v_cvt_pk_bf16_f32 v158, v140, v141
    v_mul_f32 v143, v135, v151
    v_cvt_pk_bf16_f32 v159, v142, v143
    s_add_u32 s82, s79, 458752
    buffer_store_dwordx4 v[156:159], v1, s[8:11], s82 offen sc0 sc1
    ds_read_b128 v[84:87], v7 offset:5120
    s_waitcnt lgkmcnt(4)
    v_mfma_f32_32x32x16_bf16 v[16:31], a[224:227], v[64:67], 0
    s_add_u32 s95, s94, 45056
    buffer_load_dwordx4 a[184:187], v1, s[8:11], s95 offen offset:2048
    ds_read_b64 v[152:153], v5 offset:2560
    ds_read_b128 v[88:91], v7 offset:6144
    v_mfma_f32_32x32x16_bf16 v[16:31], a[228:231], v[68:71], v[16:31]
    buffer_load_dwordx4 a[188:191], v1, s[8:11], s95 offen offset:3072
    ds_read_b128 v[64:67], v7 offset:7168
    s_waitcnt lgkmcnt(5)
    v_mfma_f32_32x32x16_bf16 v[16:31], a[232:235], v[72:75], v[16:31]
    s_add_u32 s95, s94, 49152
    buffer_load_dwordx4 a[192:195], v1, s[8:11], s95 offen offset:0
    ds_read_b128 v[68:71], v7 offset:8192
    v_mfma_f32_32x32x16_bf16 v[16:31], a[236:239], v[76:79], v[16:31]
    s_waitcnt lgkmcnt(3)
    v_fma_f32 v128, -v152, v48, v32
    v_fma_f32 v136, -v152, v56, v40
    ds_read_b128 v[72:75], v7 offset:9216
    v_mfma_f32_32x32x16_bf16 v[16:31], a[240:243], v[80:83], v[16:31]
    buffer_load_dwordx4 a[196:199], v1, s[8:11], s95 offen offset:1024
    ds_read_b128 v[76:79], v7 offset:10240
    v_mfma_f32_32x32x16_bf16 v[16:31], a[244:247], v[84:87], v[16:31]
    buffer_load_dwordx4 a[200:203], v1, s[8:11], s95 offen offset:2048
    ds_read_b128 v[80:83], v7 offset:11264
    s_waitcnt lgkmcnt(4)
    v_mfma_f32_32x32x16_bf16 v[16:31], a[248:251], v[88:91], v[16:31]
    v_fma_f32 v129, -v152, v49, v33
    v_fma_f32 v137, -v152, v57, v41
    v_mul_f32 v144, v128, v153
    v_mul_f32 v128, v128, v136
    ds_read_b128 v[84:87], v7 offset:12288
    v_mfma_f32_32x32x16_bf16 v[16:31], a[252:255], v[64:67], v[16:31]
    buffer_load_dwordx4 a[204:207], v1, s[8:11], s95 offen offset:3072
    ds_read_b128 v[88:91], v7 offset:13312
    s_waitcnt lgkmcnt(4)
    v_mfma_f32_32x32x16_bf16 v[16:31], v[176:179], v[68:71], v[16:31]
    s_add_u32 s95, s94, 53248
    buffer_load_dwordx4 a[208:211], v1, s[8:11], s95 offen offset:0
    ds_read_b128 v[64:67], v7 offset:14336
    v_mfma_f32_32x32x16_bf16 v[16:31], v[180:183], v[72:75], v[16:31]
    buffer_load_dwordx4 a[212:215], v1, s[8:11], s95 offen offset:1024
    ds_read_b128 v[68:71], v7 offset:15360
    s_waitcnt lgkmcnt(4)
    v_mfma_f32_32x32x16_bf16 v[16:31], v[184:187], v[76:79], v[16:31]
    v_fma_f32 v130, -v152, v50, v34
    v_exp_f32 v144, v144
    v_fma_f32 v138, -v152, v58, v42
    ds_read_b128 v[72:75], v7 offset:16384
    v_mfma_f32_32x32x16_bf16 v[16:31], v[188:191], v[80:83], v[16:31]
    buffer_load_dwordx4 a[216:219], v1, s[8:11], s95 offen offset:2048
    ds_read_b128 v[76:79], v7 offset:17408
    s_waitcnt lgkmcnt(4)
    v_mfma_f32_32x32x16_bf16 v[16:31], v[192:195], v[84:87], v[16:31]
    buffer_load_dwordx4 a[220:223], v1, s[8:11], s95 offen offset:3072
    ds_read_b128 v[80:83], v7 offset:18432
    v_mfma_f32_32x32x16_bf16 v[16:31], v[196:199], v[88:91], v[16:31]
    v_mul_f32 v145, v129, v153
    v_mul_f32 v129, v129, v137
    v_fma_f32 v131, -v152, v51, v35
    ds_read_b128 v[84:87], v7 offset:19456
    s_waitcnt lgkmcnt(4)
    v_mfma_f32_32x32x16_bf16 v[16:31], v[200:203], v[64:67], v[16:31]
    v_exp_f32 v145, v145
    v_fma_f32 v139, -v152, v59, v43
    v_mul_f32 v146, v130, v153
    ds_read_b128 v[88:91], v7 offset:20480
    v_mfma_f32_32x32x16_bf16 v[16:31], v[204:207], v[68:71], v[16:31]
    v_mul_f32 v130, v130, v138
    v_fma_f32 v132, -v152, v52, v36
    ds_read_b128 v[64:67], v7 offset:21504
    s_waitcnt lgkmcnt(4)
    v_mfma_f32_32x32x16_bf16 v[16:31], v[208:211], v[72:75], v[16:31]
    v_exp_f32 v146, v146
    v_fma_f32 v140, -v152, v60, v44
    v_mul_f32 v147, v131, v153
    ds_read_b128 v[68:71], v7 offset:22528
    v_mfma_f32_32x32x16_bf16 v[16:31], v[212:215], v[76:79], v[16:31]
    v_mul_f32 v131, v131, v139
    v_add_f32 v144, 1.0, v144
    v_fma_f32 v133, -v152, v53, v37
    ds_read_b128 v[72:75], v7 offset:23552
    s_waitcnt lgkmcnt(4)
    v_mfma_f32_32x32x16_bf16 v[16:31], v[216:219], v[80:83], v[16:31]
    v_exp_f32 v147, v147
    v_fma_f32 v141, -v152, v61, v45
    v_mul_f32 v148, v132, v153
    ds_read_b128 v[76:79], v7 offset:24576
    v_mfma_f32_32x32x16_bf16 v[16:31], v[220:223], v[84:87], v[16:31]
    v_rcp_f32 v144, v144
    v_mul_f32 v132, v132, v140
    ds_read_b128 v[80:83], v7 offset:25600
    s_waitcnt lgkmcnt(4)
    v_mfma_f32_32x32x16_bf16 v[16:31], v[224:227], v[88:91], v[16:31]
    s_waitcnt vmcnt(10)
    buffer_store_dwordx2 v[10:11], v9, s[8:11], 0 offen offset:0 sc0 sc1
    ds_read_b128 v[84:87], v7 offset:26624
    v_mfma_f32_32x32x16_bf16 v[16:31], v[228:231], v[64:67], v[16:31]
    s_barrier
    v_add_f32 v145, 1.0, v145
    v_fma_f32 v134, -v152, v54, v38
    ds_read_b128 v[88:91], v7 offset:27648
    s_waitcnt lgkmcnt(4)
    v_mfma_f32_32x32x16_bf16 v[16:31], v[232:235], v[68:71], v[16:31]
    v_exp_f32 v148, v148
    v_fma_f32 v142, -v152, v62, v46
    v_mul_f32 v149, v133, v153
    ds_read_b128 v[64:67], v7 offset:28672
    v_mfma_f32_32x32x16_bf16 v[16:31], v[236:239], v[72:75], v[16:31]
    v_rcp_f32 v145, v145
    v_mul_f32 v133, v133, v141
    ds_read_b128 v[68:71], v7 offset:29696
    s_waitcnt lgkmcnt(4)
    v_mfma_f32_32x32x16_bf16 v[16:31], v[240:243], v[76:79], v[16:31]
    v_add_f32 v146, 1.0, v146
    v_fma_f32 v135, -v152, v55, v39
    v_exp_f32 v149, v149
    ds_read_b128 v[72:75], v7 offset:30720
    v_mfma_f32_32x32x16_bf16 v[16:31], v[244:247], v[80:83], v[16:31]
    v_fma_f32 v143, -v152, v63, v47
    v_mul_f32 v150, v134, v153
    ds_read_b128 v[76:79], v7 offset:31744
    s_waitcnt lgkmcnt(4)
    v_mfma_f32_32x32x16_bf16 v[16:31], v[248:251], v[84:87], v[16:31]
    v_rcp_f32 v146, v146
    v_mul_f32 v134, v134, v142
    v_add_f32 v147, 1.0, v147
    ds_read_b128 v[80:83], v7 offset:32768
    v_mfma_f32_32x32x16_bf16 v[16:31], v[252:255], v[88:91], v[16:31]
    v_mul_f32 v136, v128, v144
    v_exp_f32 v150, v150
    v_mul_f32 v151, v135, v153
    v_rcp_f32 v147, v147
    v_mul_f32 v135, v135, v143
    v_add_f32 v148, 1.0, v148
    v_mul_f32 v137, v129, v145
    v_exp_f32 v151, v151
    v_rcp_f32 v148, v148
    v_add_f32 v149, 1.0, v149
    v_mul_f32 v138, v130, v146
    v_cvt_pk_bf16_f32 v156, v136, v137
    v_rcp_f32 v149, v149
    v_add_f32 v150, 1.0, v150
    v_mul_f32 v139, v131, v147
    v_rcp_f32 v150, v150
    v_add_f32 v151, 1.0, v151
    v_mul_f32 v140, v132, v148
    v_cvt_pk_bf16_f32 v157, v138, v139
    v_rcp_f32 v151, v151
    v_mul_f32 v141, v133, v149
    v_mul_f32 v142, v134, v150
    v_cvt_pk_bf16_f32 v158, v140, v141
    v_mul_f32 v143, v135, v151
    v_cvt_pk_bf16_f32 v159, v142, v143
    s_add_u32 s82, s79, 573440
    buffer_store_dwordx4 v[156:159], v1, s[8:11], s82 offen sc0 sc1
    ds_read_b128 v[84:87], v7 offset:33792
    s_waitcnt lgkmcnt(4)
    v_mfma_f32_32x32x16_bf16 v[32:47], a[224:227], v[64:67], 0
    ds_read_b64 v[152:153], v5 offset:3072
    ds_read_b128 v[88:91], v7 offset:34816
    v_mfma_f32_32x32x16_bf16 v[32:47], a[228:231], v[68:71], v[32:47]
    s_add_u32 s82, s76, s67
    s_mul_i32 s82, s82, 112
    s_mul_i32 s83, s36, 28
    s_add_u32 s82, s82, s83
    s_lshl_b32 s83, s82, 3
    s_add_u32 s83, s83, s74
    v_min_u32 v3, 27, v0
    v_lshlrev_b32 v3, 3, v3
    v_add_u32 v3, s83, v3
    s_lshl_b32 s94, s82, 10
    s_add_u32 s94, s94, s72
    buffer_load_dwordx2 v[168:169], v3, s[8:11], 0 offen sc1
    ds_read_b128 v[64:67], v7 offset:35840
    s_waitcnt lgkmcnt(5)
    v_mfma_f32_32x32x16_bf16 v[32:47], a[232:235], v[72:75], v[32:47]
    s_waitcnt lgkmcnt(2)
    v_fma_f32 v128, -v152, v48, v16
    v_fma_f32 v136, -v152, v56, v24
    v_fma_f32 v129, -v152, v49, v17
    ds_read_b128 v[68:71], v7 offset:36864
    v_mfma_f32_32x32x16_bf16 v[32:47], a[236:239], v[76:79], v[32:47]
    v_fma_f32 v137, -v152, v57, v25
    v_mul_f32 v144, v128, v153
    v_mul_f32 v128, v128, v136
    ds_read_b128 v[72:75], v7 offset:37888
    v_mfma_f32_32x32x16_bf16 v[32:47], a[240:243], v[80:83], v[32:47]
    v_fma_f32 v130, -v152, v50, v18
    v_exp_f32 v144, v144
    v_fma_f32 v138, -v152, v58, v26
    ds_read_b128 v[76:79], v7 offset:38912
    v_mfma_f32_32x32x16_bf16 v[32:47], a[244:247], v[84:87], v[32:47]
    v_mul_f32 v145, v129, v153
    v_mul_f32 v129, v129, v137
    v_fma_f32 v131, -v152, v51, v19
    s_add_u32 s82, s76, s67
    s_add_u32 s82, s82, 4
    s_mul_i32 s82, s82, 112
    s_mul_i32 s83, s36, 28
    s_add_u32 s82, s82, s83
    s_lshl_b32 s83, s82, 3
    s_add_u32 s83, s83, s74
    v_min_u32 v4, 27, v0
    v_lshlrev_b32 v4, 3, v4
    v_add_u32 v4, s83, v4
    s_lshl_b32 s95, s82, 10
    s_add_u32 s95, s95, s72
    ds_read_b128 v[80:83], v7 offset:39936
    s_waitcnt lgkmcnt(4)
    v_mfma_f32_32x32x16_bf16 v[32:47], a[248:251], v[88:91], v[32:47]
    v_exp_f32 v145, v145
    v_fma_f32 v139, -v152, v59, v27
    v_mul_f32 v146, v130, v153
    ds_read_b128 v[84:87], v7 offset:40960
    v_mfma_f32_32x32x16_bf16 v[32:47], a[252:255], v[64:67], v[32:47]
    v_mul_f32 v130, v130, v138
    v_fma_f32 v132, -v152, v52, v20
    ds_read_b128 v[88:91], v7 offset:41984
    s_waitcnt lgkmcnt(4)
    v_mfma_f32_32x32x16_bf16 v[32:47], v[176:179], v[68:71], v[32:47]
    v_exp_f32 v146, v146
    v_fma_f32 v140, -v152, v60, v28
    v_mul_f32 v147, v131, v153
    s_waitcnt vmcnt(0)
    v_cmp_ne_u64 vcc, s[96:97], v[168:169]
    s_cbranch_vccz FSD_1_52
    s_mov_b32 s80, 0
FS_1_51:
    buffer_load_dwordx2 v[168:169], v3, s[8:11], 0 offen sc1
    s_waitcnt vmcnt(0)
    v_cmp_ne_u64 vcc, s[96:97], v[168:169]
    s_cbranch_vccz FSD_1_52
    s_add_u32 s80, s80, 1
    s_cmp_lt_u32 s80, 20000
    s_cbranch_scc0 FSD_1_52_to
    s_sleep 1
    s_branch FS_1_51
FSD_1_52_to:
    s_or_b32 s39, s39, 8
FSD_1_52:
    ds_read_b128 v[64:67], v7 offset:43008
    v_mfma_f32_32x32x16_bf16 v[32:47], v[180:183], v[72:75], v[32:47]
    v_mul_f32 v131, v131, v139
    v_add_f32 v144, 1.0, v144
    v_fma_f32 v133, -v152, v53, v21
    s_lshl_b32 s80, s67, 9
    s_add_u32 s80, s80, 8
    v_add_u32 v6, s80, v5
    s_lshl_b32 s80, s36, 11
    s_add_u32 s80, s80, 118784
    v_add_u32 v12, s80, v1
    s_lshl_b32 s80, s36, 13
    s_add_u32 s80, s80, 118784
    v_add_u32 v13, s80, v1
    s_add_u32 s83, s94, 0
    buffer_load_dwordx4 v[92:95], v1, s[8:11], s83 offen offset:0
    ds_read_b128 v[68:71], v7 offset:44032
    s_waitcnt lgkmcnt(4)
    v_mfma_f32_32x32x16_bf16 v[32:47], v[184:187], v[76:79], v[32:47]
    v_exp_f32 v147, v147
    v_fma_f32 v141, -v152, v61, v29
    v_mul_f32 v148, v132, v153
    ds_read_b128 v[72:75], v7 offset:45056
    v_mfma_f32_32x32x16_bf16 v[32:47], v[188:191], v[80:83], v[32:47]
    v_rcp_f32 v144, v144
    v_mul_f32 v132, v132, v140
    s_add_u32 s83, s94, 0
    buffer_load_dwordx4 v[96:99], v1, s[8:11], s83 offen offset:1024
    ds_read_b128 v[76:79], v7 offset:46080
    s_waitcnt lgkmcnt(4)
    v_mfma_f32_32x32x16_bf16 v[32:47], v[192:195], v[84:87], v[32:47]
    v_add_f32 v145, 1.0, v145
    v_fma_f32 v134, -v152, v54, v22
    v_exp_f32 v148, v148
    ds_read_b128 v[80:83], v7 offset:47104
    v_mfma_f32_32x32x16_bf16 v[32:47], v[196:199], v[88:91], v[32:47]
    v_fma_f32 v142, -v152, v62, v30
    v_mul_f32 v149, v133, v153
    ds_read_b128 v[84:87], v7 offset:48128
    s_waitcnt lgkmcnt(4)
    v_mfma_f32_32x32x16_bf16 v[32:47], v[200:203], v[64:67], v[32:47]
    v_rcp_f32 v145, v145
    v_mul_f32 v133, v133, v141
    v_add_f32 v146, 1.0, v146
    s_add_u32 s83, s94, 0
    buffer_load_dwordx4 v[100:103], v1, s[8:11], s83 offen offset:2048
    ds_read_b128 v[88:91], v7 offset:49152
    v_mfma_f32_32x32x16_bf16 v[32:47], v[204:207], v[68:71], v[32:47]
    v_fma_f32 v135, -v152, v55, v23
    v_exp_f32 v149, v149
    ds_read_b128 v[64:67], v7 offset:50176
    s_waitcnt lgkmcnt(4)
    v_mfma_f32_32x32x16_bf16 v[32:47], v[208:211], v[72:75], v[32:47]
    v_fma_f32 v143, -v152, v63, v31
    v_mul_f32 v150, v134, v153
    v_rcp_f32 v146, v146
    s_add_u32 s83, s94, 0
    buffer_load_dwordx4 v[104:107], v1, s[8:11], s83 offen offset:3072
    ds_read_b128 v[68:71], v7 offset:51200
    v_mfma_f32_32x32x16_bf16 v[32:47], v[212:215], v[76:79], v[32:47]
    v_mul_f32 v134, v134, v142
    v_add_f32 v147, 1.0, v147
    v_mul_f32 v136, v128, v144
    ds_read_b128 v[72:75], v7 offset:52224
    s_waitcnt lgkmcnt(4)
    v_mfma_f32_32x32x16_bf16 v[32:47], v[216:219], v[80:83], v[32:47]
    v_exp_f32 v150, v150
    v_mul_f32 v151, v135, v153
    s_add_u32 s83, s94, 4096
    buffer_load_dwordx4 v[108:111], v1, s[8:11], s83 offen offset:0
    ds_read_b128 v[76:79], v7 offset:53248
    v_mfma_f32_32x32x16_bf16 v[32:47], v[220:223], v[84:87], v[32:47]
    v_rcp_f32 v147, v147
    v_mul_f32 v135, v135, v143
    ds_read_b128 v[80:83], v7 offset:54272
    s_waitcnt lgkmcnt(4)
    v_mfma_f32_32x32x16_bf16 v[32:47], v[224:227], v[88:91], v[32:47]
    buffer_store_dwordx2 v[10:11], v9, s[8:11], 0 offen offset:896 sc0 sc1
    v_add_f32 v148, 1.0, v148
    ds_read_b128 v[84:87], v7 offset:55296
    v_mfma_f32_32x32x16_bf16 v[32:47], v[228:231], v[64:67], v[32:47]
    s_barrier
    v_mul_f32 v137, v129, v145
    s_add_u32 s83, s94, 4096
    buffer_load_dwordx4 v[64:67], v1, s[8:11], s83 offen offset:1024
    ds_read_b128 v[88:91], v7 offset:56320
    s_waitcnt lgkmcnt(4)
    v_mfma_f32_32x32x16_bf16 v[32:47], v[232:235], v[68:71], v[32:47]
    v_exp_f32 v151, v151
    v_rcp_f32 v148, v148
    v_add_f32 v149, 1.0, v149
    v_mfma_f32_32x32x16_bf16 v[32:47], v[236:239], v[72:75], v[32:47]
    v_mul_f32 v138, v130, v146
    v_cvt_pk_bf16_f32 v156, v136, v137
    v_rcp_f32 v149, v149
    s_add_u32 s83, s94, 4096
    buffer_load_dwordx4 v[68:71], v1, s[8:11], s83 offen offset:2048
    s_waitcnt lgkmcnt(2)
    v_mfma_f32_32x32x16_bf16 v[32:47], v[240:243], v[76:79], v[32:47]
    v_add_f32 v150, 1.0, v150
    v_mul_f32 v139, v131, v147
    v_rcp_f32 v150, v150
    v_add_f32 v151, 1.0, v151
    v_mfma_f32_32x32x16_bf16 v[32:47], v[244:247], v[80:83], v[32:47]
    v_mul_f32 v140, v132, v148
    v_cvt_pk_bf16_f32 v157, v138, v139
    v_rcp_f32 v151, v151
    s_add_u32 s83, s94, 4096
    buffer_load_dwordx4 v[72:75], v1, s[8:11], s83 offen offset:3072
    s_waitcnt lgkmcnt(0)
    v_mfma_f32_32x32x16_bf16 v[32:47], v[248:251], v[84:87], v[32:47]
    v_mul_f32 v141, v133, v149
    v_mul_f32 v142, v134, v150
    v_cvt_pk_bf16_f32 v158, v140, v141
    v_mul_f32 v143, v135, v151
    v_cvt_pk_bf16_f32 v159, v142, v143
    v_mfma_f32_32x32x16_bf16 v[32:47], v[252:255], v[88:91], v[32:47]
    s_add_u32 s82, s79, 688128
    buffer_store_dwordx4 v[156:159], v1, s[8:11], s82 offen sc0 sc1
    s_add_u32 s83, s94, 8192
    buffer_load_dwordx4 v[76:79], v1, s[8:11], s83 offen offset:0
    s_waitcnt vmcnt(10)
    v_mfma_f32_32x32x16_bf16 v[16:31], a[0:3], v[92:95], 0
    ds_read_b64 v[152:153], v5 offset:3584
    s_waitcnt lgkmcnt(0)
    s_nop 3
    v_fma_f32 v128, -v152, v48, v32
    v_fma_f32 v136, -v152, v56, v40
    v_fma_f32 v129, -v152, v49, v33
    v_fma_f32 v137, -v152, v57, v41
    v_mfma_f32_32x32x16_bf16 v[160:175], a[4:7], v[92:95], 0
    s_add_u32 s83, s94, 8192
    buffer_load_dwordx4 v[80:83], v1, s[8:11], s83 offen offset:1024
    s_add_u32 s83, s94, 8192
    buffer_load_dwordx4 v[84:87], v1, s[8:11], s83 offen offset:2048
    s_add_u32 s83, s94, 12288
    buffer_load_dwordx4 v[92:95], v1, s[8:11], s83 offen offset:0
    s_waitcnt vmcnt(12)
    v_mfma_f32_32x32x16_bf16 v[16:31], a[8:11], v[96:99], v[16:31]
    v_mul_f32 v144, v128, v153
    v_mul_f32 v128, v128, v136
    v_fma_f32 v130, -v152, v50, v34
    v_exp_f32 v144, v144
    v_fma_f32 v138, -v152, v58, v42
    v_mfma_f32_32x32x16_bf16 v[160:175], a[12:15], v[96:99], v[160:175]
    s_add_u32 s83, s94, 8192
    buffer_load_dwordx4 v[88:91], v1, s[8:11], s83 offen offset:3072
    s_add_u32 s83, s94, 12288
    buffer_load_dwordx4 v[96:99], v1, s[8:11], s83 offen offset:1024
    s_waitcnt vmcnt(13)
    v_mfma_f32_32x32x16_bf16 v[16:31], a[16:19], v[100:103], v[16:31]
    v_mul_f32 v145, v129, v153
    v_mul_f32 v129, v129, v137
    v_fma_f32 v131, -v152, v51, v35
    v_exp_f32 v145, v145
    v_fma_f32 v139, -v152, v59, v43
    v_mfma_f32_32x32x16_bf16 v[160:175], a[20:23], v[100:103], v[160:175]
    s_add_u32 s83, s94, 12288
    buffer_load_dwordx4 v[100:103], v1, s[8:11], s83 offen offset:2048
    v_mul_f32 v146, v130, v153
    v_mul_f32 v130, v130, v138
    s_waitcnt vmcnt(13)
    v_mfma_f32_32x32x16_bf16 v[16:31], a[24:27], v[104:107], v[16:31]
    v_fma_f32 v132, -v152, v52, v36
    v_exp_f32 v146, v146
    v_fma_f32 v140, -v152, v60, v44
    v_mul_f32 v147, v131, v153
    v_mul_f32 v131, v131, v139
    v_mfma_f32_32x32x16_bf16 v[160:175], a[28:31], v[104:107], v[160:175]
    s_add_u32 s83, s94, 12288
    buffer_load_dwordx4 v[104:107], v1, s[8:11], s83 offen offset:3072
    v_add_f32 v144, 1.0, v144
    v_fma_f32 v133, -v152, v53, v37
    s_waitcnt vmcnt(13)
    v_mfma_f32_32x32x16_bf16 v[16:31], a[32:35], v[108:111], v[16:31]
    v_exp_f32 v147, v147
    v_fma_f32 v141, -v152, v61, v45
    v_mul_f32 v148, v132, v153
    v_rcp_f32 v144, v144
    v_mfma_f32_32x32x16_bf16 v[160:175], a[36:39], v[108:111], v[160:175]
    s_add_u32 s83, s94, 16384
    buffer_load_dwordx4 v[108:111], v1, s[8:11], s83 offen offset:0
    v_mul_f32 v132, v132, v140
    v_add_f32 v145, 1.0, v145
    s_waitcnt vmcnt(12)
    v_mfma_f32_32x32x16_bf16 v[16:31], a[40:43], v[64:67], v[16:31]
    v_fma_f32 v134, -v152, v54, v38
    v_exp_f32 v148, v148
    v_fma_f32 v142, -v152, v62, v46
    v_mul_f32 v149, v133, v153
    v_mfma_f32_32x32x16_bf16 v[160:175], a[44:47], v[64:67], v[160:175]
    s_add_u32 s83, s94, 16384
    buffer_load_dwordx4 v[64:67], v1, s[8:11], s83 offen offset:1024
    v_rcp_f32 v145, v145
    s_waitcnt vmcnt(12)
    v_mfma_f32_32x32x16_bf16 v[16:31], a[48:51], v[68:71], v[16:31]
    s_waitcnt vmcnt(10)
    buffer_store_dwordx2 v[10:11], v9, s[8:11], 0 offen offset:1792 sc0 sc1
    v_mul_f32 v133, v133, v141
    v_add_f32 v146, 1.0, v146
    v_fma_f32 v135, -v152, v55, v39
    v_mfma_f32_32x32x16_bf16 v[160:175], a[52:55], v[68:71], v[160:175]
    s_add_u32 s83, s94, 16384
    buffer_load_dwordx4 v[68:71], v1, s[8:11], s83 offen offset:2048
    v_exp_f32 v149, v149
    v_mfma_f32_32x32x16_bf16 v[16:31], a[56:59], v[72:75], v[16:31]
    v_fma_f32 v143, -v152, v63, v47
    v_mul_f32 v150, v134, v153
    v_rcp_f32 v146, v146
    v_mul_f32 v134, v134, v142
    v_add_f32 v147, 1.0, v147
    v_mfma_f32_32x32x16_bf16 v[160:175], a[60:63], v[72:75], v[160:175]
    s_add_u32 s83, s94, 16384
    buffer_load_dwordx4 v[72:75], v1, s[8:11], s83 offen offset:3072
    v_mul_f32 v136, v128, v144
    s_waitcnt vmcnt(12)
    v_mfma_f32_32x32x16_bf16 v[16:31], a[64:67], v[76:79], v[16:31]
    v_exp_f32 v150, v150
    v_mul_f32 v151, v135, v153
    v_rcp_f32 v147, v147
    v_mul_f32 v135, v135, v143
    v_mfma_f32_32x32x16_bf16 v[160:175], a[68:71], v[76:79], v[160:175]
    s_add_u32 s83, s94, 20480
    buffer_load_dwordx4 v[76:79], v1, s[8:11], s83 offen offset:0
    v_add_f32 v148, 1.0, v148
    v_mul_f32 v137, v129, v145
    s_waitcnt vmcnt(12)
    v_mfma_f32_32x32x16_bf16 v[16:31], a[72:75], v[80:83], v[16:31]
    v_exp_f32 v151, v151
    v_rcp_f32 v148, v148
    v_add_f32 v149, 1.0, v149
    v_mul_f32 v138, v130, v146
    buffer_load_dwordx2 v[154:155], v4, s[8:11], 0 offen sc1
    v_mfma_f32_32x32x16_bf16 v[160:175], a[76:79], v[80:83], v[160:175]
    s_add_u32 s83, s94, 20480
    buffer_load_dwordx4 v[80:83], v1, s[8:11], s83 offen offset:1024
    v_cvt_pk_bf16_f32 v156, v136, v137
    s_waitcnt vmcnt(13)
    v_mfma_f32_32x32x16_bf16 v[16:31], a[80:83], v[84:87], v[16:31]
    v_rcp_f32 v149, v149
    v_add_f32 v150, 1.0, v150
    v_mul_f32 v139, v131, v147
    v_rcp_f32 v150, v150
    v_mfma_f32_32x32x16_bf16 v[160:175], a[84:87], v[84:87], v[160:175]
    s_add_u32 s83, s94, 20480
    buffer_load_dwordx4 v[84:87], v1, s[8:11], s83 offen offset:2048
    v_add_f32 v151, 1.0, v151
    v_mul_f32 v140, v132, v148
    s_waitcnt vmcnt(12)
    v_mfma_f32_32x32x16_bf16 v[16:31], a[88:91], v[88:91], v[16:31]
    v_cvt_pk_bf16_f32 v157, v138, v139
    v_rcp_f32 v151, v151
    v_mul_f32 v141, v133, v149
    v_mul_f32 v142, v134, v150
    v_cvt_pk_bf16_f32 v158, v140, v141
    v_mfma_f32_32x32x16_bf16 v[160:175], a[92:95], v[88:91], v[160:175]
    s_add_u32 s83, s94, 20480
    buffer_load_dwordx4 v[88:91], v1, s[8:11], s83 offen offset:3072
    v_mul_f32 v143, v135, v151
    v_cvt_pk_bf16_f32 v159, v142, v143
    v_mfma_f32_32x32x16_bf16 v[16:31], a[96:99], v[92:95], v[16:31]
    s_add_u32 s82, s79, 802816
    buffer_store_dwordx4 v[156:159], v1, s[8:11], s82 offen sc0 sc1
    v_mfma_f32_32x32x16_bf16 v[160:175], a[100:103], v[92:95], v[160:175]
    s_add_u32 s83, s94, 24576
    buffer_load_dwordx4 v[92:95], v1, s[8:11], s83 offen offset:0
    s_waitcnt vmcnt(14)
    v_mfma_f32_32x32x16_bf16 v[16:31], a[104:107], v[96:99], v[16:31]
    v_mfma_f32_32x32x16_bf16 v[160:175], a[108:111], v[96:99], v[160:175]
    s_add_u32 s83, s94, 24576
    buffer_load_dwordx4 v[96:99], v1, s[8:11], s83 offen offset:1024
    s_waitcnt vmcnt(14)
    v_mfma_f32_32x32x16_bf16 v[16:31], a[112:115], v[100:103], v[16:31]
    v_mfma_f32_32x32x16_bf16 v[160:175], a[116:119], v[100:103], v[160:175]
    s_add_u32 s83, s94, 24576
    buffer_load_dwordx4 v[100:103], v1, s[8:11], s83 offen offset:2048
    s_waitcnt vmcnt(14)
    v_mfma_f32_32x32x16_bf16 v[16:31], a[120:123], v[104:107], v[16:31]
    v_mfma_f32_32x32x16_bf16 v[160:175], a[124:127], v[104:107], v[160:175]
    s_add_u32 s83, s94, 24576
    buffer_load_dwordx4 v[104:107], v1, s[8:11], s83 offen offset:3072
    s_waitcnt vmcnt(14)
    v_mfma_f32_32x32x16_bf16 v[16:31], a[128:131], v[108:111], v[16:31]
    s_waitcnt vmcnt(4)
    buffer_store_dwordx2 v[10:11], v9, s[8:11], 0 offen offset:2688 sc0 sc1
    v_mfma_f32_32x32x16_bf16 v[160:175], a[132:135], v[108:111], v[160:175]
    v_mfma_f32_32x32x16_bf16 v[16:31], a[136:139], v[64:67], v[16:31]
    v_mfma_f32_32x32x16_bf16 v[160:175], a[140:143], v[64:67], v[160:175]
    v_cmp_ne_u64 vcc, s[96:97], v[154:155]
    s_cbranch_vccz FSD_1_54
    s_mov_b32 s80, 0
FS_1_53:
    buffer_load_dwordx2 v[154:155], v4, s[8:11], 0 offen sc1
    s_waitcnt vmcnt(0)
    v_cmp_ne_u64 vcc, s[96:97], v[154:155]
    s_cbranch_vccz FSD_1_54
    s_add_u32 s80, s80, 1
    s_cmp_lt_u32 s80, 20000
    s_cbranch_scc0 FSD_1_54_to
    s_sleep 1
    s_branch FS_1_53
FSD_1_54_to:
    s_or_b32 s39, s39, 128
FSD_1_54:
    v_mfma_f32_32x32x16_bf16 v[16:31], a[144:147], v[68:71], v[16:31]
    v_mfma_f32_32x32x16_bf16 v[160:175], a[148:151], v[68:71], v[160:175]
    s_add_u32 s83, s95, 0
    buffer_load_dwordx4 v[108:111], v1, s[8:11], s83 offen offset:0
    s_add_u32 s83, s95, 0
    buffer_load_dwordx4 v[64:67], v1, s[8:11], s83 offen offset:1024
    v_mfma_f32_32x32x16_bf16 v[16:31], a[152:155], v[72:75], v[16:31]
    v_mfma_f32_32x32x16_bf16 v[160:175], a[156:159], v[72:75], v[160:175]
    s_add_u32 s83, s95, 0
    buffer_load_dwordx4 v[68:71], v1, s[8:11], s83 offen offset:2048
    s_add_u32 s83, s95, 0
    buffer_load_dwordx4 v[72:75], v1, s[8:11], s83 offen offset:3072
    v_mfma_f32_32x32x16_bf16 v[16:31], a[160:163], v[76:79], v[16:31]
    v_mfma_f32_32x32x16_bf16 v[160:175], a[164:167], v[76:79], v[160:175]
    s_add_u32 s83, s95, 4096
    buffer_load_dwordx4 v[76:79], v1, s[8:11], s83 offen offset:0
    v_mfma_f32_32x32x16_bf16 v[16:31], a[168:171], v[80:83], v[16:31]
    v_mfma_f32_32x32x16_bf16 v[160:175], a[172:175], v[80:83], v[160:175]
    s_add_u32 s83, s95, 4096
    buffer_load_dwordx4 v[80:83], v1, s[8:11], s83 offen offset:1024
    v_mfma_f32_32x32x16_bf16 v[16:31], a[176:179], v[84:87], v[16:31]
    v_mfma_f32_32x32x16_bf16 v[160:175], a[180:183], v[84:87], v[160:175]
    s_add_u32 s83, s95, 4096
    buffer_load_dwordx4 v[84:87], v1, s[8:11], s83 offen offset:2048
    v_mfma_f32_32x32x16_bf16 v[16:31], a[184:187], v[88:91], v[16:31]
    v_mfma_f32_32x32x16_bf16 v[160:175], a[188:191], v[88:91], v[160:175]
    s_add_u32 s83, s95, 4096
    buffer_load_dwordx4 v[88:91], v1, s[8:11], s83 offen offset:3072
    s_waitcnt vmcnt(12)
    v_mfma_f32_32x32x16_bf16 v[16:31], a[192:195], v[92:95], v[16:31]
    v_mfma_f32_32x32x16_bf16 v[160:175], a[196:199], v[92:95], v[160:175]
    s_add_u32 s83, s95, 8192
    buffer_load_dwordx4 v[92:95], v1, s[8:11], s83 offen offset:0
    s_waitcnt vmcnt(12)
    v_mfma_f32_32x32x16_bf16 v[16:31], a[200:203], v[96:99], v[16:31]
    v_mfma_f32_32x32x16_bf16 v[160:175], a[204:207], v[96:99], v[160:175]
    s_add_u32 s83, s95, 8192
    buffer_load_dwordx4 v[96:99], v1, s[8:11], s83 offen offset:1024
    s_waitcnt vmcnt(12)
    v_mfma_f32_32x32x16_bf16 v[16:31], a[208:211], v[100:103], v[16:31]
    v_mfma_f32_32x32x16_bf16 v[160:175], a[212:215], v[100:103], v[160:175]
    s_add_u32 s83, s95, 8192
    buffer_load_dwordx4 v[100:103], v1, s[8:11], s83 offen offset:2048
    s_waitcnt vmcnt(12)
    v_mfma_f32_32x32x16_bf16 v[16:31], a[216:219], v[104:107], v[16:31]
    v_mfma_f32_32x32x16_bf16 v[160:175], a[220:223], v[104:107], v[160:175]
    s_add_u32 s83, s95, 8192
    buffer_load_dwordx4 v[104:107], v1, s[8:11], s83 offen offset:3072
    s_waitcnt vmcnt(11)
    v_mfma_f32_32x32x16_bf16 v[32:47], a[0:3], v[108:111], 0
    v_mfma_f32_32x32x16_bf16 v[128:143], a[4:7], v[108:111], 0
    s_add_u32 s83, s95, 12288
    buffer_load_dwordx4 v[108:111], v1, s[8:11], s83 offen offset:0
    s_waitcnt vmcnt(11)
    v_mfma_f32_32x32x16_bf16 v[32:47], a[8:11], v[64:67], v[32:47]
    s_nop 1
    ds_write_b128 v12, v[16:19] offset:0
    ds_write_b128 v12, v[20:23] offset:1024
    ds_write_b128 v12, v[24:27] offset:16384
    v_mfma_f32_32x32x16_bf16 v[128:143], a[12:15], v[64:67], v[128:143]
    s_add_u32 s83, s95, 12288
    buffer_load_dwordx4 v[64:67], v1, s[8:11], s83 offen offset:1024
    ds_write_b128 v12, v[28:31] offset:17408
    s_waitcnt vmcnt(11)
    v_mfma_f32_32x32x16_bf16 v[32:47], a[16:19], v[68:71], v[32:47]
    ds_write_b128 v12, v[160:163] offset:8192
    ds_write_b128 v12, v[164:167] offset:9216
    ds_write_b128 v12, v[168:171] offset:24576
    v_mfma_f32_32x32x16_bf16 v[128:143], a[20:23], v[68:71], v[128:143]
    s_add_u32 s83, s95, 12288
    buffer_load_dwordx4 v[68:71], v1, s[8:11], s83 offen offset:2048
    ds_write_b128 v12, v[172:175] offset:25600
    s_waitcnt vmcnt(11)
    v_mfma_f32_32x32x16_bf16 v[32:47], a[24:27], v[72:75], v[32:47]
    v_mfma_f32_32x32x16_bf16 v[128:143], a[28:31], v[72:75], v[128:143]
    s_add_u32 s83, s95, 12288
    buffer_load_dwordx4 v[72:75], v1, s[8:11], s83 offen offset:3072
    s_waitcnt vmcnt(11)
    v_mfma_f32_32x32x16_bf16 v[32:47], a[32:35], v[76:79], v[32:47]
    v_mfma_f32_32x32x16_bf16 v[128:143], a[36:39], v[76:79], v[128:143]
    s_add_u32 s83, s95, 16384
    buffer_load_dwordx4 v[76:79], v1, s[8:11], s83 offen offset:0
    s_waitcnt lgkmcnt(0)
    s_barrier
    s_waitcnt vmcnt(11)
    v_mfma_f32_32x32x16_bf16 v[32:47], a[40:43], v[80:83], v[32:47]
    ds_read_b128 v[16:19], v13 offset:0
    ds_read_b128 v[20:23], v13 offset:1024
    ds_read_b128 v[24:27], v13 offset:2048
    ds_read_b128 v[28:31], v13 offset:3072
    ds_read_b128 v[160:163], v13 offset:4096
    ds_read_b128 v[164:167], v13 offset:5120
    v_mfma_f32_32x32x16_bf16 v[128:143], a[44:47], v[80:83], v[128:143]
    s_add_u32 s83, s95, 16384
    buffer_load_dwordx4 v[80:83], v1, s[8:11], s83 offen offset:1024
    ds_read_b128 v[168:171], v13 offset:6144
    ds_read_b128 v[172:175], v13 offset:7168
    s_waitcnt vmcnt(11)
    v_mfma_f32_32x32x16_bf16 v[32:47], a[48:51], v[84:87], v[32:47]
    ds_read_b32 v152, v6 offset:0
    v_mfma_f32_32x32x16_bf16 v[128:143], a[52:55], v[84:87], v[128:143]
    s_add_u32 s83, s95, 16384
    buffer_load_dwordx4 v[84:87], v1, s[8:11], s83 offen offset:2048
    s_waitcnt vmcnt(11)
    v_mfma_f32_32x32x16_bf16 v[32:47], a[56:59], v[88:91], v[32:47]
    v_mfma_f32_32x32x16_bf16 v[128:143], a[60:63], v[88:91], v[128:143]
    s_add_u32 s83, s95, 16384
    buffer_load_dwordx4 v[88:91], v1, s[8:11], s83 offen offset:3072
    s_waitcnt vmcnt(11)
    v_mfma_f32_32x32x16_bf16 v[32:47], a[64:67], v[92:95], v[32:47]
    s_waitcnt lgkmcnt(0)
    v_add_f32 v144, v16, v24
    v_add_f32 v145, v17, v25
    v_add_f32 v146, v18, v26
    v_add_f32 v147, v19, v27
    v_add_f32 v148, v20, v28
    v_mfma_f32_32x32x16_bf16 v[128:143], a[68:71], v[92:95], v[128:143]
    s_add_u32 s83, s95, 20480
    buffer_load_dwordx4 v[92:95], v1, s[8:11], s83 offen offset:0
    v_add_f32 v149, v21, v29
    v_add_f32 v150, v22, v30
    s_waitcnt vmcnt(11)
    v_mfma_f32_32x32x16_bf16 v[32:47], a[72:75], v[96:99], v[32:47]
    v_add_f32 v151, v23, v31
    v_add_f32 v160, v160, v168
    v_add_f32 v161, v161, v169
    v_add_f32 v162, v162, v170
    v_add_f32 v163, v163, v171
    v_add_f32 v164, v164, v172
    v_mfma_f32_32x32x16_bf16 v[128:143], a[76:79], v[96:99], v[128:143]
    s_add_u32 s83, s95, 20480
    buffer_load_dwordx4 v[96:99], v1, s[8:11], s83 offen offset:1024
    v_add_f32 v165, v165, v173
    v_add_f32 v166, v166, v174
    s_waitcnt vmcnt(11)
    v_mfma_f32_32x32x16_bf16 v[32:47], a[80:83], v[100:103], v[32:47]
    v_add_f32 v167, v167, v175
    v_add_f32 v144, v144, v160
    v_add_f32 v145, v145, v161
    v_add_f32 v146, v146, v162
    v_add_f32 v147, v147, v163
    v_add_f32 v148, v148, v164
    v_mfma_f32_32x32x16_bf16 v[128:143], a[84:87], v[100:103], v[128:143]
    s_add_u32 s83, s95, 20480
    buffer_load_dwordx4 v[100:103], v1, s[8:11], s83 offen offset:2048
    v_add_f32 v149, v149, v165
    v_add_f32 v150, v150, v166
    s_waitcnt vmcnt(11)
    v_mfma_f32_32x32x16_bf16 v[32:47], a[88:91], v[104:107], v[32:47]
    v_add_f32 v151, v151, v167
    v_lshlrev_b32 v153, 16, v112
    v_and_b32 v154, s77, v112
    v_fma_f32 v144, v144, v152, v153
    v_fma_f32 v145, v145, v152, v154
    v_lshlrev_b32 v153, 16, v113
    v_mfma_f32_32x32x16_bf16 v[128:143], a[92:95], v[104:107], v[128:143]
    s_add_u32 s83, s95, 20480
    buffer_load_dwordx4 v[104:107], v1, s[8:11], s83 offen offset:3072
    v_and_b32 v154, s77, v113
    v_fma_f32 v146, v146, v152, v153
    s_waitcnt vmcnt(11)
    v_mfma_f32_32x32x16_bf16 v[32:47], a[96:99], v[108:111], v[32:47]
    v_fma_f32 v147, v147, v152, v154
    v_lshlrev_b32 v153, 16, v114
    v_and_b32 v154, s77, v114
    v_fma_f32 v148, v148, v152, v153
    v_fma_f32 v149, v149, v152, v154
    v_lshlrev_b32 v153, 16, v115
    v_mfma_f32_32x32x16_bf16 v[128:143], a[100:103], v[108:111], v[128:143]
    s_add_u32 s83, s95, 24576
    buffer_load_dwordx4 v[108:111], v1, s[8:11], s83 offen offset:0
    v_and_b32 v154, s77, v115
    v_fma_f32 v150, v150, v152, v153
    s_waitcnt vmcnt(11)
    v_mfma_f32_32x32x16_bf16 v[32:47], a[104:107], v[64:67], v[32:47]
    v_fma_f32 v151, v151, v152, v154
    v_add_f32 v154, v144, v145
    v_mul_f32 v155, v144, v144
    v_fmac_f32 v155, v145, v145
    v_add_f32 v154, v154, v146
    v_fmac_f32 v155, v146, v146
    v_mfma_f32_32x32x16_bf16 v[128:143], a[108:111], v[64:67], v[128:143]
    s_add_u32 s83, s95, 24576
    buffer_load_dwordx4 v[64:67], v1, s[8:11], s83 offen offset:1024
    v_add_f32 v154, v154, v147
    v_fmac_f32 v155, v147, v147
    s_waitcnt vmcnt(11)
    v_mfma_f32_32x32x16_bf16 v[32:47], a[112:115], v[68:71], v[32:47]
    v_add_f32 v154, v154, v148
    v_fmac_f32 v155, v148, v148
    v_add_f32 v154, v154, v149
    v_fmac_f32 v155, v149, v149
    v_add_f32 v154, v154, v150
    v_fmac_f32 v155, v150, v150
    v_mfma_f32_32x32x16_bf16 v[128:143], a[116:119], v[68:71], v[128:143]
    s_add_u32 s83, s95, 24576
    buffer_load_dwordx4 v[68:71], v1, s[8:11], s83 offen offset:2048
    v_add_f32 v154, v154, v151
    v_fmac_f32 v155, v151, v151
    s_waitcnt vmcnt(11)
    v_mfma_f32_32x32x16_bf16 v[32:47], a[120:123], v[72:75], v[32:47]
    v_mov_b32 v156, v154
    v_mov_b32 v157, v155
    s_nop 0
    v_permlane32_swap_b32 v156, v154
    v_permlane32_swap_b32 v157, v155
    v_add_f32 v154, v154, v156
    v_mfma_f32_32x32x16_bf16 v[128:143], a[124:127], v[72:75], v[128:143]
    s_add_u32 s83, s95, 24576
    buffer_load_dwordx4 v[72:75], v1, s[8:11], s83 offen offset:3072
    v_add_f32 v155, v155, v157
    ds_write_b64 v14, v[154:155] offset:0
    s_waitcnt vmcnt(11)
    v_mfma_f32_32x32x16_bf16 v[32:47], a[128:131], v[76:79], v[32:47]
    v_mfma_f32_32x32x16_bf16 v[128:143], a[132:135], v[76:79], v[128:143]
    s_waitcnt vmcnt(10)
    v_mfma_f32_32x32x16_bf16 v[32:47], a[136:139], v[80:83], v[32:47]
    s_waitcnt lgkmcnt(0)
    s_barrier
    ds_read_b64 v[158:159], v14 offset:512
    v_mfma_f32_32x32x16_bf16 v[128:143], a[140:143], v[80:83], v[128:143]
    s_waitcnt vmcnt(9)
    v_mfma_f32_32x32x16_bf16 v[32:47], a[144:147], v[84:87], v[32:47]
    v_mfma_f32_32x32x16_bf16 v[128:143], a[148:151], v[84:87], v[128:143]
    s_waitcnt vmcnt(8)
    v_mfma_f32_32x32x16_bf16 v[32:47], a[152:155], v[88:91], v[32:47]
    v_mfma_f32_32x32x16_bf16 v[128:143], a[156:159], v[88:91], v[128:143]
    s_waitcnt vmcnt(7)
    v_mfma_f32_32x32x16_bf16 v[32:47], a[160:163], v[92:95], v[32:47]
    v_mfma_f32_32x32x16_bf16 v[128:143], a[164:167], v[92:95], v[128:143]
    s_waitcnt vmcnt(6)
    v_mfma_f32_32x32x16_bf16 v[32:47], a[168:171], v[96:99], v[32:47]
    v_mfma_f32_32x32x16_bf16 v[128:143], a[172:175], v[96:99], v[128:143]
    s_waitcnt vmcnt(5)
    v_mfma_f32_32x32x16_bf16 v[32:47], a[176:179], v[100:103], v[32:47]
    v_mfma_f32_32x32x16_bf16 v[128:143], a[180:183], v[100:103], v[128:143]
    s_waitcnt vmcnt(4)
    v_mfma_f32_32x32x16_bf16 v[32:47], a[184:187], v[104:107], v[32:47]
    v_mfma_f32_32x32x16_bf16 v[128:143], a[188:191], v[104:107], v[128:143]
    s_waitcnt vmcnt(3)
    v_mfma_f32_32x32x16_bf16 v[32:47], a[192:195], v[108:111], v[32:47]
    v_mfma_f32_32x32x16_bf16 v[128:143], a[196:199], v[108:111], v[128:143]
    s_waitcnt vmcnt(2)
    v_mfma_f32_32x32x16_bf16 v[32:47], a[200:203], v[64:67], v[32:47]
    v_mfma_f32_32x32x16_bf16 v[128:143], a[204:207], v[64:67], v[128:143]
    s_waitcnt vmcnt(1)
    v_mfma_f32_32x32x16_bf16 v[32:47], a[208:211], v[68:71], v[32:47]
    v_mfma_f32_32x32x16_bf16 v[128:143], a[212:215], v[68:71], v[128:143]
    s_waitcnt vmcnt(0)
    v_mfma_f32_32x32x16_bf16 v[32:47], a[216:219], v[72:75], v[32:47]
    v_mfma_f32_32x32x16_bf16 v[128:143], a[220:223], v[72:75], v[128:143]
    s_waitcnt lgkmcnt(0)
    s_cmp_eq_u32 s5, 0
    s_cbranch_scc0 GP_1_55
    v_add_f32 v154, v154, v158
    v_add_f32 v155, v155, v159
    v_mov_b32 v156, s96
    v_mov_b32 v157, s97
    s_add_u32 s80, s4, 24838144
    s_mov_b32 exec_hi, 0
    buffer_store_dwordx4 v[154:157], v1, s[8:11], s80 offen sc0 sc1
    s_mov_b32 exec_hi, -1
GP_1_55:
    s_mul_i32 s80, s68, 7168
    s_add_u32 s80, s80, 24838144
    v_and_b32 v3, 31, v0
    v_lshlrev_b32 v3, 4, v3
    v_lshrrev_b32 v159, 5, v0
    v_lshl_add_u32 v3, v159, 9, v3
    v_add_u32 v3, s80, v3
    ds_write_b128 v12, v[32:35] offset:0
    ds_write_b128 v12, v[36:39] offset:1024
    ds_write_b128 v12, v[40:43] offset:16384
    ds_write_b128 v12, v[44:47] offset:17408
    ds_write_b128 v12, v[128:131] offset:8192
    ds_write_b128 v12, v[132:135] offset:9216
    ds_write_b128 v12, v[136:139] offset:24576
    ds_write_b128 v12, v[140:143] offset:25600
    buffer_load_dwordx4 v[16:19], v3, s[8:11], 0 offen offset:0 sc1
    buffer_load_dwordx4 v[20:23], v3, s[8:11], 0 offen offset:1024 sc1
    buffer_load_dwordx4 v[24:27], v3, s[8:11], 0 offen offset:2048 sc1
    buffer_load_dwordx4 v[28:31], v3, s[8:11], 0 offen offset:3072 sc1
    buffer_load_dwordx4 v[160:163], v3, s[8:11], s78 offen offset:0 sc1
    buffer_load_dwordx4 v[164:167], v3, s[8:11], s78 offen offset:1024 sc1
    buffer_load_dwordx4 v[168:171], v3, s[8:11], s78 offen offset:2048 sc1
    s_waitcnt lgkmcnt(0)
    s_barrier
    ds_read_b128 v[64:67], v13 offset:0
    ds_read_b128 v[68:71], v13 offset:1024
    ds_read_b128 v[72:75], v13 offset:2048
    ds_read_b128 v[76:79], v13 offset:3072
    ds_read_b128 v[80:83], v13 offset:4096
    ds_read_b128 v[84:87], v13 offset:5120
    ds_read_b128 v[88:91], v13 offset:6144
    ds_read_b128 v[92:95], v13 offset:7168
    ds_read_b32 v136, v6 offset:2048
    s_waitcnt lgkmcnt(0)
    v_add_f32 v32, v64, v72
    v_add_f32 v33, v65, v73
    v_add_f32 v34, v66, v74
    v_add_f32 v35, v67, v75
    v_add_f32 v36, v68, v76
    v_add_f32 v37, v69, v77
    v_add_f32 v38, v70, v78
    v_add_f32 v39, v71, v79
    v_add_f32 v80, v80, v88
    v_add_f32 v81, v81, v89
    v_add_f32 v82, v82, v90
    v_add_f32 v83, v83, v91
    v_add_f32 v84, v84, v92
    v_add_f32 v85, v85, v93
    v_add_f32 v86, v86, v94
    v_add_f32 v87, v87, v95
    v_add_f32 v32, v32, v80
    v_add_f32 v33, v33, v81
    v_add_f32 v34, v34, v82
    v_add_f32 v35, v35, v83
    v_add_f32 v36, v36, v84
    v_add_f32 v37, v37, v85
    v_add_f32 v38, v38, v86
    v_add_f32 v39, v39, v87
    v_lshlrev_b32 v137, 16, v116
    v_and_b32 v138, s77, v116
    v_fma_f32 v32, v32, v136, v137
    v_fma_f32 v33, v33, v136, v138
    v_lshlrev_b32 v137, 16, v117
    v_and_b32 v138, s77, v117
    v_fma_f32 v34, v34, v136, v137
    v_fma_f32 v35, v35, v136, v138
    v_lshlrev_b32 v137, 16, v118
    v_and_b32 v138, s77, v118
    v_fma_f32 v36, v36, v136, v137
    v_fma_f32 v37, v37, v136, v138
    v_lshlrev_b32 v137, 16, v119
    v_and_b32 v138, s77, v119
    v_fma_f32 v38, v38, v136, v137
    v_fma_f32 v39, v39, v136, v138
    v_add_f32 v128, v32, v33
    v_mul_f32 v129, v32, v32
    v_fmac_f32 v129, v33, v33
    v_add_f32 v128, v128, v34
    v_fmac_f32 v129, v34, v34
    v_add_f32 v128, v128, v35
    v_fmac_f32 v129, v35, v35
    v_add_f32 v128, v128, v36
    v_fmac_f32 v129, v36, v36
    v_add_f32 v128, v128, v37
    v_fmac_f32 v129, v37, v37
    v_add_f32 v128, v128, v38
    v_fmac_f32 v129, v38, v38
    v_add_f32 v128, v128, v39
    v_fmac_f32 v129, v39, v39
    v_mov_b32 v130, v128
    v_mov_b32 v131, v129
    s_nop 0
    v_permlane32_swap_b32 v130, v128
    v_permlane32_swap_b32 v131, v129
    v_add_f32 v128, v128, v130
    v_add_f32 v129, v129, v131
    ds_write_b64 v14, v[128:129] offset:1024
    s_waitcnt lgkmcnt(0)
    s_barrier
    ds_read_b64 v[132:133], v14 offset:1536
    s_waitcnt lgkmcnt(0)
    s_cmp_eq_u32 s5, 0
    s_cbranch_scc0 GP_1_56
    v_add_f32 v128, v128, v132
    v_add_f32 v129, v129, v133
    v_mov_b32 v130, s96
    v_mov_b32 v131, s97
    s_add_u32 s80, s4, 24838144
    s_add_u32 s80, s80, 28672
    s_mov_b32 exec_hi, 0
    buffer_store_dwordx4 v[128:131], v1, s[8:11], s80 offen sc0 sc1
    s_mov_b32 exec_hi, -1
GP_1_56:
    s_waitcnt vmcnt(0)
    s_mov_b32 s80, 0
GC_1_57:
    v_cmpx_eq_u64 vcc, s[96:97], v[18:19]
    v_cmpx_eq_u64 vcc, s[96:97], v[22:23]
    v_cmpx_eq_u64 vcc, s[96:97], v[26:27]
    v_cmpx_eq_u64 vcc, s[96:97], v[30:31]
    v_cmpx_eq_u64 vcc, s[96:97], v[162:163]
    v_cmpx_eq_u64 vcc, s[96:97], v[166:167]
    v_cmpx_eq_u64 vcc, s[96:97], v[170:171]
    s_nop 4
    s_cmp_eq_u64 exec, -1
    s_mov_b64 exec, -1
    s_cbranch_scc1 GCD_1_58
    buffer_load_dwordx4 v[16:19], v3, s[8:11], 0 offen offset:0 sc1
    buffer_load_dwordx4 v[20:23], v3, s[8:11], 0 offen offset:1024 sc1
    buffer_load_dwordx4 v[24:27], v3, s[8:11], 0 offen offset:2048 sc1
    buffer_load_dwordx4 v[28:31], v3, s[8:11], 0 offen offset:3072 sc1
    buffer_load_dwordx4 v[160:163], v3, s[8:11], s78 offen offset:0 sc1
    buffer_load_dwordx4 v[164:167], v3, s[8:11], s78 offen offset:1024 sc1
    buffer_load_dwordx4 v[168:171], v3, s[8:11], s78 offen offset:2048 sc1
    s_waitcnt vmcnt(0)
    s_add_u32 s80, s80, 1
    s_cmp_lt_u32 s80, 20000
    s_cbranch_scc0 GCD_1_58_to
    s_sleep 1
    s_branch GC_1_57
GCD_1_58_to:
    s_or_b32 s39, s39, 16
GCD_1_58:
    v_add_f32 v18, v16, v20
    v_add_f32 v19, v17, v21
    v_add_f32 v18, v18, v24
    v_add_f32 v19, v19, v25
    v_add_f32 v18, v18, v28
    v_add_f32 v19, v19, v29
    v_add_f32 v18, v18, v160
    v_add_f32 v19, v19, v161
    v_add_f32 v18, v18, v164
    v_add_f32 v19, v19, v165
    v_add_f32 v18, v18, v168
    v_add_f32 v19, v19, v169
    v_mov_b32 v22, v18
    v_mov_b32 v23, v19
    s_nop 0
    v_permlane32_swap_b32 v22, v18
    v_permlane32_swap_b32 v23, v19
    v_add_f32 v18, v18, v22
    v_add_f32 v19, v19, v23
    v_mul_f32 v24, 0x3b124925, v18
    v_mul_f32 v26, 0x3b124925, v19
    v_fma_f32 v26, -v24, v24, v26
    v_max_f32 v26, 0, v26
    v_add_f32 v26, 0x3727c5ac, v26
    v_rsq_f32 v25, v26
    s_nop 0
    v_mul_f32 v28, v24, v25
    v_lshlrev_b32 v29, 16, v120
    v_and_b32 v30, s77, v120
    v_fma_f32 v31, v144, v25, -v28
    v_fma_f32 v160, v145, v25, -v28
    v_fmac_f32 v144, v29, v31
    v_fmac_f32 v145, v30, v160
    v_lshlrev_b32 v29, 16, v121
    v_and_b32 v30, s77, v121
    v_fma_f32 v31, v146, v25, -v28
    v_fma_f32 v160, v147, v25, -v28
    v_fmac_f32 v146, v29, v31
    v_fmac_f32 v147, v30, v160
    v_lshlrev_b32 v29, 16, v122
    v_and_b32 v30, s77, v122
    v_fma_f32 v31, v148, v25, -v28
    v_fma_f32 v160, v149, v25, -v28
    v_fmac_f32 v148, v29, v31
    v_fmac_f32 v149, v30, v160
    v_lshlrev_b32 v29, 16, v123
    v_and_b32 v30, s77, v123
    v_fma_f32 v31, v150, v25, -v28
    v_fma_f32 v160, v151, v25, -v28
    v_fmac_f32 v150, v29, v31
    v_fmac_f32 v151, v30, v160
    v_cvt_pk_bf16_f32 v112, v144, v145
    v_cvt_pk_bf16_f32 v113, v146, v147
    v_cvt_pk_bf16_f32 v114, v148, v149
    v_cvt_pk_bf16_f32 v115, v150, v151
    s_add_u32 s80, s3, 7340032
    buffer_store_dwordx4 v[112:115], v1, s[8:11], s80 offen sc0 sc1
    v_add_f32 v164, v144, v145
    v_mul_f32 v165, v144, v144
    v_fmac_f32 v165, v145, v145
    v_add_f32 v164, v164, v146
    v_fmac_f32 v165, v146, v146
    v_add_f32 v164, v164, v147
    v_fmac_f32 v165, v147, v147
    v_add_f32 v164, v164, v148
    v_fmac_f32 v165, v148, v148
    v_add_f32 v164, v164, v149
    v_fmac_f32 v165, v149, v149
    v_add_f32 v164, v164, v150
    v_fmac_f32 v165, v150, v150
    v_add_f32 v164, v164, v151
    v_fmac_f32 v165, v151, v151
    v_mov_b32 v166, v164
    v_mov_b32 v167, v165
    s_nop 0
    v_permlane32_swap_b32 v166, v164
    v_permlane32_swap_b32 v167, v165
    v_add_f32 v164, v164, v166
    v_add_f32 v165, v165, v167
    s_waitcnt vmcnt(0)
    ds_write_b64 v14, v[164:165] offset:2048
    s_waitcnt lgkmcnt(0)
    s_barrier
    ds_read_b64 v[168:169], v14 offset:2560
    s_waitcnt lgkmcnt(0)
    s_cmp_eq_u32 s5, 0
    s_cbranch_scc0 GP_1_59
    v_add_f32 v164, v164, v168
    v_add_f32 v165, v165, v169
    v_mov_b32 v166, s100
    v_mov_b32 v167, s101
    s_add_u32 s80, s4, 24379392
    s_mov_b32 exec_hi, 0
    buffer_store_dwordx4 v[164:167], v1, s[8:11], s80 offen sc0 sc1
    s_mov_b32 exec_hi, -1
GP_1_59:
    v_add_u32 v3, 28672, v3
    buffer_load_dwordx4 v[92:95], v3, s[8:11], 0 offen offset:0 sc1
    buffer_load_dwordx4 v[96:99], v3, s[8:11], 0 offen offset:1024 sc1
    buffer_load_dwordx4 v[100:103], v3, s[8:11], 0 offen offset:2048 sc1
    buffer_load_dwordx4 v[104:107], v3, s[8:11], 0 offen offset:3072 sc1
    buffer_load_dwordx4 v[108:111], v3, s[8:11], s78 offen offset:0 sc1
    buffer_load_dwordx4 v[168:171], v3, s[8:11], s78 offen offset:1024 sc1
    buffer_load_dwordx4 v[172:175], v3, s[8:11], s78 offen offset:2048 sc1
    s_mov_b32 s70, 1
    s_mov_b32 s72, 16515072
    s_mov_b32 s74, 25354240
    s_mov_b32 s71, 7340032
    v_xor_b32 v10, 1, v10
    v_and_b32 v5, 31, v0
    v_lshlrev_b32 v5, 4, v5
    v_add_u32 v5, 114688, v5
    v_add_u32 v2, 0, v1
    v_add_u32 v7, 57344, v1
    s_mul_i32 s80, s76, 112
    s_add_u32 s80, s80, s63
    s_lshl_b32 s79, s80, 10
    s_add_u32 s79, s79, s72
    s_lshl_b32 s80, s80, 3
    s_add_u32 s80, s80, s74
    v_mov_b32 v8, s80
    v_add_u32 v9, 3584, v8
    s_mul_i32 s84, s36, 7168
    s_mul_i32 s85, s76, 28672
    s_add_u32 s85, s85, s71
    s_add_u32 s85, s85, s84
    s_add_u32 s82, s76, s36
    s_mul_i32 s83, s82, 7168
    s_add_u32 s83, s83, 24379392
    v_and_b32 v4, 31, v0
    v_lshlrev_b32 v4, 4, v4
    v_lshrrev_b32 v154, 5, v0
    v_lshl_add_u32 v4, v154, 9, v4
    v_add_u32 v4, s83, v4
    buffer_load_dwordx4 v[64:67], v4, s[8:11], 0 offen offset:0 sc1
    buffer_load_dwordx4 v[68:71], v4, s[8:11], 0 offen offset:1024 sc1
    buffer_load_dwordx4 v[72:75], v4, s[8:11], 0 offen offset:2048 sc1
    buffer_load_dwordx4 v[76:79], v4, s[8:11], 0 offen offset:3072 sc1
    buffer_load_dwordx4 v[80:83], v4, s[8:11], s78 offen offset:0 sc1
    buffer_load_dwordx4 v[84:87], v4, s[8:11], s78 offen offset:1024 sc1
    buffer_load_dwordx4 v[88:91], v4, s[8:11], s78 offen offset:2048 sc1
    s_waitcnt vmcnt(0)
    s_mov_b32 s80, 0
GC_1_60:
    v_cmpx_eq_u64 vcc, s[100:101], v[66:67]
    v_cmpx_eq_u64 vcc, s[100:101], v[70:71]
    v_cmpx_eq_u64 vcc, s[100:101], v[74:75]
    v_cmpx_eq_u64 vcc, s[100:101], v[78:79]
    v_cmpx_eq_u64 vcc, s[100:101], v[82:83]
    v_cmpx_eq_u64 vcc, s[100:101], v[86:87]
    v_cmpx_eq_u64 vcc, s[100:101], v[90:91]
    s_nop 4
    s_cmp_eq_u64 exec, -1
    s_mov_b64 exec, -1
    s_cbranch_scc1 GCD_1_61
    buffer_load_dwordx4 v[64:67], v4, s[8:11], 0 offen offset:0 sc1
    buffer_load_dwordx4 v[68:71], v4, s[8:11], 0 offen offset:1024 sc1
    buffer_load_dwordx4 v[72:75], v4, s[8:11], 0 offen offset:2048 sc1
    buffer_load_dwordx4 v[76:79], v4, s[8:11], 0 offen offset:3072 sc1
    buffer_load_dwordx4 v[80:83], v4, s[8:11], s78 offen offset:0 sc1
    buffer_load_dwordx4 v[84:87], v4, s[8:11], s78 offen offset:1024 sc1
    buffer_load_dwordx4 v[88:91], v4, s[8:11], s78 offen offset:2048 sc1
    s_waitcnt vmcnt(0)
    s_add_u32 s80, s80, 1
    s_cmp_lt_u32 s80, 20000
    s_cbranch_scc0 GCD_1_61_to
    s_sleep 1
    s_branch GC_1_60
GCD_1_61_to:
    s_or_b32 s39, s39, 4
GCD_1_61:
    v_add_u32 v4, 28672, v4
    s_barrier
    s_add_u32 s83, s85, 0
    s_add_u32 m0, s84, 0
    s_nop 0
    buffer_load_dwordx4 v1, s[8:11], s83 offen offset:0 lds
    buffer_load_dwordx4 v1, s[8:11], s83 offen offset:1024 lds
    buffer_load_dwordx4 v1, s[8:11], s83 offen offset:2048 lds
    buffer_load_dwordx4 v1, s[8:11], s83 offen offset:3072 lds
    s_add_u32 s83, s83, 4096
    s_add_u32 m0, s84, 4096
    s_nop 0
    buffer_load_dwordx4 v1, s[8:11], s83 offen offset:0 lds
    buffer_load_dwordx4 v1, s[8:11], s83 offen offset:1024 lds
    buffer_load_dwordx4 v1, s[8:11], s83 offen offset:2048 lds
    v_add_f32 v66, v64, v68
    v_add_f32 v67, v65, v69
    v_add_f32 v66, v66, v72
    v_add_f32 v67, v67, v73
    v_add_f32 v66, v66, v76
    v_add_f32 v67, v67, v77
    v_add_f32 v66, v66, v80
    v_add_f32 v67, v67, v81
    v_add_f32 v66, v66, v84
    v_add_f32 v67, v67, v85
    v_add_f32 v66, v66, v88
    v_add_f32 v67, v67, v89
    v_mov_b32 v70, v66
    v_mov_b32 v71, v67
    s_nop 0
    v_permlane32_swap_b32 v70, v66
    v_permlane32_swap_b32 v71, v67
    v_add_f32 v66, v66, v70
    v_add_f32 v67, v67, v71
    v_mul_f32 v72, 0x3b124925, v66
    v_mul_f32 v77, 0x3b124925, v67
    v_fma_f32 v77, -v72, v72, v77
    v_max_f32 v77, 0, v77
    v_add_f32 v77, 0x3727c5ac, v77
    v_rsq_f32 v76, v77
    v_mov_b32 v75, 0
    v_mul_f32 v73, 0xbfb8aa3b, v76
    v_mul_f32 v74, v76, v76
    s_lshl_b32 s80, s36, 9
    v_add_u32 v80, s80, v5
    ds_write_b128 v80, v[72:75] offset:0
    s_waitcnt vmcnt(0)
    s_waitcnt lgkmcnt(0)
    s_barrier
    ds_read_b128 v[64:67], v2 offset:0
    ds_read_b128 v[68:71], v2 offset:1024
    ds_read_b128 v[72:75], v2 offset:2048
    ds_read_b128 v[76:79], v2 offset:3072
    ds_read_b128 v[80:83], v2 offset:4096
    ds_read_b128 v[84:87], v2 offset:5120
    s_waitcnt lgkmcnt(4)
    v_mfma_f32_32x32x16_bf16 v[16:31], a[224:227], v[64:67], 0
    s_add_u32 s83, s85, 28672
    s_add_u32 m0, s84, 28672
    s_nop 0
    buffer_load_dwordx4 v1, s[8:11], s83 offen offset:0 lds
    ds_read_b128 v[88:91], v2 offset:6144
    v_mfma_f32_32x32x16_bf16 v[16:31], a[228:231], v[68:71], v[16:31]
    s_add_u32 m0, s84, 28672
    s_nop 0
    buffer_load_dwordx4 v1, s[8:11], s83 offen offset:1024 lds
    ds_read_b128 v[64:67], v2 offset:7168
    s_waitcnt lgkmcnt(4)
    v_mfma_f32_32x32x16_bf16 v[16:31], a[232:235], v[72:75], v[16:31]
    ds_read_b128 v[68:71], v2 offset:8192
    v_mfma_f32_32x32x16_bf16 v[16:31], a[236:239], v[76:79], v[16:31]
    s_add_u32 m0, s84, 28672
    s_nop 0
    buffer_load_dwordx4 v1, s[8:11], s83 offen offset:2048 lds
    ds_read_b128 v[72:75], v2 offset:9216
    s_waitcnt lgkmcnt(4)
    v_mfma_f32_32x32x16_bf16 v[16:31], a[240:243], v[80:83], v[16:31]
    ds_read_b128 v[76:79], v2 offset:10240
    v_mfma_f32_32x32x16_bf16 v[16:31], a[244:247], v[84:87], v[16:31]
    s_add_u32 m0, s84, 28672
    s_nop 0
    buffer_load_dwordx4 v1, s[8:11], s83 offen offset:3072 lds
    ds_read_b128 v[80:83], v2 offset:11264
    s_waitcnt lgkmcnt(4)
    v_mfma_f32_32x32x16_bf16 v[16:31], a[248:251], v[88:91], v[16:31]
    ds_read_b128 v[84:87], v2 offset:12288
    v_mfma_f32_32x32x16_bf16 v[16:31], a[252:255], v[64:67], v[16:31]
    s_add_u32 s83, s83, 4096
    s_add_u32 m0, s84, 32768
    s_nop 0
    buffer_load_dwordx4 v1, s[8:11], s83 offen offset:0 lds
    ds_read_b128 v[88:91], v2 offset:13312
    s_waitcnt lgkmcnt(4)
    v_mfma_f32_32x32x16_bf16 v[16:31], v[176:179], v[68:71], v[16:31]
    ds_read_b128 v[64:67], v2 offset:14336
    v_mfma_f32_32x32x16_bf16 v[16:31], v[180:183], v[72:75], v[16:31]
    s_add_u32 m0, s84, 32768
    s_nop 0
    buffer_load_dwordx4 v1, s[8:11], s83 offen offset:1024 lds
    ds_read_b128 v[68:71], v2 offset:15360
    s_waitcnt lgkmcnt(4)
    v_mfma_f32_32x32x16_bf16 v[16:31], v[184:187], v[76:79], v[16:31]
    ds_read_b128 v[72:75], v2 offset:16384
    v_mfma_f32_32x32x16_bf16 v[16:31], v[188:191], v[80:83], v[16:31]
    s_add_u32 m0, s84, 32768
    s_nop 0
    buffer_load_dwordx4 v1, s[8:11], s83 offen offset:2048 lds
    ds_read_b128 v[76:79], v2 offset:17408
    s_waitcnt lgkmcnt(4)
    v_mfma_f32_32x32x16_bf16 v[16:31], v[192:195], v[84:87], v[16:31]
    ds_read_b128 v[80:83], v2 offset:18432
    v_mfma_f32_32x32x16_bf16 v[16:31], v[196:199], v[88:91], v[16:31]
    ds_read_b128 v[84:87], v2 offset:19456
    s_waitcnt lgkmcnt(4)
    v_mfma_f32_32x32x16_bf16 v[16:31], v[200:203], v[64:67], v[16:31]
    s_add_u32 s83, s85, 57344
    s_add_u32 m0, s84, 57344
    s_nop 0
    buffer_load_dwordx4 v1, s[8:11], s83 offen offset:0 lds
    ds_read_b128 v[88:91], v2 offset:20480
    v_mfma_f32_32x32x16_bf16 v[16:31], v[204:207], v[68:71], v[16:31]
    ds_read_b128 v[64:67], v2 offset:21504
    s_waitcnt lgkmcnt(4)
    v_mfma_f32_32x32x16_bf16 v[16:31], v[208:211], v[72:75], v[16:31]
    s_add_u32 m0, s84, 57344
    s_nop 0
    buffer_load_dwordx4 v1, s[8:11], s83 offen offset:1024 lds
    ds_read_b128 v[68:71], v2 offset:22528
    v_mfma_f32_32x32x16_bf16 v[16:31], v[212:215], v[76:79], v[16:31]
    ds_read_b128 v[72:75], v2 offset:23552
    s_waitcnt lgkmcnt(4)
    v_mfma_f32_32x32x16_bf16 v[16:31], v[216:219], v[80:83], v[16:31]
    s_add_u32 m0, s84, 57344
    s_nop 0
    buffer_load_dwordx4 v1, s[8:11], s83 offen offset:2048 lds
    ds_read_b128 v[76:79], v2 offset:24576
    v_mfma_f32_32x32x16_bf16 v[16:31], v[220:223], v[84:87], v[16:31]
    ds_read_b128 v[80:83], v2 offset:25600
    s_waitcnt lgkmcnt(4)
    v_mfma_f32_32x32x16_bf16 v[16:31], v[224:227], v[88:91], v[16:31]
    s_add_u32 m0, s84, 57344
    s_nop 0
    buffer_load_dwordx4 v1, s[8:11], s83 offen offset:3072 lds
    s_waitcnt vmcnt(4)
    ds_read_b128 v[84:87], v2 offset:26624
    v_mfma_f32_32x32x16_bf16 v[16:31], v[228:231], v[64:67], v[16:31]
    s_barrier
    ds_read_b128 v[88:91], v2 offset:27648
    s_waitcnt lgkmcnt(4)
    v_mfma_f32_32x32x16_bf16 v[16:31], v[232:235], v[68:71], v[16:31]
    s_add_u32 s83, s83, 4096
    s_add_u32 m0, s84, 61440
    s_nop 0
    buffer_load_dwordx4 v1, s[8:11], s83 offen offset:0 lds
    ds_read_b128 v[64:67], v2 offset:28672
    v_mfma_f32_32x32x16_bf16 v[16:31], v[236:239], v[72:75], v[16:31]
    ds_read_b128 v[68:71], v2 offset:29696
    s_waitcnt lgkmcnt(4)
    v_mfma_f32_32x32x16_bf16 v[16:31], v[240:243], v[76:79], v[16:31]
    s_add_u32 m0, s84, 61440
    s_nop 0
    buffer_load_dwordx4 v1, s[8:11], s83 offen offset:1024 lds
    ds_read_b128 v[72:75], v2 offset:30720
    v_mfma_f32_32x32x16_bf16 v[16:31], v[244:247], v[80:83], v[16:31]
    ds_read_b128 v[76:79], v2 offset:31744
    s_waitcnt lgkmcnt(4)
    v_mfma_f32_32x32x16_bf16 v[16:31], v[248:251], v[84:87], v[16:31]
    s_add_u32 m0, s84, 61440
    s_nop 0
    buffer_load_dwordx4 v1, s[8:11], s83 offen offset:2048 lds
    ds_read_b128 v[80:83], v2 offset:32768
    v_mfma_f32_32x32x16_bf16 v[16:31], v[252:255], v[88:91], v[16:31]
    s_mov_b32 s80, 0
GC_1_62:
    v_cmpx_eq_u64 vcc, s[96:97], v[94:95]
    v_cmpx_eq_u64 vcc, s[96:97], v[98:99]
    v_cmpx_eq_u64 vcc, s[96:97], v[102:103]
    v_cmpx_eq_u64 vcc, s[96:97], v[106:107]
    v_cmpx_eq_u64 vcc, s[96:97], v[110:111]
    v_cmpx_eq_u64 vcc, s[96:97], v[170:171]
    v_cmpx_eq_u64 vcc, s[96:97], v[174:175]
    s_nop 4
    s_cmp_eq_u64 exec, -1
    s_mov_b64 exec, -1
    s_cbranch_scc1 GCD_1_63
    buffer_load_dwordx4 v[92:95], v3, s[8:11], 0 offen offset:0 sc1
    buffer_load_dwordx4 v[96:99], v3, s[8:11], 0 offen offset:1024 sc1
    buffer_load_dwordx4 v[100:103], v3, s[8:11], 0 offen offset:2048 sc1
    buffer_load_dwordx4 v[104:107], v3, s[8:11], 0 offen offset:3072 sc1
    buffer_load_dwordx4 v[108:111], v3, s[8:11], s78 offen offset:0 sc1
    buffer_load_dwordx4 v[168:171], v3, s[8:11], s78 offen offset:1024 sc1
    buffer_load_dwordx4 v[172:175], v3, s[8:11], s78 offen offset:2048 sc1
    s_waitcnt vmcnt(0)
    s_add_u32 s80, s80, 1
    s_cmp_lt_u32 s80, 20000
    s_cbranch_scc0 GCD_1_63_to
    s_sleep 1
    s_branch GC_1_62
GCD_1_63_to:
    s_or_b32 s39, s39, 16
GCD_1_63:
    v_add_f32 v94, v92, v96
    v_add_f32 v95, v93, v97
    v_add_f32 v94, v94, v100
    v_add_f32 v95, v95, v101
    v_add_f32 v94, v94, v104
    v_add_f32 v95, v95, v105
    v_add_f32 v94, v94, v108
    v_add_f32 v95, v95, v109
    v_add_f32 v94, v94, v168
    v_add_f32 v95, v95, v169
    v_add_f32 v94, v94, v172
    v_add_f32 v95, v95, v173
    v_mov_b32 v98, v94
    v_mov_b32 v99, v95
    s_nop 0
    v_permlane32_swap_b32 v98, v94
    v_permlane32_swap_b32 v99, v95
    v_add_f32 v94, v94, v98
    v_add_f32 v95, v95, v99
    v_mul_f32 v100, 0x3b124925, v94
    v_mul_f32 v102, 0x3b124925, v95
    v_fma_f32 v102, -v100, v100, v102
    v_max_f32 v102, 0, v102
    v_add_f32 v102, 0x3727c5ac, v102
    v_rsq_f32 v101, v102
    s_nop 0
    v_mul_f32 v104, v100, v101
    v_lshlrev_b32 v105, 16, v124
    v_and_b32 v106, s77, v124
    v_fma_f32 v107, v32, v101, -v104
    v_fma_f32 v108, v33, v101, -v104
    v_fmac_f32 v32, v105, v107
    v_fmac_f32 v33, v106, v108
    v_lshlrev_b32 v105, 16, v125
    v_and_b32 v106, s77, v125
    v_fma_f32 v107, v34, v101, -v104
    v_fma_f32 v108, v35, v101, -v104
    v_fmac_f32 v34, v105, v107
    v_fmac_f32 v35, v106, v108
    v_lshlrev_b32 v105, 16, v126
    v_and_b32 v106, s77, v126
    v_fma_f32 v107, v36, v101, -v104
    v_fma_f32 v108, v37, v101, -v104
    v_fmac_f32 v36, v105, v107
    v_fmac_f32 v37, v106, v108
    v_lshlrev_b32 v105, 16, v127
    v_and_b32 v106, s77, v127
    v_fma_f32 v107, v38, v101, -v104
    v_fma_f32 v108, v39, v101, -v104
    v_fmac_f32 v38, v105, v107
    v_fmac_f32 v39, v106, v108
    v_cvt_pk_bf16_f32 v116, v32, v33
    v_cvt_pk_bf16_f32 v117, v34, v35
    v_cvt_pk_bf16_f32 v118, v36, v37
    v_cvt_pk_bf16_f32 v119, v38, v39
    s_add_u32 s80, s3, 7454720
    buffer_store_dwordx4 v[116:119], v1, s[8:11], s80 offen sc0 sc1
    v_add_f32 v168, v32, v33
    v_mul_f32 v169, v32, v32
    v_fmac_f32 v169, v33, v33
    v_add_f32 v168, v168, v34
    v_fmac_f32 v169, v34, v34
    v_add_f32 v168, v168, v35
    v_fmac_f32 v169, v35, v35
    v_add_f32 v168, v168, v36
    v_fmac_f32 v169, v36, v36
    v_add_f32 v168, v168, v37
    v_fmac_f32 v169, v37, v37
    v_add_f32 v168, v168, v38
    v_fmac_f32 v169, v38, v38
    v_add_f32 v168, v168, v39
    v_fmac_f32 v169, v39, v39
    v_mov_b32 v170, v168
    v_mov_b32 v171, v169
    s_nop 0
    v_permlane32_swap_b32 v170, v168
    v_permlane32_swap_b32 v171, v169
    v_add_f32 v168, v168, v170
    v_add_f32 v169, v169, v171
    s_waitcnt vmcnt(0)
    ds_write_b64 v14, v[168:169] offset:3072
    s_waitcnt lgkmcnt(0)
    s_barrier
    ds_read_b64 v[172:173], v14 offset:3584
    s_waitcnt lgkmcnt(0)
    s_cmp_eq_u32 s5, 0
    s_cbranch_scc0 GP_1_64
    v_add_f32 v168, v168, v172
    v_add_f32 v169, v169, v173
    v_mov_b32 v170, s100
    v_mov_b32 v171, s101
    s_add_u32 s80, s4, 24379392
    s_add_u32 s80, s80, 28672
    s_mov_b32 exec_hi, 0
    buffer_store_dwordx4 v[168:171], v1, s[8:11], s80 offen sc0 sc1
    s_mov_b32 exec_hi, -1
GP_1_64:
    ds_read_b128 v[84:87], v2 offset:33792
    v_mfma_f32_32x32x16_bf16 v[32:47], a[224:227], v[64:67], 0
    s_add_u32 s83, s85, 86016
    s_add_u32 m0, s84, 86016
    s_nop 0
    buffer_load_dwordx4 v1, s[8:11], s83 offen offset:0 lds
    ds_read_b64 v[152:153], v5 offset:0
    ds_read_b128 v[88:91], v2 offset:34816
    v_mfma_f32_32x32x16_bf16 v[32:47], a[228:231], v[68:71], v[32:47]
    ds_read_b128 v[64:67], v2 offset:35840
    v_mfma_f32_32x32x16_bf16 v[32:47], a[232:235], v[72:75], v[32:47]
    s_add_u32 m0, s84, 86016
    s_nop 0
    buffer_load_dwordx4 v1, s[8:11], s83 offen offset:1024 lds
    s_waitcnt lgkmcnt(2)
    ds_read_b128 v[68:71], v2 offset:36864
    v_mfma_f32_32x32x16_bf16 v[32:47], a[236:239], v[76:79], v[32:47]
    v_fma_f32 v128, -v152, v48, v16
    v_fma_f32 v136, -v152, v56, v24
    v_fma_f32 v129, -v152, v49, v17
    ds_read_b128 v[72:75], v2 offset:37888
    v_mfma_f32_32x32x16_bf16 v[32:47], a[240:243], v[80:83], v[32:47]
    v_fma_f32 v137, -v152, v57, v25
    v_mul_f32 v144, v128, v153
    v_mul_f32 v128, v128, v136
    v_fma_f32 v130, -v152, v50, v18
    ds_read_b128 v[76:79], v2 offset:38912
    v_mfma_f32_32x32x16_bf16 v[32:47], a[244:247], v[84:87], v[32:47]
    s_add_u32 m0, s84, 86016
    s_nop 0
    buffer_load_dwordx4 v1, s[8:11], s83 offen offset:2048 lds
    ds_read_b128 v[80:83], v2 offset:39936
    s_waitcnt lgkmcnt(4)
    v_mfma_f32_32x32x16_bf16 v[32:47], a[248:251], v[88:91], v[32:47]
    v_exp_f32 v144, v144
    v_fma_f32 v138, -v152, v58, v26
    v_mul_f32 v145, v129, v153
    ds_read_b128 v[84:87], v2 offset:40960
    v_mfma_f32_32x32x16_bf16 v[32:47], a[252:255], v[64:67], v[32:47]
    v_mul_f32 v129, v129, v137
    v_fma_f32 v131, -v152, v51, v19
    ds_read_b128 v[88:91], v2 offset:41984
    s_waitcnt lgkmcnt(4)
    v_mfma_f32_32x32x16_bf16 v[32:47], v[176:179], v[68:71], v[32:47]
    s_add_u32 m0, s84, 86016
    s_nop 0
    buffer_load_dwordx4 v1, s[8:11], s83 offen offset:3072 lds
    ds_read_b128 v[64:67], v2 offset:43008
    v_mfma_f32_32x32x16_bf16 v[32:47], v[180:183], v[72:75], v[32:47]
    v_exp_f32 v145, v145
    v_fma_f32 v139, -v152, v59, v27
    ds_read_b128 v[68:71], v2 offset:44032
    s_waitcnt lgkmcnt(4)
    v_mfma_f32_32x32x16_bf16 v[32:47], v[184:187], v[76:79], v[32:47]
    v_mul_f32 v146, v130, v153
    v_mul_f32 v130, v130, v138
    v_fma_f32 v132, -v152, v52, v20
    ds_read_b128 v[72:75], v2 offset:45056
    v_mfma_f32_32x32x16_bf16 v[32:47], v[188:191], v[80:83], v[32:47]
    s_add_u32 s83, s83, 4096
    s_add_u32 m0, s84, 90112
    s_nop 0
    buffer_load_dwordx4 v1, s[8:11], s83 offen offset:0 lds
    ds_read_b128 v[76:79], v2 offset:46080
    s_waitcnt lgkmcnt(4)
    v_mfma_f32_32x32x16_bf16 v[32:47], v[192:195], v[84:87], v[32:47]
    v_exp_f32 v146, v146
    v_fma_f32 v140, -v152, v60, v28
    v_mul_f32 v147, v131, v153
    ds_read_b128 v[80:83], v2 offset:47104
    v_mfma_f32_32x32x16_bf16 v[32:47], v[196:199], v[88:91], v[32:47]
    v_mul_f32 v131, v131, v139
    v_add_f32 v144, 1.0, v144
    v_fma_f32 v133, -v152, v53, v21
    ds_read_b128 v[84:87], v2 offset:48128
    s_waitcnt lgkmcnt(4)
    v_mfma_f32_32x32x16_bf16 v[32:47], v[200:203], v[64:67], v[32:47]
    s_add_u32 m0, s84, 90112
    s_nop 0
    buffer_load_dwordx4 v1, s[8:11], s83 offen offset:1024 lds
    ds_read_b128 v[88:91], v2 offset:49152
    v_mfma_f32_32x32x16_bf16 v[32:47], v[204:207], v[68:71], v[32:47]
    v_exp_f32 v147, v147
    v_fma_f32 v141, -v152, v61, v29
    ds_read_b128 v[64:67], v2 offset:50176
    s_waitcnt lgkmcnt(4)
    v_mfma_f32_32x32x16_bf16 v[32:47], v[208:211], v[72:75], v[32:47]
    v_mul_f32 v148, v132, v153
    v_rcp_f32 v144, v144
    v_mul_f32 v132, v132, v140
    ds_read_b128 v[68:71], v2 offset:51200
    v_mfma_f32_32x32x16_bf16 v[32:47], v[212:215], v[76:79], v[32:47]
    s_add_u32 m0, s84, 90112
    s_nop 0
    buffer_load_dwordx4 v1, s[8:11], s83 offen offset:2048 lds
    ds_read_b128 v[72:75], v2 offset:52224
    s_waitcnt lgkmcnt(4)
    v_mfma_f32_32x32x16_bf16 v[32:47], v[216:219], v[80:83], v[32:47]
    v_add_f32 v145, 1.0, v145
    v_fma_f32 v134, -v152, v54, v22
    v_exp_f32 v148, v148
    ds_read_b128 v[76:79], v2 offset:53248
    v_mfma_f32_32x32x16_bf16 v[32:47], v[220:223], v[84:87], v[32:47]
    v_fma_f32 v142, -v152, v62, v30
    v_mul_f32 v149, v133, v153
    ds_read_b128 v[80:83], v2 offset:54272
    s_waitcnt lgkmcnt(4)
    v_mfma_f32_32x32x16_bf16 v[32:47], v[224:227], v[88:91], v[32:47]
    v_rcp_f32 v145, v145
    v_mul_f32 v133, v133, v141
    ds_read_b128 v[84:87], v2 offset:55296
    v_mfma_f32_32x32x16_bf16 v[32:47], v[228:231], v[64:67], v[32:47]
    s_barrier
    v_add_f32 v146, 1.0, v146
    v_fma_f32 v135, -v152, v55, v23
    ds_read_b128 v[88:91], v2 offset:56320
    s_waitcnt lgkmcnt(4)
    v_mfma_f32_32x32x16_bf16 v[32:47], v[232:235], v[68:71], v[32:47]
    v_exp_f32 v149, v149
    v_fma_f32 v143, -v152, v63, v31
    v_mul_f32 v150, v134, v153
    ds_read_b128 v[64:67], v7 offset:0
    v_mfma_f32_32x32x16_bf16 v[32:47], v[236:239], v[72:75], v[32:47]
    v_rcp_f32 v146, v146
    v_mul_f32 v134, v134, v142
    ds_read_b128 v[68:71], v7 offset:1024
    s_waitcnt lgkmcnt(4)
    v_mfma_f32_32x32x16_bf16 v[32:47], v[240:243], v[76:79], v[32:47]
    v_add_f32 v147, 1.0, v147
    v_mul_f32 v136, v128, v144
    v_exp_f32 v150, v150
    ds_read_b128 v[72:75], v7 offset:2048
    v_mfma_f32_32x32x16_bf16 v[32:47], v[244:247], v[80:83], v[32:47]
    v_mul_f32 v151, v135, v153
    v_rcp_f32 v147, v147
    ds_read_b128 v[76:79], v7 offset:3072
    s_waitcnt lgkmcnt(4)
    v_mfma_f32_32x32x16_bf16 v[32:47], v[248:251], v[84:87], v[32:47]
    v_mul_f32 v135, v135, v143
    v_add_f32 v148, 1.0, v148
    v_mul_f32 v137, v129, v145
    ds_read_b128 v[80:83], v7 offset:4096
    v_mfma_f32_32x32x16_bf16 v[32:47], v[252:255], v[88:91], v[32:47]
    v_exp_f32 v151, v151
    v_rcp_f32 v148, v148
    v_add_f32 v149, 1.0, v149
    v_mul_f32 v138, v130, v146
    v_cvt_pk_bf16_f32 v156, v136, v137
    v_rcp_f32 v149, v149
    v_add_f32 v150, 1.0, v150
    v_mul_f32 v139, v131, v147
    v_rcp_f32 v150, v150
    v_add_f32 v151, 1.0, v151
    v_mul_f32 v140, v132, v148
    v_cvt_pk_bf16_f32 v157, v138, v139
    v_rcp_f32 v151, v151
    v_mul_f32 v141, v133, v149
    v_mul_f32 v142, v134, v150
    v_cvt_pk_bf16_f32 v158, v140, v141
    v_mul_f32 v143, v135, v151
    v_cvt_pk_bf16_f32 v159, v142, v143
    s_add_u32 s82, s79, 0
    buffer_store_dwordx4 v[156:159], v1, s[8:11], s82 offen sc0 sc1
    ds_read_b128 v[84:87], v7 offset:5120
    s_waitcnt lgkmcnt(4)
    v_mfma_f32_32x32x16_bf16 v[16:31], a[224:227], v[64:67], 0
    ds_read_b64 v[152:153], v5 offset:512
    ds_read_b128 v[88:91], v7 offset:6144
    v_mfma_f32_32x32x16_bf16 v[16:31], a[228:231], v[68:71], v[16:31]
    ds_read_b128 v[64:67], v7 offset:7168
    s_waitcnt lgkmcnt(5)
    v_mfma_f32_32x32x16_bf16 v[16:31], a[232:235], v[72:75], v[16:31]
    s_waitcnt lgkmcnt(2)
    v_fma_f32 v128, -v152, v48, v32
    v_fma_f32 v136, -v152, v56, v40
    v_fma_f32 v129, -v152, v49, v33
    ds_read_b128 v[68:71], v7 offset:8192
    v_mfma_f32_32x32x16_bf16 v[16:31], a[236:239], v[76:79], v[16:31]
    v_fma_f32 v137, -v152, v57, v41
    v_mul_f32 v144, v128, v153
    v_mul_f32 v128, v128, v136
    ds_read_b128 v[72:75], v7 offset:9216
    v_mfma_f32_32x32x16_bf16 v[16:31], a[240:243], v[80:83], v[16:31]
    v_fma_f32 v130, -v152, v50, v34
    v_exp_f32 v144, v144
    v_fma_f32 v138, -v152, v58, v42
    ds_read_b128 v[76:79], v7 offset:10240
    v_mfma_f32_32x32x16_bf16 v[16:31], a[244:247], v[84:87], v[16:31]
    v_mul_f32 v145, v129, v153
    v_mul_f32 v129, v129, v137
    v_fma_f32 v131, -v152, v51, v35
    ds_read_b128 v[80:83], v7 offset:11264
    s_waitcnt lgkmcnt(4)
    v_mfma_f32_32x32x16_bf16 v[16:31], a[248:251], v[88:91], v[16:31]
    buffer_load_dwordx4 v[92:95], v4, s[8:11], 0 offen offset:0 sc1
    ds_read_b128 v[84:87], v7 offset:12288
    v_mfma_f32_32x32x16_bf16 v[16:31], a[252:255], v[64:67], v[16:31]
    v_exp_f32 v145, v145
    v_fma_f32 v139, -v152, v59, v43
    ds_read_b128 v[88:91], v7 offset:13312
    s_waitcnt lgkmcnt(4)
    v_mfma_f32_32x32x16_bf16 v[16:31], v[176:179], v[68:71], v[16:31]
    buffer_load_dwordx4 v[96:99], v4, s[8:11], 0 offen offset:1024 sc1
    v_mul_f32 v146, v130, v153
    ds_read_b128 v[64:67], v7 offset:14336
    v_mfma_f32_32x32x16_bf16 v[16:31], v[180:183], v[72:75], v[16:31]
    v_mul_f32 v130, v130, v138
    v_fma_f32 v132, -v152, v52, v36
    ds_read_b128 v[68:71], v7 offset:15360
    s_waitcnt lgkmcnt(4)
    v_mfma_f32_32x32x16_bf16 v[16:31], v[184:187], v[76:79], v[16:31]
    buffer_load_dwordx4 v[100:103], v4, s[8:11], 0 offen offset:2048 sc1
    ds_read_b128 v[72:75], v7 offset:16384
    v_mfma_f32_32x32x16_bf16 v[16:31], v[188:191], v[80:83], v[16:31]
    v_exp_f32 v146, v146
    v_fma_f32 v140, -v152, v60, v44
    ds_read_b128 v[76:79], v7 offset:17408
    s_waitcnt lgkmcnt(4)
    v_mfma_f32_32x32x16_bf16 v[16:31], v[192:195], v[84:87], v[16:31]
    buffer_load_dwordx4 v[104:107], v4, s[8:11], 0 offen offset:3072 sc1
    v_mul_f32 v147, v131, v153
    ds_read_b128 v[80:83], v7 offset:18432
    v_mfma_f32_32x32x16_bf16 v[16:31], v[196:199], v[88:91], v[16:31]
    v_mul_f32 v131, v131, v139
    v_add_f32 v144, 1.0, v144
    v_fma_f32 v133, -v152, v53, v37
    ds_read_b128 v[84:87], v7 offset:19456
    s_waitcnt lgkmcnt(4)
    v_mfma_f32_32x32x16_bf16 v[16:31], v[200:203], v[64:67], v[16:31]
    buffer_load_dwordx4 v[108:111], v4, s[8:11], s78 offen offset:0 sc1
    ds_read_b128 v[88:91], v7 offset:20480
    v_mfma_f32_32x32x16_bf16 v[16:31], v[204:207], v[68:71], v[16:31]
    v_exp_f32 v147, v147
    v_fma_f32 v141, -v152, v61, v45
    ds_read_b128 v[64:67], v7 offset:21504
    s_waitcnt lgkmcnt(4)
    v_mfma_f32_32x32x16_bf16 v[16:31], v[208:211], v[72:75], v[16:31]
    buffer_load_dwordx4 v[168:171], v4, s[8:11], s78 offen offset:1024 sc1
    v_mul_f32 v148, v132, v153
    ds_read_b128 v[68:71], v7 offset:22528
    v_mfma_f32_32x32x16_bf16 v[16:31], v[212:215], v[76:79], v[16:31]
    v_rcp_f32 v144, v144
    v_mul_f32 v132, v132, v140
    ds_read_b128 v[72:75], v7 offset:23552
    s_waitcnt lgkmcnt(4)
    v_mfma_f32_32x32x16_bf16 v[16:31], v[216:219], v[80:83], v[16:31]
    buffer_load_dwordx4 v[172:175], v4, s[8:11], s78 offen offset:2048 sc1
    v_add_f32 v145, 1.0, v145
    ds_read_b128 v[76:79], v7 offset:24576
    v_mfma_f32_32x32x16_bf16 v[16:31], v[220:223], v[84:87], v[16:31]
    v_fma_f32 v134, -v152, v54, v38
    v_exp_f32 v148, v148
    ds_read_b128 v[80:83], v7 offset:25600
    s_waitcnt lgkmcnt(4)
    v_mfma_f32_32x32x16_bf16 v[16:31], v[224:227], v[88:91], v[16:31]
    s_waitcnt vmcnt(7)
    buffer_store_dwordx2 v[10:11], v8, s[8:11], 0 offen offset:0 sc0 sc1
    ds_read_b128 v[84:87], v7 offset:26624
    v_mfma_f32_32x32x16_bf16 v[16:31], v[228:231], v[64:67], v[16:31]
    s_barrier
    v_fma_f32 v142, -v152, v62, v46
    v_mul_f32 v149, v133, v153
    ds_read_b128 v[88:91], v7 offset:27648
    s_waitcnt lgkmcnt(4)
    v_mfma_f32_32x32x16_bf16 v[16:31], v[232:235], v[68:71], v[16:31]
    v_rcp_f32 v145, v145
    v_mul_f32 v133, v133, v141
    v_add_f32 v146, 1.0, v146
    ds_read_b128 v[64:67], v7 offset:28672
    v_mfma_f32_32x32x16_bf16 v[16:31], v[236:239], v[72:75], v[16:31]
    v_fma_f32 v135, -v152, v55, v39
    v_exp_f32 v149, v149
    ds_read_b128 v[68:71], v7 offset:29696
    s_waitcnt lgkmcnt(4)
    v_mfma_f32_32x32x16_bf16 v[16:31], v[240:243], v[76:79], v[16:31]
    v_fma_f32 v143, -v152, v63, v47
    v_mul_f32 v150, v134, v153
    v_rcp_f32 v146, v146
    ds_read_b128 v[72:75], v7 offset:30720
    v_mfma_f32_32x32x16_bf16 v[16:31], v[244:247], v[80:83], v[16:31]
    v_mul_f32 v134, v134, v142
    v_add_f32 v147, 1.0, v147
    v_mul_f32 v136, v128, v144
    ds_read_b128 v[76:79], v7 offset:31744
    s_waitcnt lgkmcnt(4)
    v_mfma_f32_32x32x16_bf16 v[16:31], v[248:251], v[84:87], v[16:31]
    v_exp_f32 v150, v150
    v_mul_f32 v151, v135, v153
    ds_read_b128 v[80:83], v7 offset:32768
    v_mfma_f32_32x32x16_bf16 v[16:31], v[252:255], v[88:91], v[16:31]
    s_waitcnt vmcnt(1)
    s_mov_b32 s80, 0
GC_1_65:
    v_cmpx_eq_u64 vcc, s[100:101], v[94:95]
    v_cmpx_eq_u64 vcc, s[100:101], v[98:99]
    v_cmpx_eq_u64 vcc, s[100:101], v[102:103]
    v_cmpx_eq_u64 vcc, s[100:101], v[106:107]
    v_cmpx_eq_u64 vcc, s[100:101], v[110:111]
    v_cmpx_eq_u64 vcc, s[100:101], v[170:171]
    v_cmpx_eq_u64 vcc, s[100:101], v[174:175]
    s_nop 4
    s_cmp_eq_u64 exec, -1
    s_mov_b64 exec, -1
    s_cbranch_scc1 GCD_1_66
    buffer_load_dwordx4 v[92:95], v4, s[8:11], 0 offen offset:0 sc1
    buffer_load_dwordx4 v[96:99], v4, s[8:11], 0 offen offset:1024 sc1
    buffer_load_dwordx4 v[100:103], v4, s[8:11], 0 offen offset:2048 sc1
    buffer_load_dwordx4 v[104:107], v4, s[8:11], 0 offen offset:3072 sc1
    buffer_load_dwordx4 v[108:111], v4, s[8:11], s78 offen offset:0 sc1
    buffer_load_dwordx4 v[168:171], v4, s[8:11], s78 offen offset:1024 sc1
    buffer_load_dwordx4 v[172:175], v4, s[8:11], s78 offen offset:2048 sc1
    s_waitcnt vmcnt(0)
    s_add_u32 s80, s80, 1
    s_cmp_lt_u32 s80, 20000
    s_cbranch_scc0 GCD_1_66_to
    s_sleep 1
    s_branch GC_1_65
GCD_1_66_to:
    s_or_b32 s39, s39, 64
GCD_1_66:
    v_rcp_f32 v147, v147
    v_mul_f32 v135, v135, v143
    v_add_f32 v148, 1.0, v148
    v_mul_f32 v137, v129, v145
    v_exp_f32 v151, v151
    v_rcp_f32 v148, v148
    v_add_f32 v149, 1.0, v149
    v_mul_f32 v138, v130, v146
    v_cvt_pk_bf16_f32 v156, v136, v137
    v_rcp_f32 v149, v149
    v_add_f32 v150, 1.0, v150
    v_mul_f32 v139, v131, v147
    v_rcp_f32 v150, v150
    v_add_f32 v151, 1.0, v151
    v_mul_f32 v140, v132, v148
    v_cvt_pk_bf16_f32 v157, v138, v139
    v_rcp_f32 v151, v151
    v_mul_f32 v141, v133, v149
    v_mul_f32 v142, v134, v150
    v_cvt_pk_bf16_f32 v158, v140, v141
    v_mul_f32 v143, v135, v151
    v_cvt_pk_bf16_f32 v159, v142, v143
    s_add_u32 s82, s79, 114688
    buffer_store_dwordx4 v[156:159], v1, s[8:11], s82 offen sc0 sc1
    ds_read_b128 v[84:87], v7 offset:33792
    s_waitcnt lgkmcnt(4)
    v_mfma_f32_32x32x16_bf16 v[32:47], a[224:227], v[64:67], 0
    s_barrier
    ds_read_b64 v[152:153], v5 offset:1024
    ds_read_b128 v[88:91], v7 offset:34816
    v_mfma_f32_32x32x16_bf16 v[32:47], a[228:231], v[68:71], v[32:47]
    s_add_u32 s83, s85, 114688
    s_add_u32 m0, s84, 0
    s_nop 0
    buffer_load_dwordx4 v1, s[8:11], s83 offen offset:0 lds
    ds_read_b128 v[64:67], v7 offset:35840
    s_waitcnt lgkmcnt(5)
    v_mfma_f32_32x32x16_bf16 v[32:47], a[232:235], v[72:75], v[32:47]
    s_add_u32 m0, s84, 0
    s_nop 0
    buffer_load_dwordx4 v1, s[8:11], s83 offen offset:1024 lds
    v_add_f32 v94, v92, v96
    ds_read_b128 v[68:71], v7 offset:36864
    v_mfma_f32_32x32x16_bf16 v[32:47], a[236:239], v[76:79], v[32:47]
    v_add_f32 v95, v93, v97
    v_add_f32 v94, v94, v100
    v_add_f32 v95, v95, v101
    ds_read_b128 v[72:75], v7 offset:37888
    s_waitcnt lgkmcnt(5)
    v_mfma_f32_32x32x16_bf16 v[32:47], a[240:243], v[80:83], v[32:47]
    s_add_u32 m0, s84, 0
    s_nop 0
    buffer_load_dwordx4 v1, s[8:11], s83 offen offset:2048 lds
    v_add_f32 v94, v94, v104
    ds_read_b128 v[76:79], v7 offset:38912
    v_mfma_f32_32x32x16_bf16 v[32:47], a[244:247], v[84:87], v[32:47]
    v_add_f32 v95, v95, v105
    v_add_f32 v94, v94, v108
    v_add_f32 v95, v95, v109
    ds_read_b128 v[80:83], v7 offset:39936
    s_waitcnt lgkmcnt(4)
    v_mfma_f32_32x32x16_bf16 v[32:47], a[248:251], v[88:91], v[32:47]
    s_add_u32 m0, s84, 0
    s_nop 0
    buffer_load_dwordx4 v1, s[8:11], s83 offen offset:3072 lds
    v_add_f32 v94, v94, v168
    ds_read_b128 v[84:87], v7 offset:40960
    v_mfma_f32_32x32x16_bf16 v[32:47], a[252:255], v[64:67], v[32:47]
    s_add_u32 s83, s83, 4096
    s_add_u32 m0, s84, 4096
    s_nop 0
    buffer_load_dwordx4 v1, s[8:11], s83 offen offset:0 lds
    ds_read_b128 v[88:91], v7 offset:41984
    s_waitcnt lgkmcnt(4)
    v_mfma_f32_32x32x16_bf16 v[32:47], v[176:179], v[68:71], v[32:47]
    v_add_f32 v95, v95, v169
    v_add_f32 v94, v94, v172
    v_add_f32 v95, v95, v173
    v_mov_b32 v98, v94
    ds_read_b128 v[64:67], v7 offset:43008
    v_mfma_f32_32x32x16_bf16 v[32:47], v[180:183], v[72:75], v[32:47]
    s_add_u32 m0, s84, 4096
    s_nop 0
    buffer_load_dwordx4 v1, s[8:11], s83 offen offset:1024 lds
    ds_read_b128 v[68:71], v7 offset:44032
    s_waitcnt lgkmcnt(4)
    v_mfma_f32_32x32x16_bf16 v[32:47], v[184:187], v[76:79], v[32:47]
    v_mov_b32 v99, v95
    s_nop 0
    v_permlane32_swap_b32 v98, v94
    v_permlane32_swap_b32 v99, v95
    ds_read_b128 v[72:75], v7 offset:45056
    v_mfma_f32_32x32x16_bf16 v[32:47], v[188:191], v[80:83], v[32:47]
    s_add_u32 m0, s84, 4096
    s_nop 0
    buffer_load_dwordx4 v1, s[8:11], s83 offen offset:2048 lds
    ds_read_b128 v[76:79], v7 offset:46080
    s_waitcnt lgkmcnt(4)
    v_mfma_f32_32x32x16_bf16 v[32:47], v[192:195], v[84:87], v[32:47]
    v_add_f32 v94, v94, v98
    v_add_f32 v95, v95, v99
    v_mul_f32 v100, 0x3b124925, v94
    v_mul_f32 v105, 0x3b124925, v95
    ds_read_b128 v[80:83], v7 offset:47104
    v_mfma_f32_32x32x16_bf16 v[32:47], v[196:199], v[88:91], v[32:47]
    v_fma_f32 v105, -v100, v100, v105
    v_max_f32 v105, 0, v105
    v_add_f32 v105, 0x3727c5ac, v105
    ds_read_b128 v[84:87], v7 offset:48128
    s_waitcnt lgkmcnt(4)
    v_mfma_f32_32x32x16_bf16 v[32:47], v[200:203], v[64:67], v[32:47]
    s_add_u32 s83, s85, 143360
    s_add_u32 m0, s84, 28672
    s_nop 0
    buffer_load_dwordx4 v1, s[8:11], s83 offen offset:0 lds
    ds_read_b128 v[88:91], v7 offset:49152
    v_mfma_f32_32x32x16_bf16 v[32:47], v[204:207], v[68:71], v[32:47]
    v_rsq_f32 v104, v105
    v_mov_b32 v103, 0
    ds_read_b128 v[64:67], v7 offset:50176
    s_waitcnt lgkmcnt(4)
    v_mfma_f32_32x32x16_bf16 v[32:47], v[208:211], v[72:75], v[32:47]
    s_add_u32 m0, s84, 28672
    s_nop 0
    buffer_load_dwordx4 v1, s[8:11], s83 offen offset:1024 lds
    v_mul_f32 v101, 0xbfb8aa3b, v104
    ds_read_b128 v[68:71], v7 offset:51200
    v_mfma_f32_32x32x16_bf16 v[32:47], v[212:215], v[76:79], v[32:47]
    v_mul_f32 v102, v104, v104
    v_fma_f32 v128, -v152, v48, v16
    ds_read_b128 v[72:75], v7 offset:52224
    s_waitcnt lgkmcnt(4)
    v_mfma_f32_32x32x16_bf16 v[32:47], v[216:219], v[80:83], v[32:47]
    s_add_u32 m0, s84, 28672
    s_nop 0
    buffer_load_dwordx4 v1, s[8:11], s83 offen offset:2048 lds
    v_fma_f32 v136, -v152, v56, v24
    ds_read_b128 v[76:79], v7 offset:53248
    v_mfma_f32_32x32x16_bf16 v[32:47], v[220:223], v[84:87], v[32:47]
    s_lshl_b32 s80, s36, 9
    v_add_u32 v108, s80, v5
    ds_write_b128 v108, v[100:103] offset:2048
    ds_read_b128 v[80:83], v7 offset:54272
    s_waitcnt lgkmcnt(5)
    v_mfma_f32_32x32x16_bf16 v[32:47], v[224:227], v[88:91], v[32:47]
    s_add_u32 m0, s84, 28672
    s_nop 0
    buffer_load_dwordx4 v1, s[8:11], s83 offen offset:3072 lds
    s_waitcnt vmcnt(11)
    buffer_store_dwordx2 v[10:11], v8, s[8:11], 0 offen offset:896 sc0 sc1
    s_waitcnt vmcnt(5)
    ds_read_b128 v[84:87], v7 offset:55296
    v_mfma_f32_32x32x16_bf16 v[32:47], v[228:231], v[64:67], v[32:47]
    s_barrier
    v_fma_f32 v129, -v152, v49, v17
    v_fma_f32 v137, -v152, v57, v25
    ds_read_b128 v[88:91], v7 offset:56320
    s_waitcnt lgkmcnt(5)
    v_mfma_f32_32x32x16_bf16 v[32:47], v[232:235], v[68:71], v[32:47]
    s_add_u32 s83, s83, 4096
    s_add_u32 m0, s84, 32768
    s_nop 0
    buffer_load_dwordx4 v1, s[8:11], s83 offen offset:0 lds
    ds_read_b128 v[64:67], v2 offset:0
    v_mfma_f32_32x32x16_bf16 v[32:47], v[236:239], v[72:75], v[32:47]
    v_mul_f32 v144, v128, v153
    v_mul_f32 v128, v128, v136
    v_fma_f32 v130, -v152, v50, v18
    ds_read_b128 v[68:71], v2 offset:1024
    s_waitcnt lgkmcnt(4)
    v_mfma_f32_32x32x16_bf16 v[32:47], v[240:243], v[76:79], v[32:47]
    s_add_u32 m0, s84, 32768
    s_nop 0
    buffer_load_dwordx4 v1, s[8:11], s83 offen offset:1024 lds
    ds_read_b128 v[72:75], v2 offset:2048
    v_mfma_f32_32x32x16_bf16 v[32:47], v[244:247], v[80:83], v[32:47]
    v_exp_f32 v144, v144
    v_fma_f32 v138, -v152, v58, v26
    ds_read_b128 v[76:79], v2 offset:3072
    s_waitcnt lgkmcnt(4)
    v_mfma_f32_32x32x16_bf16 v[32:47], v[248:251], v[84:87], v[32:47]
    s_add_u32 m0, s84, 32768
    s_nop 0
    buffer_load_dwordx4 v1, s[8:11], s83 offen offset:2048 lds
    v_mul_f32 v145, v129, v153
    ds_read_b128 v[80:83], v2 offset:4096
    v_mfma_f32_32x32x16_bf16 v[32:47], v[252:255], v[88:91], v[32:47]
    v_mul_f32 v129, v129, v137
    v_fma_f32 v131, -v152, v51, v19
    v_exp_f32 v145, v145
    v_fma_f32 v139, -v152, v59, v27
    v_mul_f32 v146, v130, v153
    v_mul_f32 v130, v130, v138
    v_fma_f32 v132, -v152, v52, v20
    v_exp_f32 v146, v146
    v_fma_f32 v140, -v152, v60, v28
    v_mul_f32 v147, v131, v153
    v_mul_f32 v131, v131, v139
    v_add_f32 v144, 1.0, v144
    v_fma_f32 v133, -v152, v53, v21
    v_exp_f32 v147, v147
    v_fma_f32 v141, -v152, v61, v29
    v_mul_f32 v148, v132, v153
    v_rcp_f32 v144, v144
    v_mul_f32 v132, v132, v140
    v_add_f32 v145, 1.0, v145
    v_fma_f32 v134, -v152, v54, v22
    v_exp_f32 v148, v148
    v_fma_f32 v142, -v152, v62, v30
    v_mul_f32 v149, v133, v153
    v_rcp_f32 v145, v145
    v_mul_f32 v133, v133, v141
    v_add_f32 v146, 1.0, v146
    v_fma_f32 v135, -v152, v55, v23
    v_exp_f32 v149, v149
    v_fma_f32 v143, -v152, v63, v31
    v_mul_f32 v150, v134, v153
    v_rcp_f32 v146, v146
    v_mul_f32 v134, v134, v142
    v_add_f32 v147, 1.0, v147
    v_mul_f32 v136, v128, v144
    v_exp_f32 v150, v150
    v_mul_f32 v151, v135, v153
    v_rcp_f32 v147, v147
    v_mul_f32 v135, v135, v143
    v_add_f32 v148, 1.0, v148
    v_mul_f32 v137, v129, v145
    v_exp_f32 v151, v151
    v_rcp_f32 v148, v148
    v_add_f32 v149, 1.0, v149
    v_mul_f32 v138, v130, v146
    v_cvt_pk_bf16_f32 v156, v136, v137
    v_rcp_f32 v149, v149
    v_add_f32 v150, 1.0, v150
    v_mul_f32 v139, v131, v147
    v_rcp_f32 v150, v150
    v_add_f32 v151, 1.0, v151
    v_mul_f32 v140, v132, v148
    v_cvt_pk_bf16_f32 v157, v138, v139
    v_rcp_f32 v151, v151
    v_mul_f32 v141, v133, v149
    v_mul_f32 v142, v134, v150
    v_cvt_pk_bf16_f32 v158, v140, v141
    v_mul_f32 v143, v135, v151
    v_cvt_pk_bf16_f32 v159, v142, v143
    s_add_u32 s82, s79, 229376
    buffer_store_dwordx4 v[156:159], v1, s[8:11], s82 offen sc0 sc1
    ds_read_b128 v[84:87], v2 offset:5120
    s_waitcnt lgkmcnt(4)
    v_mfma_f32_32x32x16_bf16 v[16:31], a[224:227], v[64:67], 0
    s_add_u32 s83, s85, 172032
    s_add_u32 m0, s84, 57344
    s_nop 0
    buffer_load_dwordx4 v1, s[8:11], s83 offen offset:0 lds
    ds_read_b64 v[152:153], v5 offset:1536
    ds_read_b128 v[88:91], v2 offset:6144
    v_mfma_f32_32x32x16_bf16 v[16:31], a[228:231], v[68:71], v[16:31]
    ds_read_b128 v[64:67], v2 offset:7168
    s_waitcnt lgkmcnt(5)
    v_mfma_f32_32x32x16_bf16 v[16:31], a[232:235], v[72:75], v[16:31]
    s_add_u32 m0, s84, 57344
    s_nop 0
    buffer_load_dwordx4 v1, s[8:11], s83 offen offset:1024 lds
    s_waitcnt lgkmcnt(2)
    ds_read_b128 v[68:71], v2 offset:8192
    v_mfma_f32_32x32x16_bf16 v[16:31], a[236:239], v[76:79], v[16:31]
    v_fma_f32 v128, -v152, v48, v32
    v_fma_f32 v136, -v152, v56, v40
    v_fma_f32 v129, -v152, v49, v33
    ds_read_b128 v[72:75], v2 offset:9216
    v_mfma_f32_32x32x16_bf16 v[16:31], a[240:243], v[80:83], v[16:31]
    v_fma_f32 v137, -v152, v57, v41
    v_mul_f32 v144, v128, v153
    v_mul_f32 v128, v128, v136
    v_fma_f32 v130, -v152, v50, v34
    ds_read_b128 v[76:79], v2 offset:10240
    v_mfma_f32_32x32x16_bf16 v[16:31], a[244:247], v[84:87], v[16:31]
    s_add_u32 m0, s84, 57344
    s_nop 0
    buffer_load_dwordx4 v1, s[8:11], s83 offen offset:2048 lds
    ds_read_b128 v[80:83], v2 offset:11264
    s_waitcnt lgkmcnt(4)
    v_mfma_f32_32x32x16_bf16 v[16:31], a[248:251], v[88:91], v[16:31]
    v_exp_f32 v144, v144
    v_fma_f32 v138, -v152, v58, v42
    v_mul_f32 v145, v129, v153
    ds_read_b128 v[84:87], v2 offset:12288
    v_mfma_f32_32x32x16_bf16 v[16:31], a[252:255], v[64:67], v[16:31]
    v_mul_f32 v129, v129, v137
    v_fma_f32 v131, -v152, v51, v35
    ds_read_b128 v[88:91], v2 offset:13312
    s_waitcnt lgkmcnt(4)
    v_mfma_f32_32x32x16_bf16 v[16:31], v[176:179], v[68:71], v[16:31]
    s_add_u32 m0, s84, 57344
    s_nop 0
    buffer_load_dwordx4 v1, s[8:11], s83 offen offset:3072 lds
    ds_read_b128 v[64:67], v2 offset:14336
    v_mfma_f32_32x32x16_bf16 v[16:31], v[180:183], v[72:75], v[16:31]
    v_exp_f32 v145, v145
    v_fma_f32 v139, -v152, v59, v43
    ds_read_b128 v[68:71], v2 offset:15360
    s_waitcnt lgkmcnt(4)
    v_mfma_f32_32x32x16_bf16 v[16:31], v[184:187], v[76:79], v[16:31]
    v_mul_f32 v146, v130, v153
    v_mul_f32 v130, v130, v138
    v_fma_f32 v132, -v152, v52, v36
    ds_read_b128 v[72:75], v2 offset:16384
    v_mfma_f32_32x32x16_bf16 v[16:31], v[188:191], v[80:83], v[16:31]
    s_add_u32 s83, s83, 4096
    s_add_u32 m0, s84, 61440
    s_nop 0
    buffer_load_dwordx4 v1, s[8:11], s83 offen offset:0 lds
    ds_read_b128 v[76:79], v2 offset:17408
    s_waitcnt lgkmcnt(4)
    v_mfma_f32_32x32x16_bf16 v[16:31], v[192:195], v[84:87], v[16:31]
    v_exp_f32 v146, v146
    v_fma_f32 v140, -v152, v60, v44
    v_mul_f32 v147, v131, v153
    ds_read_b128 v[80:83], v2 offset:18432
    v_mfma_f32_32x32x16_bf16 v[16:31], v[196:199], v[88:91], v[16:31]
    v_mul_f32 v131, v131, v139
    v_add_f32 v144, 1.0, v144
    v_fma_f32 v133, -v152, v53, v37
    ds_read_b128 v[84:87], v2 offset:19456
    s_waitcnt lgkmcnt(4)
    v_mfma_f32_32x32x16_bf16 v[16:31], v[200:203], v[64:67], v[16:31]
    s_add_u32 m0, s84, 61440
    s_nop 0
    buffer_load_dwordx4 v1, s[8:11], s83 offen offset:1024 lds
    ds_read_b128 v[88:91], v2 offset:20480
    v_mfma_f32_32x32x16_bf16 v[16:31], v[204:207], v[68:71], v[16:31]
    v_exp_f32 v147, v147
    v_fma_f32 v141, -v152, v61, v45
    ds_read_b128 v[64:67], v2 offset:21504
    s_waitcnt lgkmcnt(4)
    v_mfma_f32_32x32x16_bf16 v[16:31], v[208:211], v[72:75], v[16:31]
    v_mul_f32 v148, v132, v153
    v_rcp_f32 v144, v144
    v_mul_f32 v132, v132, v140
    ds_read_b128 v[68:71], v2 offset:22528
    v_mfma_f32_32x32x16_bf16 v[16:31], v[212:215], v[76:79], v[16:31]
    s_add_u32 m0, s84, 61440
    s_nop 0
    buffer_load_dwordx4 v1, s[8:11], s83 offen offset:2048 lds
    ds_read_b128 v[72:75], v2 offset:23552
    s_waitcnt lgkmcnt(4)
    v_mfma_f32_32x32x16_bf16 v[16:31], v[216:219], v[80:83], v[16:31]
    v_add_f32 v145, 1.0, v145
    v_fma_f32 v134, -v152, v54, v38
    v_exp_f32 v148, v148
    ds_read_b128 v[76:79], v2 offset:24576
    v_mfma_f32_32x32x16_bf16 v[16:31], v[220:223], v[84:87], v[16:31]
    v_fma_f32 v142, -v152, v62, v46
    v_mul_f32 v149, v133, v153
    ds_read_b128 v[80:83], v2 offset:25600
    s_waitcnt lgkmcnt(4)
    v_mfma_f32_32x32x16_bf16 v[16:31], v[224:227], v[88:91], v[16:31]
    s_waitcnt vmcnt(7)
    buffer_store_dwordx2 v[10:11], v8, s[8:11], 0 offen offset:1792 sc0 sc1
    ds_read_b128 v[84:87], v2 offset:26624
    v_mfma_f32_32x32x16_bf16 v[16:31], v[228:231], v[64:67], v[16:31]
    s_barrier
    v_rcp_f32 v145, v145
    ds_read_b128 v[88:91], v2 offset:27648
    s_waitcnt lgkmcnt(4)
    v_mfma_f32_32x32x16_bf16 v[16:31], v[232:235], v[68:71], v[16:31]
    v_mul_f32 v133, v133, v141
    v_add_f32 v146, 1.0, v146
    v_fma_f32 v135, -v152, v55, v39
    ds_read_b128 v[64:67], v2 offset:28672
    v_mfma_f32_32x32x16_bf16 v[16:31], v[236:239], v[72:75], v[16:31]
    v_exp_f32 v149, v149
    v_fma_f32 v143, -v152, v63, v47
    ds_read_b128 v[68:71], v2 offset:29696
    s_waitcnt lgkmcnt(4)
    v_mfma_f32_32x32x16_bf16 v[16:31], v[240:243], v[76:79], v[16:31]
    v_mul_f32 v150, v134, v153
    v_rcp_f32 v146, v146
    v_mul_f32 v134, v134, v142
    ds_read_b128 v[72:75], v2 offset:30720
    v_mfma_f32_32x32x16_bf16 v[16:31], v[244:247], v[80:83], v[16:31]
    v_add_f32 v147, 1.0, v147
    v_mul_f32 v136, v128, v144
    ds_read_b128 v[76:79], v2 offset:31744
    s_waitcnt lgkmcnt(4)
    v_mfma_f32_32x32x16_bf16 v[16:31], v[248:251], v[84:87], v[16:31]
    v_exp_f32 v150, v150
    v_mul_f32 v151, v135, v153
    ds_read_b128 v[80:83], v2 offset:32768
    v_mfma_f32_32x32x16_bf16 v[16:31], v[252:255], v[88:91], v[16:31]
    v_rcp_f32 v147, v147
    v_mul_f32 v135, v135, v143
    v_add_f32 v148, 1.0, v148
    v_mul_f32 v137, v129, v145
    v_exp_f32 v151, v151
    v_rcp_f32 v148, v148
    v_add_f32 v149, 1.0, v149
    v_mul_f32 v138, v130, v146
    v_cvt_pk_bf16_f32 v156, v136, v137
    v_rcp_f32 v149, v149
    v_add_f32 v150, 1.0, v150
    v_mul_f32 v139, v131, v147
    v_rcp_f32 v150, v150
    v_add_f32 v151, 1.0, v151
    v_mul_f32 v140, v132, v148
    v_cvt_pk_bf16_f32 v157, v138, v139
    v_rcp_f32 v151, v151
    v_mul_f32 v141, v133, v149
    v_mul_f32 v142, v134, v150
    v_cvt_pk_bf16_f32 v158, v140, v141
    v_mul_f32 v143, v135, v151
    v_cvt_pk_bf16_f32 v159, v142, v143
    s_add_u32 s82, s79, 344064
    buffer_store_dwordx4 v[156:159], v1, s[8:11], s82 offen sc0 sc1
    ds_read_b128 v[84:87], v2 offset:33792
    s_waitcnt lgkmcnt(4)
    v_mfma_f32_32x32x16_bf16 v[32:47], a[224:227], v[64:67], 0
    s_add_u32 s83, s85, 200704
    s_add_u32 m0, s84, 86016
    s_nop 0
    buffer_load_dwordx4 v1, s[8:11], s83 offen offset:0 lds
    ds_read_b64 v[152:153], v5 offset:2048
    ds_read_b128 v[88:91], v2 offset:34816
    v_mfma_f32_32x32x16_bf16 v[32:47], a[228:231], v[68:71], v[32:47]
    ds_read_b128 v[64:67], v2 offset:35840
    s_waitcnt lgkmcnt(5)
    v_mfma_f32_32x32x16_bf16 v[32:47], a[232:235], v[72:75], v[32:47]
    s_add_u32 m0, s84, 86016
    s_nop 0
    buffer_load_dwordx4 v1, s[8:11], s83 offen offset:1024 lds
    s_waitcnt lgkmcnt(2)
    ds_read_b128 v[68:71], v2 offset:36864
    v_mfma_f32_32x32x16_bf16 v[32:47], a[236:239], v[76:79], v[32:47]
    v_fma_f32 v128, -v152, v48, v16
    v_fma_f32 v136, -v152, v56, v24
    v_fma_f32 v129, -v152, v49, v17
    ds_read_b128 v[72:75], v2 offset:37888
    v_mfma_f32_32x32x16_bf16 v[32:47], a[240:243], v[80:83], v[32:47]
    v_fma_f32 v137, -v152, v57, v25
    v_mul_f32 v144, v128, v153
    v_mul_f32 v128, v128, v136
    v_fma_f32 v130, -v152, v50, v18
    ds_read_b128 v[76:79], v2 offset:38912
    v_mfma_f32_32x32x16_bf16 v[32:47], a[244:247], v[84:87], v[32:47]
    s_add_u32 m0, s84, 86016
    s_nop 0
    buffer_load_dwordx4 v1, s[8:11], s83 offen offset:2048 lds
    ds_read_b128 v[80:83], v2 offset:39936
    s_waitcnt lgkmcnt(4)
    v_mfma_f32_32x32x16_bf16 v[32:47], a[248:251], v[88:91], v[32:47]
    v_exp_f32 v144, v144
    v_fma_f32 v138, -v152, v58, v26
    v_mul_f32 v145, v129, v153
    ds_read_b128 v[84:87], v2 offset:40960
    v_mfma_f32_32x32x16_bf16 v[32:47], a[252:255], v[64:67], v[32:47]
    v_mul_f32 v129, v129, v137
    v_fma_f32 v131, -v152, v51, v19
    ds_read_b128 v[88:91], v2 offset:41984
    s_waitcnt lgkmcnt(4)
    v_mfma_f32_32x32x16_bf16 v[32:47], v[176:179], v[68:71], v[32:47]
    s_add_u32 m0, s84, 86016
    s_nop 0
    buffer_load_dwordx4 v1, s[8:11], s83 offen offset:3072 lds
    ds_read_b128 v[64:67], v2 offset:43008
    v_mfma_f32_32x32x16_bf16 v[32:47], v[180:183], v[72:75], v[32:47]
    v_exp_f32 v145, v145
    v_fma_f32 v139, -v152, v59, v27
    ds_read_b128 v[68:71], v2 offset:44032
    s_waitcnt lgkmcnt(4)
    v_mfma_f32_32x32x16_bf16 v[32:47], v[184:187], v[76:79], v[32:47]
    v_mul_f32 v146, v130, v153
    v_mul_f32 v130, v130, v138
    v_fma_f32 v132, -v152, v52, v20
    ds_read_b128 v[72:75], v2 offset:45056
    v_mfma_f32_32x32x16_bf16 v[32:47], v[188:191], v[80:83], v[32:47]
    s_add_u32 s83, s83, 4096
    s_add_u32 m0, s84, 90112
    s_nop 0
    buffer_load_dwordx4 v1, s[8:11], s83 offen offset:0 lds
    ds_read_b128 v[76:79], v2 offset:46080
    s_waitcnt lgkmcnt(4)
    v_mfma_f32_32x32x16_bf16 v[32:47], v[192:195], v[84:87], v[32:47]
    v_exp_f32 v146, v146
    v_fma_f32 v140, -v152, v60, v28
    v_mul_f32 v147, v131, v153
    ds_read_b128 v[80:83], v2 offset:47104
    v_mfma_f32_32x32x16_bf16 v[32:47], v[196:199], v[88:91], v[32:47]
    v_mul_f32 v131, v131, v139
    v_add_f32 v144, 1.0, v144
    v_fma_f32 v133, -v152, v53, v21
    ds_read_b128 v[84:87], v2 offset:48128
    s_waitcnt lgkmcnt(4)
    v_mfma_f32_32x32x16_bf16 v[32:47], v[200:203], v[64:67], v[32:47]
    s_add_u32 m0, s84, 90112
    s_nop 0
    buffer_load_dwordx4 v1, s[8:11], s83 offen offset:1024 lds
    ds_read_b128 v[88:91], v2 offset:49152
    v_mfma_f32_32x32x16_bf16 v[32:47], v[204:207], v[68:71], v[32:47]
    v_exp_f32 v147, v147
    v_fma_f32 v141, -v152, v61, v29
    ds_read_b128 v[64:67], v2 offset:50176
    s_waitcnt lgkmcnt(4)
    v_mfma_f32_32x32x16_bf16 v[32:47], v[208:211], v[72:75], v[32:47]
    v_mul_f32 v148, v132, v153
    v_rcp_f32 v144, v144
    v_mul_f32 v132, v132, v140
    ds_read_b128 v[68:71], v2 offset:51200
    v_mfma_f32_32x32x16_bf16 v[32:47], v[212:215], v[76:79], v[32:47]
    s_add_u32 m0, s84, 90112
    s_nop 0
    buffer_load_dwordx4 v1, s[8:11], s83 offen offset:2048 lds
    ds_read_b128 v[72:75], v2 offset:52224
    s_waitcnt lgkmcnt(4)
    v_mfma_f32_32x32x16_bf16 v[32:47], v[216:219], v[80:83], v[32:47]
    v_add_f32 v145, 1.0, v145
    v_fma_f32 v134, -v152, v54, v22
    v_exp_f32 v148, v148
    ds_read_b128 v[76:79], v2 offset:53248
    v_mfma_f32_32x32x16_bf16 v[32:47], v[220:223], v[84:87], v[32:47]
    v_fma_f32 v142, -v152, v62, v30
    v_mul_f32 v149, v133, v153
    ds_read_b128 v[80:83], v2 offset:54272
    s_waitcnt lgkmcnt(4)
    v_mfma_f32_32x32x16_bf16 v[32:47], v[224:227], v[88:91], v[32:47]
    s_waitcnt vmcnt(7)
    buffer_store_dwordx2 v[10:11], v8, s[8:11], 0 offen offset:2688 sc0 sc1
    ds_read_b128 v[84:87], v2 offset:55296
    v_mfma_f32_32x32x16_bf16 v[32:47], v[228:231], v[64:67], v[32:47]
    s_barrier
    v_rcp_f32 v145, v145
    ds_read_b128 v[88:91], v2 offset:56320
    s_waitcnt lgkmcnt(4)
    v_mfma_f32_32x32x16_bf16 v[32:47], v[232:235], v[68:71], v[32:47]
    v_mul_f32 v133, v133, v141
    v_add_f32 v146, 1.0, v146
    v_fma_f32 v135, -v152, v55, v23
    ds_read_b128 v[64:67], v7 offset:0
    v_mfma_f32_32x32x16_bf16 v[32:47], v[236:239], v[72:75], v[32:47]
    v_exp_f32 v149, v149
    v_fma_f32 v143, -v152, v63, v31
    ds_read_b128 v[68:71], v7 offset:1024
    s_waitcnt lgkmcnt(4)
    v_mfma_f32_32x32x16_bf16 v[32:47], v[240:243], v[76:79], v[32:47]
    v_mul_f32 v150, v134, v153
    v_rcp_f32 v146, v146
    v_mul_f32 v134, v134, v142
    ds_read_b128 v[72:75], v7 offset:2048
    v_mfma_f32_32x32x16_bf16 v[32:47], v[244:247], v[80:83], v[32:47]
    v_add_f32 v147, 1.0, v147
    v_mul_f32 v136, v128, v144
    ds_read_b128 v[76:79], v7 offset:3072
    s_waitcnt lgkmcnt(4)
    v_mfma_f32_32x32x16_bf16 v[32:47], v[248:251], v[84:87], v[32:47]
    v_exp_f32 v150, v150
    v_mul_f32 v151, v135, v153
    ds_read_b128 v[80:83], v7 offset:4096
    v_mfma_f32_32x32x16_bf16 v[32:47], v[252:255], v[88:91], v[32:47]
    v_rcp_f32 v147, v147
    v_mul_f32 v135, v135, v143
    v_add_f32 v148, 1.0, v148
    v_mul_f32 v137, v129, v145
    v_exp_f32 v151, v151
    v_rcp_f32 v148, v148
    v_add_f32 v149, 1.0, v149
    v_mul_f32 v138, v130, v146
    v_cvt_pk_bf16_f32 v156, v136, v137
    v_rcp_f32 v149, v149
    v_add_f32 v150, 1.0, v150
    v_mul_f32 v139, v131, v147
    v_rcp_f32 v150, v150
    v_add_f32 v151, 1.0, v151
    v_mul_f32 v140, v132, v148
    v_cvt_pk_bf16_f32 v157, v138, v139
    v_rcp_f32 v151, v151
    v_mul_f32 v141, v133, v149
    v_mul_f32 v142, v134, v150
    v_cvt_pk_bf16_f32 v158, v140, v141
    v_mul_f32 v143, v135, v151
    v_cvt_pk_bf16_f32 v159, v142, v143
    s_add_u32 s82, s79, 458752
    buffer_store_dwordx4 v[156:159], v1, s[8:11], s82 offen sc0 sc1
    ds_read_b128 v[84:87], v7 offset:5120
    s_waitcnt lgkmcnt(4)
    v_mfma_f32_32x32x16_bf16 v[16:31], a[224:227], v[64:67], 0
    ds_read_b64 v[152:153], v5 offset:2560
    ds_read_b128 v[88:91], v7 offset:6144
    v_mfma_f32_32x32x16_bf16 v[16:31], a[228:231], v[68:71], v[16:31]
    ds_read_b128 v[64:67], v7 offset:7168
    s_waitcnt lgkmcnt(5)
    v_mfma_f32_32x32x16_bf16 v[16:31], a[232:235], v[72:75], v[16:31]
    s_waitcnt lgkmcnt(2)
    v_fma_f32 v128, -v152, v48, v32
    v_fma_f32 v136, -v152, v56, v40
    v_fma_f32 v129, -v152, v49, v33
    ds_read_b128 v[68:71], v7 offset:8192
    v_mfma_f32_32x32x16_bf16 v[16:31], a[236:239], v[76:79], v[16:31]
    v_fma_f32 v137, -v152, v57, v41
    v_mul_f32 v144, v128, v153
    v_mul_f32 v128, v128, v136
    ds_read_b128 v[72:75], v7 offset:9216
    v_mfma_f32_32x32x16_bf16 v[16:31], a[240:243], v[80:83], v[16:31]
    v_fma_f32 v130, -v152, v50, v34
    v_exp_f32 v144, v144
    v_fma_f32 v138, -v152, v58, v42
    ds_read_b128 v[76:79], v7 offset:10240
    v_mfma_f32_32x32x16_bf16 v[16:31], a[244:247], v[84:87], v[16:31]
    v_mul_f32 v145, v129, v153
    v_mul_f32 v129, v129, v137
    v_fma_f32 v131, -v152, v51, v35
    ds_read_b128 v[80:83], v7 offset:11264
    s_waitcnt lgkmcnt(4)
    v_mfma_f32_32x32x16_bf16 v[16:31], a[248:251], v[88:91], v[16:31]
    v_exp_f32 v145, v145
    v_fma_f32 v139, -v152, v59, v43
    v_mul_f32 v146, v130, v153
    ds_read_b128 v[84:87], v7 offset:12288
    v_mfma_f32_32x32x16_bf16 v[16:31], a[252:255], v[64:67], v[16:31]
    v_mul_f32 v130, v130, v138
    v_fma_f32 v132, -v152, v52, v36
    ds_read_b128 v[88:91], v7 offset:13312
    s_waitcnt lgkmcnt(4)
    v_mfma_f32_32x32x16_bf16 v[16:31], v[176:179], v[68:71], v[16:31]
    v_exp_f32 v146, v146
    v_fma_f32 v140, -v152, v60, v44
    v_mul_f32 v147, v131, v153
    ds_read_b128 v[64:67], v7 offset:14336
    v_mfma_f32_32x32x16_bf16 v[16:31], v[180:183], v[72:75], v[16:31]
    v_mul_f32 v131, v131, v139
    v_add_f32 v144, 1.0, v144
    v_fma_f32 v133, -v152, v53, v37
    ds_read_b128 v[68:71], v7 offset:15360
    s_waitcnt lgkmcnt(4)
    v_mfma_f32_32x32x16_bf16 v[16:31], v[184:187], v[76:79], v[16:31]
    v_exp_f32 v147, v147
    v_fma_f32 v141, -v152, v61, v45
    v_mul_f32 v148, v132, v153
    ds_read_b128 v[72:75], v7 offset:16384
    v_mfma_f32_32x32x16_bf16 v[16:31], v[188:191], v[80:83], v[16:31]
    v_rcp_f32 v144, v144
    v_mul_f32 v132, v132, v140
    ds_read_b128 v[76:79], v7 offset:17408
    s_waitcnt lgkmcnt(4)
    v_mfma_f32_32x32x16_bf16 v[16:31], v[192:195], v[84:87], v[16:31]
    v_add_f32 v145, 1.0, v145
    v_fma_f32 v134, -v152, v54, v38
    v_exp_f32 v148, v148
    ds_read_b128 v[80:83], v7 offset:18432
    v_mfma_f32_32x32x16_bf16 v[16:31], v[196:199], v[88:91], v[16:31]
    v_fma_f32 v142, -v152, v62, v46
    v_mul_f32 v149, v133, v153
    ds_read_b128 v[84:87], v7 offset:19456
    s_waitcnt lgkmcnt(4)
    v_mfma_f32_32x32x16_bf16 v[16:31], v[200:203], v[64:67], v[16:31]
    v_rcp_f32 v145, v145
    v_mul_f32 v133, v133, v141
    v_add_f32 v146, 1.0, v146
    ds_read_b128 v[88:91], v7 offset:20480
    v_mfma_f32_32x32x16_bf16 v[16:31], v[204:207], v[68:71], v[16:31]
    v_fma_f32 v135, -v152, v55, v39
    v_exp_f32 v149, v149
    ds_read_b128 v[64:67], v7 offset:21504
    s_waitcnt lgkmcnt(4)
    v_mfma_f32_32x32x16_bf16 v[16:31], v[208:211], v[72:75], v[16:31]
    v_fma_f32 v143, -v152, v63, v47
    v_mul_f32 v150, v134, v153
    v_rcp_f32 v146, v146
    ds_read_b128 v[68:71], v7 offset:22528
    v_mfma_f32_32x32x16_bf16 v[16:31], v[212:215], v[76:79], v[16:31]
    v_mul_f32 v134, v134, v142
    v_add_f32 v147, 1.0, v147
    v_mul_f32 v136, v128, v144
    ds_read_b128 v[72:75], v7 offset:23552
    s_waitcnt lgkmcnt(4)
    v_mfma_f32_32x32x16_bf16 v[16:31], v[216:219], v[80:83], v[16:31]
    v_exp_f32 v150, v150
    v_mul_f32 v151, v135, v153
    ds_read_b128 v[76:79], v7 offset:24576
    v_mfma_f32_32x32x16_bf16 v[16:31], v[220:223], v[84:87], v[16:31]
    v_rcp_f32 v147, v147
    v_mul_f32 v135, v135, v143
    ds_read_b128 v[80:83], v7 offset:25600
    s_waitcnt lgkmcnt(4)
    v_mfma_f32_32x32x16_bf16 v[16:31], v[224:227], v[88:91], v[16:31]
    s_waitcnt vmcnt(0)
    buffer_store_dwordx2 v[10:11], v9, s[8:11], 0 offen offset:0 sc0 sc1
    ds_read_b128 v[84:87], v7 offset:26624
    v_mfma_f32_32x32x16_bf16 v[16:31], v[228:231], v[64:67], v[16:31]
    s_barrier
    v_add_f32 v148, 1.0, v148
    v_mul_f32 v137, v129, v145
    ds_read_b128 v[88:91], v7 offset:27648
    s_waitcnt lgkmcnt(4)
    v_mfma_f32_32x32x16_bf16 v[16:31], v[232:235], v[68:71], v[16:31]
    v_exp_f32 v151, v151
    v_rcp_f32 v148, v148
    ds_read_b128 v[64:67], v7 offset:28672
    v_mfma_f32_32x32x16_bf16 v[16:31], v[236:239], v[72:75], v[16:31]
    v_add_f32 v149, 1.0, v149
    v_mul_f32 v138, v130, v146
    v_cvt_pk_bf16_f32 v156, v136, v137
    ds_read_b128 v[68:71], v7 offset:29696
    s_waitcnt lgkmcnt(4)
    v_mfma_f32_32x32x16_bf16 v[16:31], v[240:243], v[76:79], v[16:31]
    v_rcp_f32 v149, v149
    v_add_f32 v150, 1.0, v150
    v_mul_f32 v139, v131, v147
    ds_read_b128 v[72:75], v7 offset:30720
    v_mfma_f32_32x32x16_bf16 v[16:31], v[244:247], v[80:83], v[16:31]
    v_rcp_f32 v150, v150
    v_add_f32 v151, 1.0, v151
    ds_read_b128 v[76:79], v7 offset:31744
    s_waitcnt lgkmcnt(4)
    v_mfma_f32_32x32x16_bf16 v[16:31], v[248:251], v[84:87], v[16:31]
    v_mul_f32 v140, v132, v148
    v_cvt_pk_bf16_f32 v157, v138, v139
    v_rcp_f32 v151, v151
    ds_read_b128 v[80:83], v7 offset:32768
    v_mfma_f32_32x32x16_bf16 v[16:31], v[252:255], v[88:91], v[16:31]
    v_mul_f32 v141, v133, v149
    v_mul_f32 v142, v134, v150
    v_cvt_pk_bf16_f32 v158, v140, v141
    v_mul_f32 v143, v135, v151
    v_cvt_pk_bf16_f32 v159, v142, v143
    s_add_u32 s82, s79, 573440
    buffer_store_dwordx4 v[156:159], v1, s[8:11], s82 offen sc0 sc1
    ds_read_b128 v[84:87], v7 offset:33792
    s_waitcnt lgkmcnt(4)
    v_mfma_f32_32x32x16_bf16 v[32:47], a[224:227], v[64:67], 0
    ds_read_b64 v[152:153], v5 offset:3072
    ds_read_b128 v[88:91], v7 offset:34816
    v_mfma_f32_32x32x16_bf16 v[32:47], a[228:231], v[68:71], v[32:47]
    s_add_u32 s82, s76, s67
    s_mul_i32 s82, s82, 112
    s_mul_i32 s83, s36, 28
    s_add_u32 s82, s82, s83
    s_lshl_b32 s83, s82, 3
    s_add_u32 s83, s83, s74
    v_min_u32 v3, 27, v0
    v_lshlrev_b32 v3, 3, v3
    v_add_u32 v3, s83, v3
    s_lshl_b32 s94, s82, 10
    s_add_u32 s94, s94, s72
    buffer_load_dwordx2 v[168:169], v3, s[8:11], 0 offen sc1
    ds_read_b128 v[64:67], v7 offset:35840
    s_waitcnt lgkmcnt(5)
    v_mfma_f32_32x32x16_bf16 v[32:47], a[232:235], v[72:75], v[32:47]
    s_waitcnt lgkmcnt(2)
    v_fma_f32 v128, -v152, v48, v16
    v_fma_f32 v136, -v152, v56, v24
    v_fma_f32 v129, -v152, v49, v17
    ds_read_b128 v[68:71], v7 offset:36864
    v_mfma_f32_32x32x16_bf16 v[32:47], a[236:239], v[76:79], v[32:47]
    v_fma_f32 v137, -v152, v57, v25
    v_mul_f32 v144, v128, v153
    v_mul_f32 v128, v128, v136
    ds_read_b128 v[72:75], v7 offset:37888
    v_mfma_f32_32x32x16_bf16 v[32:47], a[240:243], v[80:83], v[32:47]
    v_fma_f32 v130, -v152, v50, v18
    v_exp_f32 v144, v144
    v_fma_f32 v138, -v152, v58, v26
    ds_read_b128 v[76:79], v7 offset:38912
    v_mfma_f32_32x32x16_bf16 v[32:47], a[244:247], v[84:87], v[32:47]
    v_mul_f32 v145, v129, v153
    v_mul_f32 v129, v129, v137
    v_fma_f32 v131, -v152, v51, v19
    s_add_u32 s82, s76, s67
    s_add_u32 s82, s82, 4
    s_mul_i32 s82, s82, 112
    s_mul_i32 s83, s36, 28
    s_add_u32 s82, s82, s83
    s_lshl_b32 s83, s82, 3
    s_add_u32 s83, s83, s74
    v_min_u32 v4, 27, v0
    v_lshlrev_b32 v4, 3, v4
    v_add_u32 v4, s83, v4
    s_lshl_b32 s95, s82, 10
    s_add_u32 s95, s95, s72
    ds_read_b128 v[80:83], v7 offset:39936
    s_waitcnt lgkmcnt(4)
    v_mfma_f32_32x32x16_bf16 v[32:47], a[248:251], v[88:91], v[32:47]
    v_exp_f32 v145, v145
    v_fma_f32 v139, -v152, v59, v27
    v_mul_f32 v146, v130, v153
    ds_read_b128 v[84:87], v7 offset:40960
    v_mfma_f32_32x32x16_bf16 v[32:47], a[252:255], v[64:67], v[32:47]
    v_mul_f32 v130, v130, v138
    v_fma_f32 v132, -v152, v52, v20
    ds_read_b128 v[88:91], v7 offset:41984
    s_waitcnt lgkmcnt(4)
    v_mfma_f32_32x32x16_bf16 v[32:47], v[176:179], v[68:71], v[32:47]
    v_exp_f32 v146, v146
    v_fma_f32 v140, -v152, v60, v28
    v_mul_f32 v147, v131, v153
    s_waitcnt vmcnt(0)
    v_cmp_ne_u64 vcc, s[100:101], v[168:169]
    s_cbranch_vccz FSD_1_68
    s_mov_b32 s80, 0
FS_1_67:
    buffer_load_dwordx2 v[168:169], v3, s[8:11], 0 offen sc1
    s_waitcnt vmcnt(0)
    v_cmp_ne_u64 vcc, s[100:101], v[168:169]
    s_cbranch_vccz FSD_1_68
    s_add_u32 s80, s80, 1
    s_cmp_lt_u32 s80, 20000
    s_cbranch_scc0 FSD_1_68_to
    s_sleep 1
    s_branch FS_1_67
FSD_1_68_to:
    s_or_b32 s39, s39, 8
FSD_1_68:
    ds_read_b128 v[64:67], v7 offset:43008
    v_mfma_f32_32x32x16_bf16 v[32:47], v[180:183], v[72:75], v[32:47]
    v_mul_f32 v131, v131, v139
    v_add_f32 v144, 1.0, v144
    v_fma_f32 v133, -v152, v53, v21
    s_lshl_b32 s80, s67, 9
    s_add_u32 s80, s80, 8
    v_add_u32 v6, s80, v5
    s_lshl_b32 s80, s36, 11
    s_add_u32 s80, s80, 118784
    v_add_u32 v12, s80, v1
    s_lshl_b32 s80, s36, 13
    s_add_u32 s80, s80, 118784
    v_add_u32 v13, s80, v1
    s_add_u32 s83, s94, 0
    buffer_load_dwordx4 v[92:95], v1, s[8:11], s83 offen offset:0
    ds_read_b128 v[68:71], v7 offset:44032
    s_waitcnt lgkmcnt(4)
    v_mfma_f32_32x32x16_bf16 v[32:47], v[184:187], v[76:79], v[32:47]
    v_exp_f32 v147, v147
    v_fma_f32 v141, -v152, v61, v29
    v_mul_f32 v148, v132, v153
    ds_read_b128 v[72:75], v7 offset:45056
    v_mfma_f32_32x32x16_bf16 v[32:47], v[188:191], v[80:83], v[32:47]
    v_rcp_f32 v144, v144
    v_mul_f32 v132, v132, v140
    s_add_u32 s83, s94, 0
    buffer_load_dwordx4 v[96:99], v1, s[8:11], s83 offen offset:1024
    ds_read_b128 v[76:79], v7 offset:46080
    s_waitcnt lgkmcnt(4)
    v_mfma_f32_32x32x16_bf16 v[32:47], v[192:195], v[84:87], v[32:47]
    v_add_f32 v145, 1.0, v145
    v_fma_f32 v134, -v152, v54, v22
    v_exp_f32 v148, v148
    ds_read_b128 v[80:83], v7 offset:47104
    v_mfma_f32_32x32x16_bf16 v[32:47], v[196:199], v[88:91], v[32:47]
    v_fma_f32 v142, -v152, v62, v30
    v_mul_f32 v149, v133, v153
    ds_read_b128 v[84:87], v7 offset:48128
    s_waitcnt lgkmcnt(4)
    v_mfma_f32_32x32x16_bf16 v[32:47], v[200:203], v[64:67], v[32:47]
    v_rcp_f32 v145, v145
    v_mul_f32 v133, v133, v141
    v_add_f32 v146, 1.0, v146
    s_add_u32 s83, s94, 0
    buffer_load_dwordx4 v[100:103], v1, s[8:11], s83 offen offset:2048
    ds_read_b128 v[88:91], v7 offset:49152
    v_mfma_f32_32x32x16_bf16 v[32:47], v[204:207], v[68:71], v[32:47]
    v_fma_f32 v135, -v152, v55, v23
    v_exp_f32 v149, v149
    ds_read_b128 v[64:67], v7 offset:50176
    s_waitcnt lgkmcnt(4)
    v_mfma_f32_32x32x16_bf16 v[32:47], v[208:211], v[72:75], v[32:47]
    v_fma_f32 v143, -v152, v63, v31
    v_mul_f32 v150, v134, v153
    v_rcp_f32 v146, v146
    s_add_u32 s83, s94, 0
    buffer_load_dwordx4 v[104:107], v1, s[8:11], s83 offen offset:3072
    ds_read_b128 v[68:71], v7 offset:51200
    v_mfma_f32_32x32x16_bf16 v[32:47], v[212:215], v[76:79], v[32:47]
    v_mul_f32 v134, v134, v142
    v_add_f32 v147, 1.0, v147
    v_mul_f32 v136, v128, v144
    ds_read_b128 v[72:75], v7 offset:52224
    s_waitcnt lgkmcnt(4)
    v_mfma_f32_32x32x16_bf16 v[32:47], v[216:219], v[80:83], v[32:47]
    v_exp_f32 v150, v150
    v_mul_f32 v151, v135, v153
    s_add_u32 s83, s94, 4096
    buffer_load_dwordx4 v[108:111], v1, s[8:11], s83 offen offset:0
    ds_read_b128 v[76:79], v7 offset:53248
    v_mfma_f32_32x32x16_bf16 v[32:47], v[220:223], v[84:87], v[32:47]
    v_rcp_f32 v147, v147
    v_mul_f32 v135, v135, v143
    ds_read_b128 v[80:83], v7 offset:54272
    s_waitcnt lgkmcnt(4)
    v_mfma_f32_32x32x16_bf16 v[32:47], v[224:227], v[88:91], v[32:47]
    buffer_store_dwordx2 v[10:11], v9, s[8:11], 0 offen offset:896 sc0 sc1
    v_add_f32 v148, 1.0, v148
    ds_read_b128 v[84:87], v7 offset:55296
    v_mfma_f32_32x32x16_bf16 v[32:47], v[228:231], v[64:67], v[32:47]
    s_barrier
    v_mul_f32 v137, v129, v145
    s_add_u32 s83, s94, 4096
    buffer_load_dwordx4 v[64:67], v1, s[8:11], s83 offen offset:1024
    ds_read_b128 v[88:91], v7 offset:56320
    s_waitcnt lgkmcnt(4)
    v_mfma_f32_32x32x16_bf16 v[32:47], v[232:235], v[68:71], v[32:47]
    v_exp_f32 v151, v151
    v_rcp_f32 v148, v148
    v_add_f32 v149, 1.0, v149
    v_mfma_f32_32x32x16_bf16 v[32:47], v[236:239], v[72:75], v[32:47]
    v_mul_f32 v138, v130, v146
    v_cvt_pk_bf16_f32 v156, v136, v137
    v_rcp_f32 v149, v149
    s_add_u32 s83, s94, 4096
    buffer_load_dwordx4 v[68:71], v1, s[8:11], s83 offen offset:2048
    s_waitcnt lgkmcnt(2)
    v_mfma_f32_32x32x16_bf16 v[32:47], v[240:243], v[76:79], v[32:47]
    v_add_f32 v150, 1.0, v150
    v_mul_f32 v139, v131, v147
    v_rcp_f32 v150, v150
    v_add_f32 v151, 1.0, v151
    v_mfma_f32_32x32x16_bf16 v[32:47], v[244:247], v[80:83], v[32:47]
    v_mul_f32 v140, v132, v148
    v_cvt_pk_bf16_f32 v157, v138, v139
    v_rcp_f32 v151, v151
    s_add_u32 s83, s94, 4096
    buffer_load_dwordx4 v[72:75], v1, s[8:11], s83 offen offset:3072
    s_waitcnt lgkmcnt(0)
    v_mfma_f32_32x32x16_bf16 v[32:47], v[248:251], v[84:87], v[32:47]
    v_mul_f32 v141, v133, v149
    v_mul_f32 v142, v134, v150
    v_cvt_pk_bf16_f32 v158, v140, v141
    v_mul_f32 v143, v135, v151
    v_cvt_pk_bf16_f32 v159, v142, v143
    v_mfma_f32_32x32x16_bf16 v[32:47], v[252:255], v[88:91], v[32:47]
    s_add_u32 s82, s79, 688128
    buffer_store_dwordx4 v[156:159], v1, s[8:11], s82 offen sc0 sc1
    s_add_u32 s83, s94, 8192
    buffer_load_dwordx4 v[76:79], v1, s[8:11], s83 offen offset:0
    s_waitcnt vmcnt(10)
    v_mfma_f32_32x32x16_bf16 v[16:31], a[0:3], v[92:95], 0
    ds_read_b64 v[152:153], v5 offset:3584
    s_waitcnt lgkmcnt(0)
    s_nop 3
    v_fma_f32 v128, -v152, v48, v32
    v_fma_f32 v136, -v152, v56, v40
    v_fma_f32 v129, -v152, v49, v33
    v_fma_f32 v137, -v152, v57, v41
    v_mfma_f32_32x32x16_bf16 v[160:175], a[4:7], v[92:95], 0
    s_add_u32 s83, s94, 8192
    buffer_load_dwordx4 v[80:83], v1, s[8:11], s83 offen offset:1024
    s_add_u32 s83, s94, 8192
    buffer_load_dwordx4 v[84:87], v1, s[8:11], s83 offen offset:2048
    s_add_u32 s83, s94, 12288
    buffer_load_dwordx4 v[92:95], v1, s[8:11], s83 offen offset:0
    s_waitcnt vmcnt(12)
    v_mfma_f32_32x32x16_bf16 v[16:31], a[8:11], v[96:99], v[16:31]
    v_mul_f32 v144, v128, v153
    v_mul_f32 v128, v128, v136
    v_fma_f32 v130, -v152, v50, v34
    v_exp_f32 v144, v144
    v_fma_f32 v138, -v152, v58, v42
    v_mfma_f32_32x32x16_bf16 v[160:175], a[12:15], v[96:99], v[160:175]
    s_add_u32 s83, s94, 8192
    buffer_load_dwordx4 v[88:91], v1, s[8:11], s83 offen offset:3072
    s_add_u32 s83, s94, 12288
    buffer_load_dwordx4 v[96:99], v1, s[8:11], s83 offen offset:1024
    s_waitcnt vmcnt(13)
    v_mfma_f32_32x32x16_bf16 v[16:31], a[16:19], v[100:103], v[16:31]
    v_mul_f32 v145, v129, v153
    v_mul_f32 v129, v129, v137
    v_fma_f32 v131, -v152, v51, v35
    v_exp_f32 v145, v145
    v_fma_f32 v139, -v152, v59, v43
    v_mfma_f32_32x32x16_bf16 v[160:175], a[20:23], v[100:103], v[160:175]
    s_add_u32 s83, s94, 12288
    buffer_load_dwordx4 v[100:103], v1, s[8:11], s83 offen offset:2048
    v_mul_f32 v146, v130, v153
    v_mul_f32 v130, v130, v138
    s_waitcnt vmcnt(13)
    v_mfma_f32_32x32x16_bf16 v[16:31], a[24:27], v[104:107], v[16:31]
    v_fma_f32 v132, -v152, v52, v36
    v_exp_f32 v146, v146
    v_fma_f32 v140, -v152, v60, v44
    v_mul_f32 v147, v131, v153
    v_mul_f32 v131, v131, v139
    v_mfma_f32_32x32x16_bf16 v[160:175], a[28:31], v[104:107], v[160:175]
    s_add_u32 s83, s94, 12288
    buffer_load_dwordx4 v[104:107], v1, s[8:11], s83 offen offset:3072
    v_add_f32 v144, 1.0, v144
    v_fma_f32 v133, -v152, v53, v37
    s_waitcnt vmcnt(13)
    v_mfma_f32_32x32x16_bf16 v[16:31], a[32:35], v[108:111], v[16:31]
    v_exp_f32 v147, v147
    v_fma_f32 v141, -v152, v61, v45
    v_mul_f32 v148, v132, v153
    v_rcp_f32 v144, v144
    v_mfma_f32_32x32x16_bf16 v[160:175], a[36:39], v[108:111], v[160:175]
    s_add_u32 s83, s94, 16384
    buffer_load_dwordx4 v[108:111], v1, s[8:11], s83 offen offset:0
    v_mul_f32 v132, v132, v140
    v_add_f32 v145, 1.0, v145
    s_waitcnt vmcnt(12)
    v_mfma_f32_32x32x16_bf16 v[16:31], a[40:43], v[64:67], v[16:31]
    v_fma_f32 v134, -v152, v54, v38
    v_exp_f32 v148, v148
    v_fma_f32 v142, -v152, v62, v46
    v_mul_f32 v149, v133, v153
    v_mfma_f32_32x32x16_bf16 v[160:175], a[44:47], v[64:67], v[160:175]
    s_add_u32 s83, s94, 16384
    buffer_load_dwordx4 v[64:67], v1, s[8:11], s83 offen offset:1024
    v_rcp_f32 v145, v145
    s_waitcnt vmcnt(12)
    v_mfma_f32_32x32x16_bf16 v[16:31], a[48:51], v[68:71], v[16:31]
    s_waitcnt vmcnt(10)
    buffer_store_dwordx2 v[10:11], v9, s[8:11], 0 offen offset:1792 sc0 sc1
    v_mul_f32 v133, v133, v141
    v_add_f32 v146, 1.0, v146
    v_fma_f32 v135, -v152, v55, v39
    v_mfma_f32_32x32x16_bf16 v[160:175], a[52:55], v[68:71], v[160:175]
    s_add_u32 s83, s94, 16384
    buffer_load_dwordx4 v[68:71], v1, s[8:11], s83 offen offset:2048
    v_exp_f32 v149, v149
    v_mfma_f32_32x32x16_bf16 v[16:31], a[56:59], v[72:75], v[16:31]
    v_fma_f32 v143, -v152, v63, v47
    v_mul_f32 v150, v134, v153
    v_rcp_f32 v146, v146
    v_mul_f32 v134, v134, v142
    v_add_f32 v147, 1.0, v147
    v_mfma_f32_32x32x16_bf16 v[160:175], a[60:63], v[72:75], v[160:175]
    s_add_u32 s83, s94, 16384
    buffer_load_dwordx4 v[72:75], v1, s[8:11], s83 offen offset:3072
    v_mul_f32 v136, v128, v144
    s_waitcnt vmcnt(12)
    v_mfma_f32_32x32x16_bf16 v[16:31], a[64:67], v[76:79], v[16:31]
    v_exp_f32 v150, v150
    v_mul_f32 v151, v135, v153
    v_rcp_f32 v147, v147
    v_mul_f32 v135, v135, v143
    v_mfma_f32_32x32x16_bf16 v[160:175], a[68:71], v[76:79], v[160:175]
    s_add_u32 s83, s94, 20480
    buffer_load_dwordx4 v[76:79], v1, s[8:11], s83 offen offset:0
    v_add_f32 v148, 1.0, v148
    v_mul_f32 v137, v129, v145
    s_waitcnt vmcnt(12)
    v_mfma_f32_32x32x16_bf16 v[16:31], a[72:75], v[80:83], v[16:31]
    v_exp_f32 v151, v151
    v_rcp_f32 v148, v148
    v_add_f32 v149, 1.0, v149
    v_mul_f32 v138, v130, v146
    buffer_load_dwordx2 v[154:155], v4, s[8:11], 0 offen sc1
    v_mfma_f32_32x32x16_bf16 v[160:175], a[76:79], v[80:83], v[160:175]
    s_add_u32 s83, s94, 20480
    buffer_load_dwordx4 v[80:83], v1, s[8:11], s83 offen offset:1024
    v_cvt_pk_bf16_f32 v156, v136, v137
    s_waitcnt vmcnt(13)
    v_mfma_f32_32x32x16_bf16 v[16:31], a[80:83], v[84:87], v[16:31]
    v_rcp_f32 v149, v149
    v_add_f32 v150, 1.0, v150
    v_mul_f32 v139, v131, v147
    v_rcp_f32 v150, v150
    v_mfma_f32_32x32x16_bf16 v[160:175], a[84:87], v[84:87], v[160:175]
    s_add_u32 s83, s94, 20480
    buffer_load_dwordx4 v[84:87], v1, s[8:11], s83 offen offset:2048
    v_add_f32 v151, 1.0, v151
    v_mul_f32 v140, v132, v148
    s_waitcnt vmcnt(12)
    v_mfma_f32_32x32x16_bf16 v[16:31], a[88:91], v[88:91], v[16:31]
    v_cvt_pk_bf16_f32 v157, v138, v139
    v_rcp_f32 v151, v151
    v_mul_f32 v141, v133, v149
    v_mul_f32 v142, v134, v150
    v_cvt_pk_bf16_f32 v158, v140, v141
    v_mfma_f32_32x32x16_bf16 v[160:175], a[92:95], v[88:91], v[160:175]
    s_add_u32 s83, s94, 20480
    buffer_load_dwordx4 v[88:91], v1, s[8:11], s83 offen offset:3072
    v_mul_f32 v143, v135, v151
    v_cvt_pk_bf16_f32 v159, v142, v143
    v_mfma_f32_32x32x16_bf16 v[16:31], a[96:99], v[92:95], v[16:31]
    s_add_u32 s82, s79, 802816
    buffer_store_dwordx4 v[156:159], v1, s[8:11], s82 offen sc0 sc1
    v_mfma_f32_32x32x16_bf16 v[160:175], a[100:103], v[92:95], v[160:175]
    s_add_u32 s83, s94, 24576
    buffer_load_dwordx4 v[92:95], v1, s[8:11], s83 offen offset:0
    s_waitcnt vmcnt(14)
    v_mfma_f32_32x32x16_bf16 v[16:31], a[104:107], v[96:99], v[16:31]
    v_mfma_f32_32x32x16_bf16 v[160:175], a[108:111], v[96:99], v[160:175]
    s_add_u32 s83, s94, 24576
    buffer_load_dwordx4 v[96:99], v1, s[8:11], s83 offen offset:1024
    s_waitcnt vmcnt(14)
    v_mfma_f32_32x32x16_bf16 v[16:31], a[112:115], v[100:103], v[16:31]
    v_mfma_f32_32x32x16_bf16 v[160:175], a[116:119], v[100:103], v[160:175]
    s_add_u32 s83, s94, 24576
    buffer_load_dwordx4 v[100:103], v1, s[8:11], s83 offen offset:2048
    s_waitcnt vmcnt(14)
    v_mfma_f32_32x32x16_bf16 v[16:31], a[120:123], v[104:107], v[16:31]
    v_mfma_f32_32x32x16_bf16 v[160:175], a[124:127], v[104:107], v[160:175]
    s_add_u32 s83, s94, 24576
    buffer_load_dwordx4 v[104:107], v1, s[8:11], s83 offen offset:3072
    s_waitcnt vmcnt(14)
    v_mfma_f32_32x32x16_bf16 v[16:31], a[128:131], v[108:111], v[16:31]
    s_waitcnt vmcnt(4)
    buffer_store_dwordx2 v[10:11], v9, s[8:11], 0 offen offset:2688 sc0 sc1
    v_mfma_f32_32x32x16_bf16 v[160:175], a[132:135], v[108:111], v[160:175]
    v_mfma_f32_32x32x16_bf16 v[16:31], a[136:139], v[64:67], v[16:31]
    v_mfma_f32_32x32x16_bf16 v[160:175], a[140:143], v[64:67], v[160:175]
    v_cmp_ne_u64 vcc, s[100:101], v[154:155]
    s_cbranch_vccz FSD_1_70
    s_mov_b32 s80, 0
FS_1_69:
    buffer_load_dwordx2 v[154:155], v4, s[8:11], 0 offen sc1
    s_waitcnt vmcnt(0)
    v_cmp_ne_u64 vcc, s[100:101], v[154:155]
    s_cbranch_vccz FSD_1_70
    s_add_u32 s80, s80, 1
    s_cmp_lt_u32 s80, 20000
    s_cbranch_scc0 FSD_1_70_to
    s_sleep 1
    s_branch FS_1_69
FSD_1_70_to:
    s_or_b32 s39, s39, 128
FSD_1_70:
    v_mfma_f32_32x32x16_bf16 v[16:31], a[144:147], v[68:71], v[16:31]
    v_mfma_f32_32x32x16_bf16 v[160:175], a[148:151], v[68:71], v[160:175]
    s_add_u32 s83, s95, 0
    buffer_load_dwordx4 v[108:111], v1, s[8:11], s83 offen offset:0
    s_add_u32 s83, s95, 0
    buffer_load_dwordx4 v[64:67], v1, s[8:11], s83 offen offset:1024
    v_mfma_f32_32x32x16_bf16 v[16:31], a[152:155], v[72:75], v[16:31]
    v_mfma_f32_32x32x16_bf16 v[160:175], a[156:159], v[72:75], v[160:175]
    s_add_u32 s83, s95, 0
    buffer_load_dwordx4 v[68:71], v1, s[8:11], s83 offen offset:2048
    s_add_u32 s83, s95, 0
    buffer_load_dwordx4 v[72:75], v1, s[8:11], s83 offen offset:3072
    v_mfma_f32_32x32x16_bf16 v[16:31], a[160:163], v[76:79], v[16:31]
    v_mfma_f32_32x32x16_bf16 v[160:175], a[164:167], v[76:79], v[160:175]
    s_add_u32 s83, s95, 4096
    buffer_load_dwordx4 v[76:79], v1, s[8:11], s83 offen offset:0
    v_mfma_f32_32x32x16_bf16 v[16:31], a[168:171], v[80:83], v[16:31]
    v_mfma_f32_32x32x16_bf16 v[160:175], a[172:175], v[80:83], v[160:175]
    s_add_u32 s83, s95, 4096
    buffer_load_dwordx4 v[80:83], v1, s[8:11], s83 offen offset:1024
    v_mfma_f32_32x32x16_bf16 v[16:31], a[176:179], v[84:87], v[16:31]
    v_mfma_f32_32x32x16_bf16 v[160:175], a[180:183], v[84:87], v[160:175]
    s_add_u32 s83, s95, 4096
    buffer_load_dwordx4 v[84:87], v1, s[8:11], s83 offen offset:2048
    v_mfma_f32_32x32x16_bf16 v[16:31], a[184:187], v[88:91], v[16:31]
    v_mfma_f32_32x32x16_bf16 v[160:175], a[188:191], v[88:91], v[160:175]
    s_add_u32 s83, s95, 4096
    buffer_load_dwordx4 v[88:91], v1, s[8:11], s83 offen offset:3072
    s_waitcnt vmcnt(12)
    v_mfma_f32_32x32x16_bf16 v[16:31], a[192:195], v[92:95], v[16:31]
    v_mfma_f32_32x32x16_bf16 v[160:175], a[196:199], v[92:95], v[160:175]
    s_add_u32 s83, s95, 8192
    buffer_load_dwordx4 v[92:95], v1, s[8:11], s83 offen offset:0
    s_waitcnt vmcnt(12)
    v_mfma_f32_32x32x16_bf16 v[16:31], a[200:203], v[96:99], v[16:31]
    v_mfma_f32_32x32x16_bf16 v[160:175], a[204:207], v[96:99], v[160:175]
    s_add_u32 s83, s95, 8192
    buffer_load_dwordx4 v[96:99], v1, s[8:11], s83 offen offset:1024
    s_waitcnt vmcnt(12)
    v_mfma_f32_32x32x16_bf16 v[16:31], a[208:211], v[100:103], v[16:31]
    v_mfma_f32_32x32x16_bf16 v[160:175], a[212:215], v[100:103], v[160:175]
    s_add_u32 s83, s95, 8192
    buffer_load_dwordx4 v[100:103], v1, s[8:11], s83 offen offset:2048
    s_waitcnt vmcnt(12)
    v_mfma_f32_32x32x16_bf16 v[16:31], a[216:219], v[104:107], v[16:31]
    v_mfma_f32_32x32x16_bf16 v[160:175], a[220:223], v[104:107], v[160:175]
    s_add_u32 s83, s95, 8192
    buffer_load_dwordx4 v[104:107], v1, s[8:11], s83 offen offset:3072
    s_waitcnt vmcnt(11)
    v_mfma_f32_32x32x16_bf16 v[32:47], a[0:3], v[108:111], 0
    v_mfma_f32_32x32x16_bf16 v[128:143], a[4:7], v[108:111], 0
    s_add_u32 s83, s95, 12288
    buffer_load_dwordx4 v[108:111], v1, s[8:11], s83 offen offset:0
    s_waitcnt vmcnt(11)
    v_mfma_f32_32x32x16_bf16 v[32:47], a[8:11], v[64:67], v[32:47]
    s_nop 1
    ds_write_b128 v12, v[16:19] offset:0
    ds_write_b128 v12, v[20:23] offset:1024
    ds_write_b128 v12, v[24:27] offset:16384
    v_mfma_f32_32x32x16_bf16 v[128:143], a[12:15], v[64:67], v[128:143]
    s_add_u32 s83, s95, 12288
    buffer_load_dwordx4 v[64:67], v1, s[8:11], s83 offen offset:1024
    ds_write_b128 v12, v[28:31] offset:17408
    s_waitcnt vmcnt(11)
    v_mfma_f32_32x32x16_bf16 v[32:47], a[16:19], v[68:71], v[32:47]
    ds_write_b128 v12, v[160:163] offset:8192
    ds_write_b128 v12, v[164:167] offset:9216
    ds_write_b128 v12, v[168:171] offset:24576
    v_mfma_f32_32x32x16_bf16 v[128:143], a[20:23], v[68:71], v[128:143]
    s_add_u32 s83, s95, 12288
    buffer_load_dwordx4 v[68:71], v1, s[8:11], s83 offen offset:2048
    ds_write_b128 v12, v[172:175] offset:25600
    s_waitcnt vmcnt(11)
    v_mfma_f32_32x32x16_bf16 v[32:47], a[24:27], v[72:75], v[32:47]
    v_mfma_f32_32x32x16_bf16 v[128:143], a[28:31], v[72:75], v[128:143]
    s_add_u32 s83, s95, 12288
    buffer_load_dwordx4 v[72:75], v1, s[8:11], s83 offen offset:3072
    s_waitcnt vmcnt(11)
    v_mfma_f32_32x32x16_bf16 v[32:47], a[32:35], v[76:79], v[32:47]
    v_mfma_f32_32x32x16_bf16 v[128:143], a[36:39], v[76:79], v[128:143]
    s_add_u32 s83, s95, 16384
    buffer_load_dwordx4 v[76:79], v1, s[8:11], s83 offen offset:0
    s_waitcnt lgkmcnt(0)
    s_barrier
    s_waitcnt vmcnt(11)
    v_mfma_f32_32x32x16_bf16 v[32:47], a[40:43], v[80:83], v[32:47]
    ds_read_b128 v[16:19], v13 offset:0
    ds_read_b128 v[20:23], v13 offset:1024
    ds_read_b128 v[24:27], v13 offset:2048
    ds_read_b128 v[28:31], v13 offset:3072
    ds_read_b128 v[160:163], v13 offset:4096
    ds_read_b128 v[164:167], v13 offset:5120
    v_mfma_f32_32x32x16_bf16 v[128:143], a[44:47], v[80:83], v[128:143]
    s_add_u32 s83, s95, 16384
    buffer_load_dwordx4 v[80:83], v1, s[8:11], s83 offen offset:1024
    ds_read_b128 v[168:171], v13 offset:6144
    ds_read_b128 v[172:175], v13 offset:7168
    s_waitcnt vmcnt(11)
    v_mfma_f32_32x32x16_bf16 v[32:47], a[48:51], v[84:87], v[32:47]
    ds_read_b32 v152, v6 offset:0
    v_mfma_f32_32x32x16_bf16 v[128:143], a[52:55], v[84:87], v[128:143]
    s_add_u32 s83, s95, 16384
    buffer_load_dwordx4 v[84:87], v1, s[8:11], s83 offen offset:2048
    s_waitcnt vmcnt(11)
    v_mfma_f32_32x32x16_bf16 v[32:47], a[56:59], v[88:91], v[32:47]
    v_mfma_f32_32x32x16_bf16 v[128:143], a[60:63], v[88:91], v[128:143]
    s_add_u32 s83, s95, 16384
    buffer_load_dwordx4 v[88:91], v1, s[8:11], s83 offen offset:3072
    s_waitcnt vmcnt(11)
    v_mfma_f32_32x32x16_bf16 v[32:47], a[64:67], v[92:95], v[32:47]
    s_waitcnt lgkmcnt(0)
    v_add_f32 v144, v16, v24
    v_add_f32 v145, v17, v25
    v_add_f32 v146, v18, v26
    v_add_f32 v147, v19, v27
    v_add_f32 v148, v20, v28
    v_mfma_f32_32x32x16_bf16 v[128:143], a[68:71], v[92:95], v[128:143]
    s_add_u32 s83, s95, 20480
    buffer_load_dwordx4 v[92:95], v1, s[8:11], s83 offen offset:0
    v_add_f32 v149, v21, v29
    v_add_f32 v150, v22, v30
    s_waitcnt vmcnt(11)
    v_mfma_f32_32x32x16_bf16 v[32:47], a[72:75], v[96:99], v[32:47]
    v_add_f32 v151, v23, v31
    v_add_f32 v160, v160, v168
    v_add_f32 v161, v161, v169
    v_add_f32 v162, v162, v170
    v_add_f32 v163, v163, v171
    v_add_f32 v164, v164, v172
    v_mfma_f32_32x32x16_bf16 v[128:143], a[76:79], v[96:99], v[128:143]
    s_add_u32 s83, s95, 20480
    buffer_load_dwordx4 v[96:99], v1, s[8:11], s83 offen offset:1024
    v_add_f32 v165, v165, v173
    v_add_f32 v166, v166, v174
    s_waitcnt vmcnt(11)
    v_mfma_f32_32x32x16_bf16 v[32:47], a[80:83], v[100:103], v[32:47]
    v_add_f32 v167, v167, v175
    v_add_f32 v144, v144, v160
    v_add_f32 v145, v145, v161
    v_add_f32 v146, v146, v162
    v_add_f32 v147, v147, v163
    v_add_f32 v148, v148, v164
    v_mfma_f32_32x32x16_bf16 v[128:143], a[84:87], v[100:103], v[128:143]
    s_add_u32 s83, s95, 20480
    buffer_load_dwordx4 v[100:103], v1, s[8:11], s83 offen offset:2048
    v_add_f32 v149, v149, v165
    v_add_f32 v150, v150, v166
    s_waitcnt vmcnt(11)
    v_mfma_f32_32x32x16_bf16 v[32:47], a[88:91], v[104:107], v[32:47]
    v_add_f32 v151, v151, v167
    v_lshlrev_b32 v153, 16, v112
    v_and_b32 v154, s77, v112
    v_fma_f32 v144, v144, v152, v153
    v_fma_f32 v145, v145, v152, v154
    v_lshlrev_b32 v153, 16, v113
    v_mfma_f32_32x32x16_bf16 v[128:143], a[92:95], v[104:107], v[128:143]
    s_add_u32 s83, s95, 20480
    buffer_load_dwordx4 v[104:107], v1, s[8:11], s83 offen offset:3072
    v_and_b32 v154, s77, v113
    v_fma_f32 v146, v146, v152, v153
    s_waitcnt vmcnt(11)
    v_mfma_f32_32x32x16_bf16 v[32:47], a[96:99], v[108:111], v[32:47]
    v_fma_f32 v147, v147, v152, v154
    v_lshlrev_b32 v153, 16, v114
    v_and_b32 v154, s77, v114
    v_fma_f32 v148, v148, v152, v153
    v_fma_f32 v149, v149, v152, v154
    v_lshlrev_b32 v153, 16, v115
    v_mfma_f32_32x32x16_bf16 v[128:143], a[100:103], v[108:111], v[128:143]
    s_add_u32 s83, s95, 24576
    buffer_load_dwordx4 v[108:111], v1, s[8:11], s83 offen offset:0
    v_and_b32 v154, s77, v115
    v_fma_f32 v150, v150, v152, v153
    s_waitcnt vmcnt(11)
    v_mfma_f32_32x32x16_bf16 v[32:47], a[104:107], v[64:67], v[32:47]
    v_fma_f32 v151, v151, v152, v154
    v_mfma_f32_32x32x16_bf16 v[128:143], a[108:111], v[64:67], v[128:143]
    s_add_u32 s83, s95, 24576
    buffer_load_dwordx4 v[64:67], v1, s[8:11], s83 offen offset:1024
    s_waitcnt vmcnt(11)
    v_mfma_f32_32x32x16_bf16 v[32:47], a[112:115], v[68:71], v[32:47]
    v_mfma_f32_32x32x16_bf16 v[128:143], a[116:119], v[68:71], v[128:143]
    s_add_u32 s83, s95, 24576
    buffer_load_dwordx4 v[68:71], v1, s[8:11], s83 offen offset:2048
    s_waitcnt vmcnt(11)
    v_mfma_f32_32x32x16_bf16 v[32:47], a[120:123], v[72:75], v[32:47]
    v_mfma_f32_32x32x16_bf16 v[128:143], a[124:127], v[72:75], v[128:143]
    s_add_u32 s83, s95, 24576
    buffer_load_dwordx4 v[72:75], v1, s[8:11], s83 offen offset:3072
    s_waitcnt vmcnt(11)
    v_mfma_f32_32x32x16_bf16 v[32:47], a[128:131], v[76:79], v[32:47]
    v_mfma_f32_32x32x16_bf16 v[128:143], a[132:135], v[76:79], v[128:143]
    s_waitcnt vmcnt(10)
    v_mfma_f32_32x32x16_bf16 v[32:47], a[136:139], v[80:83], v[32:47]
    v_mfma_f32_32x32x16_bf16 v[128:143], a[140:143], v[80:83], v[128:143]
    s_waitcnt vmcnt(9)
    v_mfma_f32_32x32x16_bf16 v[32:47], a[144:147], v[84:87], v[32:47]
    v_mfma_f32_32x32x16_bf16 v[128:143], a[148:151], v[84:87], v[128:143]
    s_waitcnt vmcnt(8)
    v_mfma_f32_32x32x16_bf16 v[32:47], a[152:155], v[88:91], v[32:47]
    v_mfma_f32_32x32x16_bf16 v[128:143], a[156:159], v[88:91], v[128:143]
    s_waitcnt vmcnt(7)
    v_mfma_f32_32x32x16_bf16 v[32:47], a[160:163], v[92:95], v[32:47]
    v_mfma_f32_32x32x16_bf16 v[128:143], a[164:167], v[92:95], v[128:143]
    s_waitcnt vmcnt(6)
    v_mfma_f32_32x32x16_bf16 v[32:47], a[168:171], v[96:99], v[32:47]
    v_mfma_f32_32x32x16_bf16 v[128:143], a[172:175], v[96:99], v[128:143]
    s_waitcnt vmcnt(5)
    v_mfma_f32_32x32x16_bf16 v[32:47], a[176:179], v[100:103], v[32:47]
    v_mfma_f32_32x32x16_bf16 v[128:143], a[180:183], v[100:103], v[128:143]
    s_waitcnt vmcnt(4)
    v_mfma_f32_32x32x16_bf16 v[32:47], a[184:187], v[104:107], v[32:47]
    v_mfma_f32_32x32x16_bf16 v[128:143], a[188:191], v[104:107], v[128:143]
    s_waitcnt vmcnt(3)
    v_mfma_f32_32x32x16_bf16 v[32:47], a[192:195], v[108:111], v[32:47]
    v_mfma_f32_32x32x16_bf16 v[128:143], a[196:199], v[108:111], v[128:143]
    s_waitcnt vmcnt(2)
    v_mfma_f32_32x32x16_bf16 v[32:47], a[200:203], v[64:67], v[32:47]
    v_mfma_f32_32x32x16_bf16 v[128:143], a[204:207], v[64:67], v[128:143]
    s_waitcnt vmcnt(1)
    v_mfma_f32_32x32x16_bf16 v[32:47], a[208:211], v[68:71], v[32:47]
    v_mfma_f32_32x32x16_bf16 v[128:143], a[212:215], v[68:71], v[128:143]
    s_waitcnt vmcnt(0)
    v_mfma_f32_32x32x16_bf16 v[32:47], a[216:219], v[72:75], v[32:47]
    v_mfma_f32_32x32x16_bf16 v[128:143], a[220:223], v[72:75], v[128:143]
    v_and_b32 v4, 31, v0
    s_lshl_b32 s80, s68, 5
    v_add_u32 v4, s80, v4
    v_mul_u32_u24 v4, 896, v4
    v_lshrrev_b32 v158, 5, v0
    v_lshl_add_u32 v4, v158, 3, v4
    v_cvt_pk_bf16_f32 v154, v144, v145
    v_cvt_pk_bf16_f32 v155, v146, v147
    v_cvt_pk_bf16_f32 v156, v148, v149
    v_cvt_pk_bf16_f32 v157, v150, v151
    s_lshl_b32 s80, s69, 6
    s_lshl_b32 s81, s5, 5
    s_add_u32 s80, s80, s81
    buffer_store_dwordx2 v[154:155], v4, s[32:35], s80 offen offset:0
    buffer_store_dwordx2 v[156:157], v4, s[32:35], s80 offen offset:16
    s_barrier
    ds_write_b128 v12, v[32:35] offset:0
    ds_write_b128 v12, v[36:39] offset:1024
    ds_write_b128 v12, v[40:43] offset:16384
    ds_write_b128 v12, v[44:47] offset:17408
    ds_write_b128 v12, v[128:131] offset:8192
    ds_write_b128 v12, v[132:135] offset:9216
    ds_write_b128 v12, v[136:139] offset:24576
    ds_write_b128 v12, v[140:143] offset:25600
    s_waitcnt lgkmcnt(0)
    s_barrier
    ds_read_b128 v[128:131], v13 offset:0
    ds_read_b128 v[132:135], v13 offset:1024
    ds_read_b128 v[136:139], v13 offset:2048
    ds_read_b128 v[140:143], v13 offset:3072
    ds_read_b128 v[144:147], v13 offset:4096
    ds_read_b128 v[148:151], v13 offset:5120
    ds_read_b128 v[152:155], v13 offset:6144
    ds_read_b128 v[156:159], v13 offset:7168
    ds_read_b32 v168, v6 offset:2048
    s_waitcnt lgkmcnt(0)
    v_add_f32 v160, v128, v136
    v_add_f32 v161, v129, v137
    v_add_f32 v162, v130, v138
    v_add_f32 v163, v131, v139
    v_add_f32 v164, v132, v140
    v_add_f32 v165, v133, v141
    v_add_f32 v166, v134, v142
    v_add_f32 v167, v135, v143
    v_add_f32 v144, v144, v152
    v_add_f32 v145, v145, v153
    v_add_f32 v146, v146, v154
    v_add_f32 v147, v147, v155
    v_add_f32 v148, v148, v156
    v_add_f32 v149, v149, v157
    v_add_f32 v150, v150, v158
    v_add_f32 v151, v151, v159
    v_add_f32 v160, v160, v144
    v_add_f32 v161, v161, v145
    v_add_f32 v162, v162, v146
    v_add_f32 v163, v163, v147
    v_add_f32 v164, v164, v148
    v_add_f32 v165, v165, v149
    v_add_f32 v166, v166, v150
    v_add_f32 v167, v167, v151
    v_lshlrev_b32 v169, 16, v116
    v_and_b32 v170, s77, v116
    v_fma_f32 v160, v160, v168, v169
    v_fma_f32 v161, v161, v168, v170
    v_lshlrev_b32 v169, 16, v117
    v_and_b32 v170, s77, v117
    v_fma_f32 v162, v162, v168, v169
    v_fma_f32 v163, v163, v168, v170
    v_lshlrev_b32 v169, 16, v118
    v_and_b32 v170, s77, v118
    v_fma_f32 v164, v164, v168, v169
    v_fma_f32 v165, v165, v168, v170
    v_lshlrev_b32 v169, 16, v119
    v_and_b32 v170, s77, v119
    v_fma_f32 v166, v166, v168, v169
    v_fma_f32 v167, v167, v168, v170
    v_cvt_pk_bf16_f32 v170, v160, v161
    v_cvt_pk_bf16_f32 v171, v162, v163
    v_cvt_pk_bf16_f32 v172, v164, v165
    v_cvt_pk_bf16_f32 v173, v166, v167
    s_lshl_b32 s80, s69, 6
    s_lshl_b32 s81, s5, 5
    s_add_u32 s80, s80, s81
    s_add_u32 s80, s80, 114688
    buffer_store_dwordx2 v[170:171], v4, s[32:35], s80 offen offset:0
    buffer_store_dwordx2 v[172:173], v4, s[32:35], s80 offen offset:16
    s_branch KB_end
KB_end:
    s_cmp_eq_u32 s39, 0
    s_cbranch_scc1 ER_1_71
    v_mov_b32 v2, s39
    s_lshl_b32 s40, s2, 2
    s_add_u32 s40, s40, 25418752
    v_mov_b32 v3, s40
    buffer_store_dword v2, v3, s[8:11], 0 offen
ER_1_71:
    s_endpgm
KB_spare:
    s_getpc_b64 s[44:45]
KB_pc:
    s_sub_u32 s44, s44, KB_pc-interleave_layers__ssm_conv_h3__swiglu_ffn__prompt_kernel
    s_subb_u32 s45, s45, 0
    s_sub_u32 s40, s2, 224
    s_lshr_b32 s41, s40, 3
    s_lshl_b32 s41, s41, 2
    s_add_u32 s41, s41, s36
    s_lshl_b32 s46, s41, 13
    v_lshlrev_b32 v6, 7, v0
    v_add_u32 v7, s46, v6
    v_cmp_gt_u32 vcc, KB_done-interleave_layers__ssm_conv_h3__swiglu_ffn__prompt_kernel, v7
    s_nop 0
    s_and_saveexec_b64 s[60:61], vcc
    s_cbranch_execz KB_nocode
    global_load_dword v136, v7, s[44:45] sc1
KB_nocode:
    s_mov_b64 exec, s[60:61]
    s_lshl_b32 s42, s40, 6
    s_lshl_b32 s43, s36, 4
    s_add_u32 s42, s42, s43
    v_lshrrev_b32 v2, 3, v0
    v_add_u32 v2, s42, v2
    v_and_b32 v3, 7, v0
    v_mul_u32_u24 v4, 896, v2
    v_lshl_add_u32 v4, v3, 4, v4
    v_add_u32 v5, 7168, v4
    buffer_load_dwordx4 v[8:11], v4, s[16:19], 0 offen offset:0
    buffer_load_dwordx4 v[12:15], v4, s[16:19], 0 offen offset:128
    buffer_load_dwordx4 v[16:19], v4, s[16:19], 0 offen offset:256
    buffer_load_dwordx4 v[20:23], v4, s[16:19], 0 offen offset:384
    buffer_load_dwordx4 v[24:27], v4, s[16:19], 0 offen offset:512
    buffer_load_dwordx4 v[28:31], v4, s[16:19], 0 offen offset:640
    buffer_load_dwordx4 v[32:35], v4, s[16:19], 0 offen offset:768
    buffer_load_dwordx4 v[36:39], v5, s[16:19], 0 offen offset:0
    buffer_load_dwordx4 v[40:43], v5, s[16:19], 0 offen offset:128
    buffer_load_dwordx4 v[44:47], v5, s[16:19], 0 offen offset:256
    buffer_load_dwordx4 v[48:51], v5, s[16:19], 0 offen offset:384
    buffer_load_dwordx4 v[52:55], v5, s[16:19], 0 offen offset:512
    buffer_load_dwordx4 v[56:59], v5, s[16:19], 0 offen offset:640
    buffer_load_dwordx4 v[60:63], v5, s[16:19], 0 offen offset:768
    v_mov_b32 v132, 0
    global_load_dwordx2 v[130:131], v132, s[98:99] sc1
    s_waitcnt vmcnt(0)
    s_cmp_ge_u32 s40, 28
    s_cbranch_scc1 SP_1_72
    v_lshrrev_b32 v141, 4, v0
    v_and_b32 v141, 1, v141
    v_lshrrev_b32 v142, 2, v0
    v_and_b32 v142, 3, v142
    v_lshl_add_u32 v141, v141, 2, v142
    s_mov_b32 s80, 896
    v_mul_lo_u32 v141, s80, v141
    v_and_b32 v142, 3, v0
    v_lshrrev_b32 v143, 5, v0
    v_lshl_add_u32 v142, v143, 2, v142
    v_lshl_add_u32 v140, v142, 4, v141
    s_and_b32 s42, s40, 3
    s_mul_i32 s42, s42, 448
    s_mul_i32 s43, s36, 112
    s_add_u32 s42, s42, s43
    s_mul_i32 s42, s42, 896
    s_lshr_b32 s43, s40, 2
    s_lshl_b32 s43, s43, 7
    s_add_u32 s42, s42, s43
    s_mul_i32 s43, s36, 14336
    s_add_u32 m0, s43, 0
    s_add_u32 s46, s42, 0
    buffer_load_dwordx4 v140, s[28:31], s46 offen offset:0 lds
    s_add_u32 s46, s42, 6144
    buffer_load_dwordx4 v140, s[28:31], s46 offen offset:1024 lds
    s_add_u32 s46, s42, 12288
    buffer_load_dwordx4 v140, s[28:31], s46 offen offset:2048 lds
    s_add_u32 s46, s42, 18432
    buffer_load_dwordx4 v140, s[28:31], s46 offen offset:3072 lds
    s_add_u32 m0, s43, 4096
    s_add_u32 s46, s42, 28672
    buffer_load_dwordx4 v140, s[28:31], s46 offen offset:0 lds
    s_add_u32 s46, s42, 34816
    buffer_load_dwordx4 v140, s[28:31], s46 offen offset:1024 lds
    s_add_u32 s46, s42, 40960
    buffer_load_dwordx4 v140, s[28:31], s46 offen offset:2048 lds
    s_add_u32 s46, s42, 47104
    buffer_load_dwordx4 v140, s[28:31], s46 offen offset:3072 lds
    s_add_u32 m0, s43, 8192
    s_add_u32 s46, s42, 57344
    buffer_load_dwordx4 v140, s[28:31], s46 offen offset:0 lds
    s_add_u32 s46, s42, 63488
    buffer_load_dwordx4 v140, s[28:31], s46 offen offset:1024 lds
    s_add_u32 s46, s42, 69632
    buffer_load_dwordx4 v140, s[28:31], s46 offen offset:2048 lds
    s_add_u32 s46, s42, 75776
    buffer_load_dwordx4 v140, s[28:31], s46 offen offset:3072 lds
    s_add_u32 m0, s43, 12288
    s_add_u32 s46, s42, 86016
    buffer_load_dwordx4 v140, s[28:31], s46 offen offset:0 lds
    s_add_u32 s46, s42, 92160
    buffer_load_dwordx4 v140, s[28:31], s46 offen offset:1024 lds
SP_1_72:
    v_lshlrev_b32 v70, 16, v8
    v_and_b32 v71, s77, v8
    v_lshlrev_b32 v72, 16, v9
    v_and_b32 v73, s77, v9
    v_lshlrev_b32 v74, 16, v10
    v_and_b32 v75, s77, v10
    v_lshlrev_b32 v76, 16, v11
    v_and_b32 v77, s77, v11
    v_lshlrev_b32 v78, 16, v12
    v_and_b32 v79, s77, v12
    v_lshlrev_b32 v80, 16, v13
    v_and_b32 v81, s77, v13
    v_lshlrev_b32 v82, 16, v14
    v_and_b32 v83, s77, v14
    v_lshlrev_b32 v84, 16, v15
    v_and_b32 v85, s77, v15
    v_lshlrev_b32 v86, 16, v16
    v_and_b32 v87, s77, v16
    v_lshlrev_b32 v88, 16, v17
    v_and_b32 v89, s77, v17
    v_lshlrev_b32 v90, 16, v18
    v_and_b32 v91, s77, v18
    v_lshlrev_b32 v92, 16, v19
    v_and_b32 v93, s77, v19
    v_lshlrev_b32 v94, 16, v20
    v_and_b32 v95, s77, v20
    v_lshlrev_b32 v96, 16, v21
    v_and_b32 v97, s77, v21
    v_lshlrev_b32 v98, 16, v22
    v_and_b32 v99, s77, v22
    v_lshlrev_b32 v100, 16, v23
    v_and_b32 v101, s77, v23
    v_lshlrev_b32 v102, 16, v24
    v_and_b32 v103, s77, v24
    v_lshlrev_b32 v104, 16, v25
    v_and_b32 v105, s77, v25
    v_lshlrev_b32 v106, 16, v26
    v_and_b32 v107, s77, v26
    v_lshlrev_b32 v108, 16, v27
    v_and_b32 v109, s77, v27
    v_lshlrev_b32 v110, 16, v28
    v_and_b32 v111, s77, v28
    v_lshlrev_b32 v112, 16, v29
    v_and_b32 v113, s77, v29
    v_lshlrev_b32 v114, 16, v30
    v_and_b32 v115, s77, v30
    v_lshlrev_b32 v116, 16, v31
    v_and_b32 v117, s77, v31
    v_lshlrev_b32 v118, 16, v32
    v_and_b32 v119, s77, v32
    v_lshlrev_b32 v120, 16, v33
    v_and_b32 v121, s77, v33
    v_lshlrev_b32 v122, 16, v34
    v_and_b32 v123, s77, v34
    v_lshlrev_b32 v124, 16, v35
    v_and_b32 v125, s77, v35
    v_add_f32 v64, v70, v71
    v_add_f32 v65, v72, v73
    v_add_f32 v64, v64, v74
    v_add_f32 v65, v65, v75
    v_add_f32 v64, v64, v76
    v_add_f32 v65, v65, v77
    v_add_f32 v64, v64, v78
    v_add_f32 v65, v65, v79
    v_add_f32 v64, v64, v80
    v_add_f32 v65, v65, v81
    v_add_f32 v64, v64, v82
    v_add_f32 v65, v65, v83
    v_add_f32 v64, v64, v84
    v_add_f32 v65, v65, v85
    v_add_f32 v64, v64, v86
    v_add_f32 v65, v65, v87
    v_add_f32 v64, v64, v88
    v_add_f32 v65, v65, v89
    v_add_f32 v64, v64, v90
    v_add_f32 v65, v65, v91
    v_add_f32 v64, v64, v92
    v_add_f32 v65, v65, v93
    v_add_f32 v64, v64, v94
    v_add_f32 v65, v65, v95
    v_add_f32 v64, v64, v96
    v_add_f32 v65, v65, v97
    v_add_f32 v64, v64, v98
    v_add_f32 v65, v65, v99
    v_add_f32 v64, v64, v100
    v_add_f32 v65, v65, v101
    v_add_f32 v64, v64, v102
    v_add_f32 v65, v65, v103
    v_add_f32 v64, v64, v104
    v_add_f32 v65, v65, v105
    v_add_f32 v64, v64, v106
    v_add_f32 v65, v65, v107
    v_add_f32 v64, v64, v108
    v_add_f32 v65, v65, v109
    v_add_f32 v64, v64, v110
    v_add_f32 v65, v65, v111
    v_add_f32 v64, v64, v112
    v_add_f32 v65, v65, v113
    v_add_f32 v64, v64, v114
    v_add_f32 v65, v65, v115
    v_add_f32 v64, v64, v116
    v_add_f32 v65, v65, v117
    v_add_f32 v64, v64, v118
    v_add_f32 v65, v65, v119
    v_add_f32 v64, v64, v120
    v_add_f32 v65, v65, v121
    v_add_f32 v64, v64, v122
    v_add_f32 v65, v65, v123
    v_add_f32 v64, v64, v124
    v_add_f32 v65, v65, v125
    v_add_f32 v64, v64, v65
    s_nop 1
    v_add_f32_dpp v64, v64, v64 quad_perm:[1,0,3,2] row_mask:0xf bank_mask:0xf
    s_nop 1
    v_add_f32_dpp v64, v64, v64 quad_perm:[2,3,0,1] row_mask:0xf bank_mask:0xf
    s_nop 1
    v_add_f32_dpp v64, v64, v64 row_half_mirror row_mask:0xf bank_mask:0xf
    v_mul_f32 v64, 0x3b124925, v64
    v_mov_b32 v65, 0
    v_mov_b32 v66, 0
    v_sub_f32 v70, v70, v64
    v_sub_f32 v71, v71, v64
    v_fmac_f32 v65, v70, v70
    v_fmac_f32 v66, v71, v71
    v_sub_f32 v72, v72, v64
    v_sub_f32 v73, v73, v64
    v_fmac_f32 v65, v72, v72
    v_fmac_f32 v66, v73, v73
    v_sub_f32 v74, v74, v64
    v_sub_f32 v75, v75, v64
    v_fmac_f32 v65, v74, v74
    v_fmac_f32 v66, v75, v75
    v_sub_f32 v76, v76, v64
    v_sub_f32 v77, v77, v64
    v_fmac_f32 v65, v76, v76
    v_fmac_f32 v66, v77, v77
    v_sub_f32 v78, v78, v64
    v_sub_f32 v79, v79, v64
    v_fmac_f32 v65, v78, v78
    v_fmac_f32 v66, v79, v79
    v_sub_f32 v80, v80, v64
    v_sub_f32 v81, v81, v64
    v_fmac_f32 v65, v80, v80
    v_fmac_f32 v66, v81, v81
    v_sub_f32 v82, v82, v64
    v_sub_f32 v83, v83, v64
    v_fmac_f32 v65, v82, v82
    v_fmac_f32 v66, v83, v83
    v_sub_f32 v84, v84, v64
    v_sub_f32 v85, v85, v64
    v_fmac_f32 v65, v84, v84
    v_fmac_f32 v66, v85, v85
    v_sub_f32 v86, v86, v64
    v_sub_f32 v87, v87, v64
    v_fmac_f32 v65, v86, v86
    v_fmac_f32 v66, v87, v87
    v_sub_f32 v88, v88, v64
    v_sub_f32 v89, v89, v64
    v_fmac_f32 v65, v88, v88
    v_fmac_f32 v66, v89, v89
    v_sub_f32 v90, v90, v64
    v_sub_f32 v91, v91, v64
    v_fmac_f32 v65, v90, v90
    v_fmac_f32 v66, v91, v91
    v_sub_f32 v92, v92, v64
    v_sub_f32 v93, v93, v64
    v_fmac_f32 v65, v92, v92
    v_fmac_f32 v66, v93, v93
    v_sub_f32 v94, v94, v64
    v_sub_f32 v95, v95, v64
    v_fmac_f32 v65, v94, v94
    v_fmac_f32 v66, v95, v95
    v_sub_f32 v96, v96, v64
    v_sub_f32 v97, v97, v64
    v_fmac_f32 v65, v96, v96
    v_fmac_f32 v66, v97, v97
    v_sub_f32 v98, v98, v64
    v_sub_f32 v99, v99, v64
    v_fmac_f32 v65, v98, v98
    v_fmac_f32 v66, v99, v99
    v_sub_f32 v100, v100, v64
    v_sub_f32 v101, v101, v64
    v_fmac_f32 v65, v100, v100
    v_fmac_f32 v66, v101, v101
    v_sub_f32 v102, v102, v64
    v_sub_f32 v103, v103, v64
    v_fmac_f32 v65, v102, v102
    v_fmac_f32 v66, v103, v103
    v_sub_f32 v104, v104, v64
    v_sub_f32 v105, v105, v64
    v_fmac_f32 v65, v104, v104
    v_fmac_f32 v66, v105, v105
    v_sub_f32 v106, v106, v64
    v_sub_f32 v107, v107, v64
    v_fmac_f32 v65, v106, v106
    v_fmac_f32 v66, v107, v107
    v_sub_f32 v108, v108, v64
    v_sub_f32 v109, v109, v64
    v_fmac_f32 v65, v108, v108
    v_fmac_f32 v66, v109, v109
    v_sub_f32 v110, v110, v64
    v_sub_f32 v111, v111, v64
    v_fmac_f32 v65, v110, v110
    v_fmac_f32 v66, v111, v111
    v_sub_f32 v112, v112, v64
    v_sub_f32 v113, v113, v64
    v_fmac_f32 v65, v112, v112
    v_fmac_f32 v66, v113, v113
    v_sub_f32 v114, v114, v64
    v_sub_f32 v115, v115, v64
    v_fmac_f32 v65, v114, v114
    v_fmac_f32 v66, v115, v115
    v_sub_f32 v116, v116, v64
    v_sub_f32 v117, v117, v64
    v_fmac_f32 v65, v116, v116
    v_fmac_f32 v66, v117, v117
    v_sub_f32 v118, v118, v64
    v_sub_f32 v119, v119, v64
    v_fmac_f32 v65, v118, v118
    v_fmac_f32 v66, v119, v119
    v_sub_f32 v120, v120, v64
    v_sub_f32 v121, v121, v64
    v_fmac_f32 v65, v120, v120
    v_fmac_f32 v66, v121, v121
    v_sub_f32 v122, v122, v64
    v_sub_f32 v123, v123, v64
    v_fmac_f32 v65, v122, v122
    v_fmac_f32 v66, v123, v123
    v_sub_f32 v124, v124, v64
    v_sub_f32 v125, v125, v64
    v_fmac_f32 v65, v124, v124
    v_fmac_f32 v66, v125, v125
    v_add_f32 v65, v65, v66
    s_nop 1
    v_add_f32_dpp v65, v65, v65 quad_perm:[1,0,3,2] row_mask:0xf bank_mask:0xf
    s_nop 1
    v_add_f32_dpp v65, v65, v65 quad_perm:[2,3,0,1] row_mask:0xf bank_mask:0xf
    s_nop 1
    v_add_f32_dpp v65, v65, v65 row_half_mirror row_mask:0xf bank_mask:0xf
    v_mov_b32 v66, 0x3727c5ac
    v_fmac_f32 v66, 0x3b124925, v65
    v_rsq_f32 v65, v66
    v_add_u32 v67, 0, v2
    v_lshlrev_b32 v67, 3, v67
    v_add_u32 v67, 23855104, v67
    v_cmp_eq_u32 vcc, 0, v3
    s_nop 0
    s_and_saveexec_b64 s[60:61], vcc
    buffer_store_dwordx2 v[64:65], v67, s[8:11], 0 offen sc0 sc1
    s_mov_b64 exec, s[60:61]
    v_lshlrev_b32 v70, 16, v36
    v_and_b32 v71, s77, v36
    v_lshlrev_b32 v72, 16, v37
    v_and_b32 v73, s77, v37
    v_lshlrev_b32 v74, 16, v38
    v_and_b32 v75, s77, v38
    v_lshlrev_b32 v76, 16, v39
    v_and_b32 v77, s77, v39
    v_lshlrev_b32 v78, 16, v40
    v_and_b32 v79, s77, v40
    v_lshlrev_b32 v80, 16, v41
    v_and_b32 v81, s77, v41
    v_lshlrev_b32 v82, 16, v42
    v_and_b32 v83, s77, v42
    v_lshlrev_b32 v84, 16, v43
    v_and_b32 v85, s77, v43
    v_lshlrev_b32 v86, 16, v44
    v_and_b32 v87, s77, v44
    v_lshlrev_b32 v88, 16, v45
    v_and_b32 v89, s77, v45
    v_lshlrev_b32 v90, 16, v46
    v_and_b32 v91, s77, v46
    v_lshlrev_b32 v92, 16, v47
    v_and_b32 v93, s77, v47
    v_lshlrev_b32 v94, 16, v48
    v_and_b32 v95, s77, v48
    v_lshlrev_b32 v96, 16, v49
    v_and_b32 v97, s77, v49
    v_lshlrev_b32 v98, 16, v50
    v_and_b32 v99, s77, v50
    v_lshlrev_b32 v100, 16, v51
    v_and_b32 v101, s77, v51
    v_lshlrev_b32 v102, 16, v52
    v_and_b32 v103, s77, v52
    v_lshlrev_b32 v104, 16, v53
    v_and_b32 v105, s77, v53
    v_lshlrev_b32 v106, 16, v54
    v_and_b32 v107, s77, v54
    v_lshlrev_b32 v108, 16, v55
    v_and_b32 v109, s77, v55
    v_lshlrev_b32 v110, 16, v56
    v_and_b32 v111, s77, v56
    v_lshlrev_b32 v112, 16, v57
    v_and_b32 v113, s77, v57
    v_lshlrev_b32 v114, 16, v58
    v_and_b32 v115, s77, v58
    v_lshlrev_b32 v116, 16, v59
    v_and_b32 v117, s77, v59
    v_lshlrev_b32 v118, 16, v60
    v_and_b32 v119, s77, v60
    v_lshlrev_b32 v120, 16, v61
    v_and_b32 v121, s77, v61
    v_lshlrev_b32 v122, 16, v62
    v_and_b32 v123, s77, v62
    v_lshlrev_b32 v124, 16, v63
    v_and_b32 v125, s77, v63
    v_add_f32 v64, v70, v71
    v_add_f32 v65, v72, v73
    v_add_f32 v64, v64, v74
    v_add_f32 v65, v65, v75
    v_add_f32 v64, v64, v76
    v_add_f32 v65, v65, v77
    v_add_f32 v64, v64, v78
    v_add_f32 v65, v65, v79
    v_add_f32 v64, v64, v80
    v_add_f32 v65, v65, v81
    v_add_f32 v64, v64, v82
    v_add_f32 v65, v65, v83
    v_add_f32 v64, v64, v84
    v_add_f32 v65, v65, v85
    v_add_f32 v64, v64, v86
    v_add_f32 v65, v65, v87
    v_add_f32 v64, v64, v88
    v_add_f32 v65, v65, v89
    v_add_f32 v64, v64, v90
    v_add_f32 v65, v65, v91
    v_add_f32 v64, v64, v92
    v_add_f32 v65, v65, v93
    v_add_f32 v64, v64, v94
    v_add_f32 v65, v65, v95
    v_add_f32 v64, v64, v96
    v_add_f32 v65, v65, v97
    v_add_f32 v64, v64, v98
    v_add_f32 v65, v65, v99
    v_add_f32 v64, v64, v100
    v_add_f32 v65, v65, v101
    v_add_f32 v64, v64, v102
    v_add_f32 v65, v65, v103
    v_add_f32 v64, v64, v104
    v_add_f32 v65, v65, v105
    v_add_f32 v64, v64, v106
    v_add_f32 v65, v65, v107
    v_add_f32 v64, v64, v108
    v_add_f32 v65, v65, v109
    v_add_f32 v64, v64, v110
    v_add_f32 v65, v65, v111
    v_add_f32 v64, v64, v112
    v_add_f32 v65, v65, v113
    v_add_f32 v64, v64, v114
    v_add_f32 v65, v65, v115
    v_add_f32 v64, v64, v116
    v_add_f32 v65, v65, v117
    v_add_f32 v64, v64, v118
    v_add_f32 v65, v65, v119
    v_add_f32 v64, v64, v120
    v_add_f32 v65, v65, v121
    v_add_f32 v64, v64, v122
    v_add_f32 v65, v65, v123
    v_add_f32 v64, v64, v124
    v_add_f32 v65, v65, v125
    v_add_f32 v64, v64, v65
    s_nop 1
    v_add_f32_dpp v64, v64, v64 quad_perm:[1,0,3,2] row_mask:0xf bank_mask:0xf
    s_nop 1
    v_add_f32_dpp v64, v64, v64 quad_perm:[2,3,0,1] row_mask:0xf bank_mask:0xf
    s_nop 1
    v_add_f32_dpp v64, v64, v64 row_half_mirror row_mask:0xf bank_mask:0xf
    v_mul_f32 v64, 0x3b124925, v64
    v_mov_b32 v65, 0
    v_mov_b32 v66, 0
    v_sub_f32 v70, v70, v64
    v_sub_f32 v71, v71, v64
    v_fmac_f32 v65, v70, v70
    v_fmac_f32 v66, v71, v71
    v_sub_f32 v72, v72, v64
    v_sub_f32 v73, v73, v64
    v_fmac_f32 v65, v72, v72
    v_fmac_f32 v66, v73, v73
    v_sub_f32 v74, v74, v64
    v_sub_f32 v75, v75, v64
    v_fmac_f32 v65, v74, v74
    v_fmac_f32 v66, v75, v75
    v_sub_f32 v76, v76, v64
    v_sub_f32 v77, v77, v64
    v_fmac_f32 v65, v76, v76
    v_fmac_f32 v66, v77, v77
    v_sub_f32 v78, v78, v64
    v_sub_f32 v79, v79, v64
    v_fmac_f32 v65, v78, v78
    v_fmac_f32 v66, v79, v79
    v_sub_f32 v80, v80, v64
    v_sub_f32 v81, v81, v64
    v_fmac_f32 v65, v80, v80
    v_fmac_f32 v66, v81, v81
    v_sub_f32 v82, v82, v64
    v_sub_f32 v83, v83, v64
    v_fmac_f32 v65, v82, v82
    v_fmac_f32 v66, v83, v83
    v_sub_f32 v84, v84, v64
    v_sub_f32 v85, v85, v64
    v_fmac_f32 v65, v84, v84
    v_fmac_f32 v66, v85, v85
    v_sub_f32 v86, v86, v64
    v_sub_f32 v87, v87, v64
    v_fmac_f32 v65, v86, v86
    v_fmac_f32 v66, v87, v87
    v_sub_f32 v88, v88, v64
    v_sub_f32 v89, v89, v64
    v_fmac_f32 v65, v88, v88
    v_fmac_f32 v66, v89, v89
    v_sub_f32 v90, v90, v64
    v_sub_f32 v91, v91, v64
    v_fmac_f32 v65, v90, v90
    v_fmac_f32 v66, v91, v91
    v_sub_f32 v92, v92, v64
    v_sub_f32 v93, v93, v64
    v_fmac_f32 v65, v92, v92
    v_fmac_f32 v66, v93, v93
    v_sub_f32 v94, v94, v64
    v_sub_f32 v95, v95, v64
    v_fmac_f32 v65, v94, v94
    v_fmac_f32 v66, v95, v95
    v_sub_f32 v96, v96, v64
    v_sub_f32 v97, v97, v64
    v_fmac_f32 v65, v96, v96
    v_fmac_f32 v66, v97, v97
    v_sub_f32 v98, v98, v64
    v_sub_f32 v99, v99, v64
    v_fmac_f32 v65, v98, v98
    v_fmac_f32 v66, v99, v99
    v_sub_f32 v100, v100, v64
    v_sub_f32 v101, v101, v64
    v_fmac_f32 v65, v100, v100
    v_fmac_f32 v66, v101, v101
    v_sub_f32 v102, v102, v64
    v_sub_f32 v103, v103, v64
    v_fmac_f32 v65, v102, v102
    v_fmac_f32 v66, v103, v103
    v_sub_f32 v104, v104, v64
    v_sub_f32 v105, v105, v64
    v_fmac_f32 v65, v104, v104
    v_fmac_f32 v66, v105, v105
    v_sub_f32 v106, v106, v64
    v_sub_f32 v107, v107, v64
    v_fmac_f32 v65, v106, v106
    v_fmac_f32 v66, v107, v107
    v_sub_f32 v108, v108, v64
    v_sub_f32 v109, v109, v64
    v_fmac_f32 v65, v108, v108
    v_fmac_f32 v66, v109, v109
    v_sub_f32 v110, v110, v64
    v_sub_f32 v111, v111, v64
    v_fmac_f32 v65, v110, v110
    v_fmac_f32 v66, v111, v111
    v_sub_f32 v112, v112, v64
    v_sub_f32 v113, v113, v64
    v_fmac_f32 v65, v112, v112
    v_fmac_f32 v66, v113, v113
    v_sub_f32 v114, v114, v64
    v_sub_f32 v115, v115, v64
    v_fmac_f32 v65, v114, v114
    v_fmac_f32 v66, v115, v115
    v_sub_f32 v116, v116, v64
    v_sub_f32 v117, v117, v64
    v_fmac_f32 v65, v116, v116
    v_fmac_f32 v66, v117, v117
    v_sub_f32 v118, v118, v64
    v_sub_f32 v119, v119, v64
    v_fmac_f32 v65, v118, v118
    v_fmac_f32 v66, v119, v119
    v_sub_f32 v120, v120, v64
    v_sub_f32 v121, v121, v64
    v_fmac_f32 v65, v120, v120
    v_fmac_f32 v66, v121, v121
    v_sub_f32 v122, v122, v64
    v_sub_f32 v123, v123, v64
    v_fmac_f32 v65, v122, v122
    v_fmac_f32 v66, v123, v123
    v_sub_f32 v124, v124, v64
    v_sub_f32 v125, v125, v64
    v_fmac_f32 v65, v124, v124
    v_fmac_f32 v66, v125, v125
    v_add_f32 v65, v65, v66
    s_nop 1
    v_add_f32_dpp v65, v65, v65 quad_perm:[1,0,3,2] row_mask:0xf bank_mask:0xf
    s_nop 1
    v_add_f32_dpp v65, v65, v65 quad_perm:[2,3,0,1] row_mask:0xf bank_mask:0xf
    s_nop 1
    v_add_f32_dpp v65, v65, v65 row_half_mirror row_mask:0xf bank_mask:0xf
    v_mov_b32 v66, 0x3727c5ac
    v_fmac_f32 v66, 0x3b124925, v65
    v_rsq_f32 v65, v66
    v_add_u32 v67, 8, v2
    v_lshlrev_b32 v67, 3, v67
    v_add_u32 v67, 23855104, v67
    v_cmp_eq_u32 vcc, 0, v3
    s_nop 0
    s_and_saveexec_b64 s[60:61], vcc
    buffer_store_dwordx2 v[64:65], v67, s[8:11], 0 offen sc0 sc1
    s_mov_b64 exec, s[60:61]
    s_mov_b32 s80, 0
NG_1_73:
    v_readfirstlane_b32 s96, v130
    v_readfirstlane_b32 s97, v131
    s_nop 0
    s_cmp_lg_u32 s97, 0
    s_cbranch_scc1 NGD_1_74
    v_mov_b32 v132, 0
    global_load_dwordx2 v[130:131], v132, s[98:99] sc1
    s_waitcnt vmcnt(0)
    s_add_u32 s80, s80, 1
    s_cmp_lt_u32 s80, 20000
    s_cbranch_scc0 NGD_1_74_to
    s_sleep 1
    s_branch NG_1_73
NGD_1_74_to:
    s_or_b32 s39, s39, 1024
NGD_1_74:
    s_waitcnt vmcnt(0)
    s_barrier
    s_lshl_b32 s43, s40, 3
    s_add_u32 s44, s43, 25419776
    s_add_u32 s43, s43, 25415680
    s_cmp_eq_u32 s36, 0
    s_cbranch_scc0 FL_1_75
    v_mov_b32 v64, s96
    v_mov_b32 v65, s97
    v_mov_b32 v66, s43
    s_mov_b64 s[60:61], exec
    s_mov_b64 exec, 1
    buffer_store_dwordx2 v[64:65], v66, s[8:11], 0 offen sc0 sc1
    s_mov_b64 exec, s[60:61]
FL_1_75:
    s_cmp_ge_u32 s40, 28
    s_cbranch_scc1 SP_1_76
    v_lshrrev_b32 v140, 5, v0
    v_lshlrev_b32 v140, 8, v140
    v_bfe_u32 v141, v0, 2, 2
    v_lshl_add_u32 v140, v141, 6, v140
    v_bfe_u32 v141, v0, 4, 1
    v_lshl_add_u32 v140, v141, 5, v140
    v_and_b32 v141, 3, v0
    v_lshl_add_u32 v140, v141, 3, v140
    s_mul_i32 s43, s36, 14336
    v_add_u32 v140, s43, v140
    s_mul_i32 s42, s40, 57344
    s_add_u32 s42, s42, s43
    s_add_u32 s42, s42, 25420800
    ds_read_b64_tr_b16 v[8:9], v140 offset:0
    ds_read_b64_tr_b16 v[10:11], v140 offset:1024
    ds_read_b64_tr_b16 v[12:13], v140 offset:512
    ds_read_b64_tr_b16 v[14:15], v140 offset:1536
    ds_read_b64_tr_b16 v[16:17], v140 offset:2048
    ds_read_b64_tr_b16 v[18:19], v140 offset:3072
    ds_read_b64_tr_b16 v[20:21], v140 offset:2560
    ds_read_b64_tr_b16 v[22:23], v140 offset:3584
    ds_read_b64_tr_b16 v[24:25], v140 offset:4096
    ds_read_b64_tr_b16 v[26:27], v140 offset:5120
    ds_read_b64_tr_b16 v[28:29], v140 offset:4608
    ds_read_b64_tr_b16 v[30:31], v140 offset:5632
    ds_read_b64_tr_b16 v[32:33], v140 offset:6144
    ds_read_b64_tr_b16 v[34:35], v140 offset:7168
    ds_read_b64_tr_b16 v[36:37], v140 offset:6656
    ds_read_b64_tr_b16 v[38:39], v140 offset:7680
    s_waitcnt lgkmcnt(0)
    ds_read_b64_tr_b16 v[40:41], v140 offset:8192
    ds_read_b64_tr_b16 v[42:43], v140 offset:9216
    ds_read_b64_tr_b16 v[44:45], v140 offset:8704
    ds_read_b64_tr_b16 v[46:47], v140 offset:9728
    ds_read_b64_tr_b16 v[48:49], v140 offset:10240
    ds_read_b64_tr_b16 v[50:51], v140 offset:11264
    ds_read_b64_tr_b16 v[52:53], v140 offset:10752
    ds_read_b64_tr_b16 v[54:55], v140 offset:11776
    ds_read_b64_tr_b16 v[56:57], v140 offset:12288
    ds_read_b64_tr_b16 v[58:59], v140 offset:13312
    ds_read_b64_tr_b16 v[60:61], v140 offset:12800
    ds_read_b64_tr_b16 v[62:63], v140 offset:13824
    s_waitcnt lgkmcnt(0)
    s_add_u32 s43, s42, 0
    buffer_store_dwordx4 v[8:11], v1, s[8:11], s43 offen offset:0 sc0 sc1
    buffer_store_dwordx4 v[12:15], v1, s[8:11], s43 offen offset:1024 sc0 sc1
    buffer_store_dwordx4 v[16:19], v1, s[8:11], s43 offen offset:2048 sc0 sc1
    buffer_store_dwordx4 v[20:23], v1, s[8:11], s43 offen offset:3072 sc0 sc1
    s_add_u32 s43, s42, 4096
    buffer_store_dwordx4 v[24:27], v1, s[8:11], s43 offen offset:0 sc0 sc1
    buffer_store_dwordx4 v[28:31], v1, s[8:11], s43 offen offset:1024 sc0 sc1
    buffer_store_dwordx4 v[32:35], v1, s[8:11], s43 offen offset:2048 sc0 sc1
    buffer_store_dwordx4 v[36:39], v1, s[8:11], s43 offen offset:3072 sc0 sc1
    s_add_u32 s43, s42, 8192
    buffer_store_dwordx4 v[40:43], v1, s[8:11], s43 offen offset:0 sc0 sc1
    buffer_store_dwordx4 v[44:47], v1, s[8:11], s43 offen offset:1024 sc0 sc1
    buffer_store_dwordx4 v[48:51], v1, s[8:11], s43 offen offset:2048 sc0 sc1
    buffer_store_dwordx4 v[52:55], v1, s[8:11], s43 offen offset:3072 sc0 sc1
    s_add_u32 s43, s42, 12288
    buffer_store_dwordx4 v[56:59], v1, s[8:11], s43 offen offset:0 sc0 sc1
    buffer_store_dwordx4 v[60:63], v1, s[8:11], s43 offen offset:1024 sc0 sc1
    s_waitcnt vmcnt(0)
SP_1_76:
    s_barrier
    s_cmp_ge_u32 s40, 28
    s_cbranch_scc1 SP_1_77
    s_cmp_eq_u32 s36, 0
    s_cbranch_scc0 FL_1_78
    v_mov_b32 v64, s96
    v_mov_b32 v65, s97
    v_mov_b32 v66, s44
    s_mov_b64 s[60:61], exec
    s_mov_b64 exec, 1
    buffer_store_dwordx2 v[64:65], v66, s[8:11], 0 offen sc0 sc1
    s_mov_b64 exec, s[60:61]
FL_1_78:
SP_1_77:
    s_and_b32 s64, s2, 7
    s_lshl_b32 s81, s64, 8
    s_add_u32 s81, s81, 25416704
    v_min_u32 v66, 27, v0
    v_lshlrev_b32 v66, 3, v66
    v_add_u32 v66, s81, v66
    s_mov_b32 s80, 0
CC_1_79:
    buffer_load_dwordx2 v[64:65], v66, s[8:11], 0 offen sc1
    s_waitcnt vmcnt(0)
    v_xor_b32 v65, s97, v65
    v_cmp_ne_u32 vcc, s96, v64
    v_cmp_lt_u32 s[88:89], 15, v65
    s_nop 0
    s_or_b64 vcc, vcc, s[88:89]
    s_cbranch_vccz CCD_1_80
    s_add_u32 s80, s80, 1
    s_cmp_lt_u32 s80, 20000
    s_cbranch_scc0 CCD_1_80_to
    s_sleep 1
    s_branch CC_1_79
CCD_1_80_to:
    s_or_b32 s39, s39, 256
CCD_1_80:
    v_readfirstlane_b32 s81, v65
    s_nop 1
    v_cmp_ne_u32 vcc, s81, v65
    s_nop 0
    s_cmp_eq_u64 vcc, 0
    s_cselect_b32 s37, 1, 0
    s_mul_i32 s42, s41, 57344
    s_add_u32 s42, s42, 25420800
    s_mul_i32 s43, s64, 917504
    s_lshl_b32 s46, s41, 13
    s_add_u32 s43, s43, s46
    s_add_u32 s43, s43, 9175040
    v_min_u32 v2, 27, v0
    v_lshlrev_b32 v2, 3, v2
    v_add_u32 v2, 25419776, v2
    buffer_load_dwordx2 v[4:5], v2, s[8:11], 0 offen sc1
    s_waitcnt vmcnt(0)
    v_cmp_ne_u64 vcc, s[96:97], v[4:5]
    s_cbranch_vccz FSD_1_82
    s_mov_b32 s80, 0
FS_1_81:
    buffer_load_dwordx2 v[4:5], v2, s[8:11], 0 offen sc1
    s_waitcnt vmcnt(0)
    v_cmp_ne_u64 vcc, s[96:97], v[4:5]
    s_cbranch_vccz FSD_1_82
    s_add_u32 s80, s80, 1
    s_cmp_lt_u32 s80, 20000
    s_cbranch_scc0 FSD_1_82_to
    s_sleep 1
    s_branch FS_1_81
FSD_1_82_to:
    s_or_b32 s39, s39, 2048
FSD_1_82:
    s_add_u32 s47, s42, 0
    buffer_load_dword v134, v6, s[8:11], s47 offen sc1
ST_1_83:
    s_cmp_ge_u32 s41, 12
    s_cbranch_scc1 ST_1_84
    s_add_u32 s47, s42, 917504
    buffer_load_dword v135, v6, s[8:11], s47 offen sc1
ST_1_84:
    s_cmp_eq_u32 s37, 0
    s_cselect_b32 s46, 1, 0
    s_cmp_ge_u32 s41, 14
    s_cselect_b32 s47, 1, 0
    s_or_b32 s46, s46, s47
    s_cbranch_scc1 ST_1_85
    s_add_u32 s47, s43, 0
    buffer_load_dword v134, v6, s[8:11], s47 offen sc1
ST_1_85:
    s_cmp_eq_u32 s37, 0
    s_cselect_b32 s46, 1, 0
    s_cmp_ge_u32 s41, 14
    s_cselect_b32 s47, 1, 0
    s_or_b32 s46, s46, s47
    s_cbranch_scc1 ST_1_86
    s_add_u32 s47, s43, 114688
    buffer_load_dword v135, v6, s[8:11], s47 offen sc1
ST_1_86:
    s_add_u32 s47, s42, 8192
    buffer_load_dword v134, v6, s[8:11], s47 offen sc1
ST_1_87:
    s_cmp_ge_u32 s41, 12
    s_cbranch_scc1 ST_1_88
    s_add_u32 s47, s42, 925696
    buffer_load_dword v135, v6, s[8:11], s47 offen sc1
ST_1_88:
    s_cmp_eq_u32 s37, 0
    s_cselect_b32 s46, 1, 0
    s_cmp_ge_u32 s41, 14
    s_cselect_b32 s47, 1, 0
    s_or_b32 s46, s46, s47
    s_cbranch_scc1 ST_1_89
    s_add_u32 s47, s43, 229376
    buffer_load_dword v134, v6, s[8:11], s47 offen sc1
ST_1_89:
    s_cmp_eq_u32 s37, 0
    s_cselect_b32 s46, 1, 0
    s_cmp_ge_u32 s41, 14
    s_cselect_b32 s47, 1, 0
    s_or_b32 s46, s46, s47
    s_cbranch_scc1 ST_1_90
    s_add_u32 s47, s43, 344064
    buffer_load_dword v135, v6, s[8:11], s47 offen sc1
ST_1_90:
    s_add_u32 s47, s42, 16384
    buffer_load_dword v134, v6, s[8:11], s47 offen sc1
ST_1_91:
    s_cmp_ge_u32 s41, 12
    s_cbranch_scc1 ST_1_92
    s_add_u32 s47, s42, 933888
    buffer_load_dword v135, v6, s[8:11], s47 offen sc1
ST_1_92:
    s_cmp_eq_u32 s37, 0
    s_cselect_b32 s46, 1, 0
    s_cmp_ge_u32 s41, 14
    s_cselect_b32 s47, 1, 0
    s_or_b32 s46, s46, s47
    s_cbranch_scc1 ST_1_93
    s_add_u32 s47, s43, 458752
    buffer_load_dword v134, v6, s[8:11], s47 offen sc1
ST_1_93:
    s_cmp_eq_u32 s37, 0
    s_cselect_b32 s46, 1, 0
    s_cmp_ge_u32 s41, 14
    s_cselect_b32 s47, 1, 0
    s_or_b32 s46, s46, s47
    s_cbranch_scc1 ST_1_94
    s_add_u32 s47, s43, 573440
    buffer_load_dword v135, v6, s[8:11], s47 offen sc1
ST_1_94:
    s_add_u32 s47, s42, 24576
    buffer_load_dword v134, v6, s[8:11], s47 offen sc1
ST_1_95:
    s_cmp_ge_u32 s41, 12
    s_cbranch_scc1 ST_1_96
    s_add_u32 s47, s42, 942080
    buffer_load_dword v135, v6, s[8:11], s47 offen sc1
ST_1_96:
    s_cmp_eq_u32 s37, 0
    s_cselect_b32 s46, 1, 0
    s_cmp_ge_u32 s41, 14
    s_cselect_b32 s47, 1, 0
    s_or_b32 s46, s46, s47
    s_cbranch_scc1 ST_1_97
    s_add_u32 s47, s43, 688128
    buffer_load_dword v134, v6, s[8:11], s47 offen sc1
ST_1_97:
    s_cmp_eq_u32 s37, 0
    s_cselect_b32 s46, 1, 0
    s_cmp_ge_u32 s41, 14
    s_cselect_b32 s47, 1, 0
    s_or_b32 s46, s46, s47
    s_cbranch_scc1 ST_1_98
    s_add_u32 s47, s43, 802816
    buffer_load_dword v135, v6, s[8:11], s47 offen sc1
ST_1_98:
    s_waitcnt vmcnt(15)
    s_add_u32 s47, s42, 32768
    buffer_load_dword v134, v6, s[8:11], s47 offen sc1
ST_1_99:
    s_waitcnt vmcnt(15)
    s_cmp_ge_u32 s41, 12
    s_cbranch_scc1 ST_1_100
    s_add_u32 s47, s42, 950272
    buffer_load_dword v135, v6, s[8:11], s47 offen sc1
ST_1_100:
    s_waitcnt vmcnt(15)
    s_add_u32 s47, s42, 40960
    buffer_load_dword v134, v6, s[8:11], s47 offen sc1
ST_1_101:
    s_waitcnt vmcnt(15)
    s_cmp_ge_u32 s41, 12
    s_cbranch_scc1 ST_1_102
    s_add_u32 s47, s42, 958464
    buffer_load_dword v135, v6, s[8:11], s47 offen sc1
ST_1_102:
    s_waitcnt vmcnt(15)
    s_add_u32 s47, s42, 49152
    buffer_load_dword v134, v6, s[8:11], s47 offen sc1
ST_1_103:
    s_waitcnt vmcnt(15)
    s_cmp_ge_u32 s41, 12
    s_cbranch_scc1 ST_1_104
    s_add_u32 s47, s42, 966656
    buffer_load_dword v135, v6, s[8:11], s47 offen sc1
ST_1_104:
    s_waitcnt vmcnt(15)
    s_waitcnt vmcnt(0)
    s_endpgm
KB_done:
    s_endpgm
.section .rodata,"a"
.p2align 6
.amdhsa_kernel interleave_layers__ssm_conv_h3__swiglu_ffn__prompt_kernel
  .amdhsa_next_free_vgpr 512
  .amdhsa_next_free_sgpr 102
  .amdhsa_accum_offset 256
  .amdhsa_group_segment_fixed_size 0
  .amdhsa_kernarg_size 104
  .amdhsa_user_sgpr_count 2
  .amdhsa_user_sgpr_kernarg_segment_ptr 1
  .amdhsa_system_sgpr_workgroup_id_x 1
  .amdhsa_float_denorm_mode_32 3
  .amdhsa_float_denorm_mode_16_64 3
.end_amdhsa_kernel
```
